```python
import torch

def _softmax(x, axis=-1):
    return torch.softmax(x, dim=axis)

def _gelu(x):
    return torch.nn.functional.gelu(x, approximate='tanh')

def _silu(x):
    return torch.nn.functional.silu(x)

def _sigmoid(x):
    return torch.sigmoid(x)

def _layernorm(x, axis=-1, eps=1e-05):
    m = x.mean(dim=axis, keepdim=True)
    v = x.var(dim=axis, keepdim=True, unbiased=False)
    return (x - m) / torch.sqrt(v + eps)

def _scatter_add(tgt, idx, src, axis=0):
    return tgt.clone().index_add_(axis, idx, src)

def _segment_sum(src, seg, n):
    out = torch.zeros((n,) + src.shape[1:], dtype=src.dtype)
    return out.index_add_(0, seg, src)

def _pad(x, pw):
    flat = tuple((v for pair in reversed(pw) for v in pair))
    return torch.nn.functional.pad(x, flat)
kernel_name = 'adaLN_cond__sliding_local_dilated__swiglu_ffn__prompt'

def setup_inputs():

    _w = lambda a: (lambda t: t.to(torch.bfloat16) if t.is_floating_point() else t)(torch.as_tensor(a))

    def _A_setup():
        B, S, D = (1, 2048, 640)
        return {'x': _w((lambda *s: torch.randn(*s, dtype=torch.bfloat16) * 0.05)(B, S, D)), 'wqkv': _w((lambda *s: torch.randn(*s, dtype=torch.bfloat16) * 0.05)(D, 3 * D)), 'wo': _w((lambda *s: torch.randn(*s, dtype=torch.bfloat16) * 0.05)(D, D))}
    _A_in = _A_setup()

    def _B_setup():
        B, S, D, F = (1, 2048, 640, 1536)
        return {'x': _w((lambda *s: torch.randn(*s, dtype=torch.bfloat16) * 0.05)(B, S, D)), 'w_gate': _w((lambda *s: torch.randn(*s, dtype=torch.bfloat16) * 0.05)(D, F)), 'w_up': _w((lambda *s: torch.randn(*s, dtype=torch.bfloat16) * 0.05)(D, F)), 'w_down': _w((lambda *s: torch.randn(*s, dtype=torch.bfloat16) * 0.05)(F, D))}
    _B_in = _B_setup()
    return {'A_x': _A_in['x'], 'A_wqkv': _A_in['wqkv'], 'A_wo': _A_in['wo'], 'B_x': _B_in['x'], 'B_w_gate': _B_in['w_gate'], 'B_w_up': _B_in['w_up'], 'B_w_down': _B_in['w_down'], 'c': _w((lambda *s: torch.randn(*s, dtype=torch.bfloat16) * 0.1)(1, 640) * 8.0), 'w_mod': _w((lambda *s: torch.randn(*s, dtype=torch.bfloat16) * 0.1)(640, 6 * 640) * 640 ** (-0.5) * 8.0)}

def reference(A_x, A_wqkv, A_wo, B_x, B_w_gate, B_w_up, B_w_down, c, w_mod):

    def _A_ref(x, wqkv, wo):
        B, S, D = x.shape
        H = 32
        Dh = D // H
        W, dil = (8, 2)
        qkv = (lambda x, *d: x.permute(*d))((x @ wqkv).reshape(B, S, 3, H, Dh), 2, 0, 3, 1, 4)
        q, k, v = (qkv[0], qkv[1], qkv[2])
        scale = Dh ** (-0.5)
        pos = torch.arange(S)
        off = torch.arange(W) * dil
        idx = pos[:, None] - off[None, :]
        mask = idx >= 0
        idx_c = torch.where(mask, idx, 0).reshape(-1)
        kg = k[:, :, idx_c, :].reshape(B, H, S, W, Dh)
        vg = v[:, :, idx_c, :].reshape(B, H, S, W, Dh)
        logits = torch.einsum('bhsd,bhswd->bhsw', q, kg) * scale
        logits = torch.where(mask[None, None, :, :], logits, -1000000000.0)
        attn = _softmax(logits, axis=-1)
        o = torch.einsum('bhsw,bhswd->bhsd', attn, vg)
        return (lambda x, *d: x.permute(*d))(o, 0, 2, 1, 3).reshape(B, S, D) @ wo

    def _B_ref(x, w_gate, w_up, w_down):
        g = _silu(x @ w_gate)
        u = x @ w_up
        return g * u @ w_down
    x = A_x
    mod = (_silu(c) @ w_mod).reshape(c.shape[0], 6, 1, -1)
    sa, ca, ga, sb, cb, gb = (mod[:, 0].clone(), mod[:, 1].clone(), mod[:, 2].clone(), mod[:, 3].clone(), mod[:, 4].clone(), mod[:, 5].clone())
    h = _layernorm(x, axis=-1) * (1 + ca) + sa
    x = x + ga * _A_ref(h, A_wqkv, A_wo)
    h = _layernorm(x, axis=-1) * (1 + cb) + sb
    x = x + gb * _B_ref(h, B_w_gate, B_w_up, B_w_down)
    return x
```

```asm
; @launch grid=(256,1,1) block=(256,1,1) lds=163840
.amdgcn_target "amdgcn-amd-amdhsa--gfx950"
.text
.globl adaLN_cond__sliding_local_dilated__swiglu_ffn__prompt_kernel
.p2align 12
.type adaLN_cond__sliding_local_dilated__swiglu_ffn__prompt_kernel,@function
adaLN_cond__sliding_local_dilated__swiglu_ffn__prompt_kernel:
  s_load_dwordx16 s[64:79], s[0:1], 0
  s_load_dwordx8 s[80:87], s[0:1], 64
  s_load_dwordx2 s[32:33], s[0:1], 64
  s_load_dwordx2 s[8:9], s[0:1], 0
  s_load_dwordx2 s[4:5], s[0:1], 88
  s_memrealtime s[38:39]
  s_cmp_ge_u32 s2, 256
  s_cbranch_scc1 K_END
  v_lshrrev_b32 v2, 6, v0
  v_and_b32 v1, 63, v0
  v_readfirstlane_b32 s3, v2
  v_lshlrev_b32 v2, 4, v1
  s_lshr_b32 s20, s2, 4
  s_and_b32 s21, s2, 7
  s_lshl_b32 s21, s21, 4
  s_or_b32 s20, s20, s21
  v_and_b32 v30, 7, v0
  v_lshrrev_b32 v31, 3, v1
  v_mov_b32 v20, 0
  s_mov_b32 s7, 0x20000
  s_mov_b32 s11, s7
  s_mov_b32 s6, 29360128
  s_mov_b32 s10, 2621440
  s_bitcmp0_b32 s2, 3
  s_cbranch_scc1 P_H
  s_getpc_b64 s[90:91]
  s_and_b32 s90, s90, 0xfffff000
  s_lshr_b32 s22, s2, 2
  s_andn2_b32 s22, s22, 3
  s_add_u32 s22, s22, s3
  s_min_u32 s22, s22, 40
  v_lshl_add_u32 v10, s22, 10, v2
  global_load_dwordx4 v[244:247], v10, s[90:91]
  s_branch P_RE
P_H:
  s_and_b32 s29, s20, 3
  s_lshr_b32 s21, s20, 2
  s_cmp_lt_u32 s21, 20
  s_cselect_b32 s28, 0, 10
  s_add_u32 s28, s28, s21
  s_mul_i32 s93, s29, 1228800
  s_lshl_b32 s23, s28, 7
  s_add_u32 s92, s93, s23
  s_mov_b32 s35, s7
  s_mov_b32 s34, 4915200
  s_mulk_i32 s29, 160
  v_lshrrev_b32 v254, 3, v0
  v_mul_u32_u24 v253, 7680, v254
  v_lshl_add_u32 v253, v30, 4, v253
  v_min_u32 v252, 4, v30
  v_lshl_add_u32 v254, v252, 5, v254
  v_add_lshl_u32 v254, v254, s29, 1
  s_or_b32 s25, s2, s3
  s_waitcnt lgkmcnt(0)
  s_cbranch_scc1 P_NONON
  s_or_b32 s22, s38, 1
  v_mov_b32 v22, s22
  global_store_dword v20, v22, s[84:85] sc0 sc1
P_NONON:
  global_load_ushort v220, v254, s[78:79]
  s_mov_b32 s24, 245760
  buffer_load_dwordx4 v[56:59], v253, s[32:35], s92 offen nt
  s_add_u32 s92, s92, s24
  buffer_load_dwordx4 v[60:63], v253, s[32:35], s92 offen nt
  s_add_u32 s92, s92, s24
  buffer_load_dwordx4 v[64:67], v253, s[32:35], s92 offen nt
  s_add_u32 s92, s92, s24
  buffer_load_dwordx4 v[68:71], v253, s[32:35], s92 offen nt
  s_add_u32 s92, s92, s24
  buffer_load_dwordx4 v[72:75], v253, s[32:35], s92 offen nt
  s_and_b32 s22, s20, 63
  s_lshl_b32 s22, s22, 1
  s_and_b32 s23, s3, 1
  s_add_u32 s22, s22, s23
  s_lshl_b32 s22, s22, 5
  s_lshr_b32 s23, s20, 6
  s_lshl_b32 s23, s23, 1
  s_add_u32 s22, s22, s23
  s_lshr_b32 s23, s3, 1
  s_add_u32 s22, s22, s23
  s_mulk_i32 s22, 640
  v_mul_u32_u24 v10, 2560, v30
  v_lshl_add_u32 v10, v31, 4, v10
  v_lshrrev_b32 v248, 4, v1
  v_lshlrev_b32 v248, 3, v248
  v_lshl_add_u32 v248, v30, 5, v248
  s_lshl_b32 s23, s3, 8
  s_add_u32 s23, s23, 137216
  v_add_u32 v249, s23, v248
  v_lshlrev_b32 v248, 2, v1
  v_add_u32 v250, 137216, v248
  s_mulk_i32 s29, 96
  s_lshl_b32 s28, s28, 8
  s_add_u32 s28, s28, s29
  s_waitcnt vmcnt(5)
  global_load_dword v19, v20, s[84:85] sc1
  s_barrier
  buffer_load_dwordx4 v[80:83], v10, s[8:11], s22 offen offset:0
  buffer_load_dwordx4 v[84:87], v10, s[8:11], s22 offen offset:128
  buffer_load_dwordx4 v[88:91], v10, s[8:11], s22 offen offset:256
  buffer_load_dwordx4 v[92:95], v10, s[8:11], s22 offen offset:384
  buffer_load_dwordx4 v[96:99], v10, s[8:11], s22 offen offset:512
  global_load_dword v18, v20, s[84:85] sc1
  v_lshlrev_b32 v220, 16, v220
  v_mul_f32 v221, 3216550459, v220
  v_exp_f32 v221, v221
  s_nop 0
  v_add_f32 v221, 1.0, v221
  v_rcp_f32 v221, v221
  s_nop 0
  v_mul_f32 v220, v220, v221
  v_cvt_pk_bf16_f32 v220, v220, 0
  ds_swizzle_b32 v221, v220 offset:24
  ds_swizzle_b32 v222, v220 offset:56
  ds_swizzle_b32 v223, v220 offset:88
  ds_swizzle_b32 v224, v220 offset:120
  ds_swizzle_b32 v225, v220 offset:152
  s_waitcnt lgkmcnt(0)
  v_lshlrev_b32 v226, 16, v221
  v_lshlrev_b32 v227, 16, v222
  v_lshlrev_b32 v228, 16, v223
  v_lshlrev_b32 v229, 16, v224
  v_lshlrev_b32 v230, 16, v225
  s_waitcnt vmcnt(7)
  v_mov_b32 v32, 0
  v_mov_b32 v33, 0
  v_mov_b32 v34, 0
  v_mov_b32 v35, 0
  v_mov_b32 v36, 0
  v_mov_b32 v37, 0
  v_mov_b32 v38, 0
  v_mov_b32 v39, 0
  v_dot2c_f32_bf16 v32, v56, v221
  v_dot2c_f32_bf16 v33, v56, v226
  v_dot2c_f32_bf16 v34, v57, v221
  v_dot2c_f32_bf16 v35, v57, v226
  v_dot2c_f32_bf16 v36, v58, v221
  v_dot2c_f32_bf16 v37, v58, v226
  v_dot2c_f32_bf16 v38, v59, v221
  v_dot2c_f32_bf16 v39, v59, v226
  v_dot2c_f32_bf16 v32, v60, v222
  v_dot2c_f32_bf16 v33, v60, v227
  v_dot2c_f32_bf16 v34, v61, v222
  v_dot2c_f32_bf16 v35, v61, v227
  v_dot2c_f32_bf16 v36, v62, v222
  v_dot2c_f32_bf16 v37, v62, v227
  v_dot2c_f32_bf16 v38, v63, v222
  v_dot2c_f32_bf16 v39, v63, v227
  v_dot2c_f32_bf16 v32, v64, v223
  v_dot2c_f32_bf16 v33, v64, v228
  v_dot2c_f32_bf16 v34, v65, v223
  v_dot2c_f32_bf16 v35, v65, v228
  v_dot2c_f32_bf16 v36, v66, v223
  v_dot2c_f32_bf16 v37, v66, v228
  v_dot2c_f32_bf16 v38, v67, v223
  v_dot2c_f32_bf16 v39, v67, v228
  v_dot2c_f32_bf16 v32, v68, v224
  v_dot2c_f32_bf16 v33, v68, v229
  v_dot2c_f32_bf16 v34, v69, v224
  v_dot2c_f32_bf16 v35, v69, v229
  v_dot2c_f32_bf16 v36, v70, v224
  v_dot2c_f32_bf16 v37, v70, v229
  v_dot2c_f32_bf16 v38, v71, v224
  v_dot2c_f32_bf16 v39, v71, v229
  v_dot2c_f32_bf16 v32, v72, v225
  v_dot2c_f32_bf16 v33, v72, v230
  v_dot2c_f32_bf16 v34, v73, v225
  v_dot2c_f32_bf16 v35, v73, v230
  v_dot2c_f32_bf16 v36, v74, v225
  v_dot2c_f32_bf16 v37, v74, v230
  v_dot2c_f32_bf16 v38, v75, v225
  v_dot2c_f32_bf16 v39, v75, v230
  v_permlane32_swap_b32 v32, v36
  v_permlane32_swap_b32 v33, v37
  v_permlane32_swap_b32 v34, v38
  v_permlane32_swap_b32 v35, v39
  v_add_f32 v32, v32, v36
  v_add_f32 v33, v33, v37
  v_add_f32 v34, v34, v38
  v_add_f32 v35, v35, v39
  s_nop 0
  v_permlane16_swap_b32 v32, v34
  v_permlane16_swap_b32 v33, v35
  v_add_f32 v32, v32, v34
  v_add_f32 v33, v33, v35
  s_nop 0
  v_add_f32_dpp v32, v32, v32 row_ror:8 row_mask:0xf bank_mask:0xf
  v_add_f32_dpp v33, v33, v33 row_ror:8 row_mask:0xf bank_mask:0xf
  ds_write_b64 v249, v[32:33] offset:0
  s_waitcnt vmcnt(6)
  v_readfirstlane_b32 s22, v19
  s_nop 0
  s_cmp_lg_u32 s22, 0
  s_cbranch_scc1 P_N1
  s_waitcnt vmcnt(0)
  v_mov_b32 v19, v18
P_N1:
  s_mov_b32 s27, 400000
P_NPH:
  v_readfirstlane_b32 s22, v19
  s_sub_u32 s27, s27, 1
  s_cmp_eq_u32 s27, 0
  s_cbranch_scc1 P_NOKH
  s_cmp_eq_u32 s22, 0
  s_cbranch_scc1 P_NRH
  s_sub_u32 s23, s38, s22
  s_add_u32 s23, s23, 2000
  s_cmp_lt_u32 s23, 4000
  s_cbranch_scc1 P_NOKH
  s_cmp_lt_u32 s27, 399936
  s_cbranch_scc1 P_NOKH
P_NRH:
  global_load_dword v19, v20, s[84:85] sc1
  s_waitcnt vmcnt(0)
  s_branch P_NPH
P_NOKH:
  s_mul_i32 s22, s22, 0x9e3779b1
  s_lshr_b32 s23, s22, 15
  s_xor_b32 s22, s22, s23
  s_mul_i32 s22, s22, 0x85ebca6b
  s_max_u32 s36, s22, 1
  s_waitcnt lgkmcnt(0)
  s_barrier
  s_cmp_lg_u32 s3, 0
  s_cbranch_scc1 PUB_1
  ds_read2st64_b32 v[32:33], v250 offset0:0 offset1:1
  ds_read2st64_b32 v[34:35], v250 offset0:2 offset1:3
  v_bfe_u32 v252, v1, 2, 2
  v_lshlrev_b32 v252, 3, v252
  v_lshrrev_b32 v252, v252, s36
  v_and_b32 v251, 3, v1
  v_cmp_eq_u32 vcc, 0, v251
  v_mov_b32 v251, 0xff
  s_nop 0
  v_cndmask_b32_e64 v251, 0, v251, vcc
  s_waitcnt lgkmcnt(0)
  v_add_f32 v32, v32, v33
  v_add_f32 v34, v34, v35
  v_add_f32 v32, v32, v34
  v_bfi_b32 v32, v251, v252, v32
  buffer_store_dword v32, v248, s[4:7], s28 offen sc0 sc1
PUB_1:
  s_cmp_lt_u32 s21, 18
  s_cselect_b32 s30, 12, 32
  s_cmp_lt_u32 s21, 8
  s_cselect_b32 s30, 42, s30
  s_add_u32 s30, s30, s21
  s_lshl_b32 s23, s30, 7
  s_add_u32 s92, s93, s23
  s_lshl_b32 s30, s30, 8
  s_add_u32 s30, s30, s29
  s_cmp_lt_u32 s21, 28
  s_cselect_b32 s92, s92, 1073741824
  s_cselect_b32 s30, s30, 1073741824
  buffer_load_dwordx4 v[100:103], v253, s[32:35], s92 offen nt
  s_add_u32 s92, s92, s24
  buffer_load_dwordx4 v[104:107], v253, s[32:35], s92 offen nt
  s_add_u32 s92, s92, s24
  buffer_load_dwordx4 v[108:111], v253, s[32:35], s92 offen nt
  s_add_u32 s92, s92, s24
  buffer_load_dwordx4 v[112:115], v253, s[32:35], s92 offen nt
  s_add_u32 s92, s92, s24
  buffer_load_dwordx4 v[116:119], v253, s[32:35], s92 offen nt
  s_mul_i32 s22, s2, 171
  s_lshr_b32 s22, s22, 12
  s_mul_i32 s23, s22, 24
  s_sub_u32 s23, s2, s23
  s_lshl_b32 s23, s23, 2
  s_add_u32 s23, s23, s3
  s_mul_i32 s23, s23, 20480
  s_lshl_b32 s22, s22, 7
  s_add_u32 s22, s22, s23
  s_cmp_lt_u32 s2, 240
  s_cselect_b32 s22, s22, 1073741824
  s_add_u32 s23, s22, 10240
  v_mul_u32_u24 v21, 1280, v31
  v_lshl_add_u32 v21, v30, 4, v21
  s_mov_b32 s88, s76
  s_mov_b32 s89, s77
  s_mov_b32 s90, 1966080
  s_mov_b32 s91, 0x20000
  buffer_load_dwordx4 a[240:243], v21, s[88:91], s22 offen nt
  buffer_load_dwordx4 a[244:247], v21, s[88:91], s23 offen nt
  s_cmp_lg_u32 s3, 0
  s_cbranch_scc1 P_H00
  s_call_b64 s[94:95], WARM_1
  s_branch P_H0e
P_H00:
  s_cmp_lg_u32 s3, 1
  s_cbranch_scc1 P_H01
  s_call_b64 s[94:95], WARM_2
  s_branch P_H0e
P_H01:
  s_cmp_lg_u32 s3, 2
  s_cbranch_scc1 P_H02
  s_call_b64 s[94:95], WARM_3
  s_branch P_H0e
P_H02:
  s_call_b64 s[94:95], WARM_4
P_H0e:
  v_mov_b32 v7, 0
  v_mov_b32 v9, 0
  s_mov_b32 s63, 0
  s_mov_b32 s62, 0
  s_mov_b32 s52, 0xff
  v_add_u32 v3, 0x10000, v2
  v_add_u32 v4, 0x20000, v2
  s_and_b32 s22, s2, 7
  s_lshr_b32 s23, s2, 3
  s_lshr_b32 s24, s23, 3
  s_and_b32 s19, s23, 7
  s_lshl_b32 s18, s22, 2
  s_add_u32 s18, s18, s24
  s_lshr_b32 s16, s22, 1
  s_lshl_b32 s16, s16, 2
  s_add_u32 s16, s16, s24
  s_and_b32 s17, s22, 1
  s_lshl_b32 s17, s17, 3
  s_add_u32 s17, s17, s19
  s_lshl_b32 s44, s3, 12
  v_add_u32 v5, s44, v2
  s_lshl_b32 s45, s3, 10
  s_add_u32 s45, s45, 16384
  v_add_u32 v6, s45, v2
  s_mov_b32 s12, s82
  s_mov_b32 s13, s83
  s_mov_b32 s14, 2621440
  s_mov_b32 s15, 0x20000
  s_lshl_b32 s39, s20, 7
  s_add_u32 s39, s39, 884736
  s_cmp_eq_u32 s3, 0
  s_cselect_b32 s53, s39, 1073741824
  v_mov_b32 v24, 0
  v_mov_b32 v25, 0
  v_mov_b32 v26, 0
  v_mov_b32 v27, 0
  s_lshl_b32 s46, s16, 2
  s_add_u32 s46, s46, s3
  s_lshl_b32 s46, s46, 4
  s_add_u32 s46, s46, s17
  s_lshl_b32 s46, s46, 7
  s_add_u32 s46, s46, 229376
  s_lshl_b32 s47, s18, 2
  s_add_u32 s47, s47, s3
  s_lshl_b32 s47, s47, 3
  s_add_u32 s47, s47, s19
  s_lshl_b32 s47, s47, 7
  s_add_u32 s47, s47, 753664
  v_lshlrev_b32 v22, 17, v31
  v_lshl_add_u32 v22, v30, 4, v22
  s_mov_b64 exec, 0xffffffff
  buffer_store_dwordx4 v[24:27], v22, s[4:7], s46 offen sc0 sc1
  s_mov_b64 exec, 0xff
  buffer_store_dwordx4 v[24:27], v2, s[4:7], s47 offen sc0 sc1
  buffer_store_dwordx4 v[24:27], v2, s[4:7], s53 offen sc0 sc1
  s_mov_b32 exec_lo, s52
  buffer_store_dwordx4 v[24:27], v2, s[4:7], s53 offen sc0 sc1
  s_mov_b64 exec, -1
  v_mov_b32 v38, 0x3f803f80
  s_waitcnt vmcnt(11)
  v_dot2_f32_bf16 v40, v80, v38, 0
  v_dot2_f32_bf16 v41, v80, v80, 0
  v_dot2_f32_bf16 v40, v81, v38, v40
  v_dot2_f32_bf16 v41, v81, v81, v41
  v_dot2_f32_bf16 v40, v82, v38, v40
  v_dot2_f32_bf16 v41, v82, v82, v41
  v_dot2_f32_bf16 v40, v83, v38, v40
  v_dot2_f32_bf16 v41, v83, v83, v41
  v_dot2_f32_bf16 v40, v84, v38, v40
  v_dot2_f32_bf16 v41, v84, v84, v41
  v_dot2_f32_bf16 v40, v85, v38, v40
  v_dot2_f32_bf16 v41, v85, v85, v41
  v_dot2_f32_bf16 v40, v86, v38, v40
  v_dot2_f32_bf16 v41, v86, v86, v41
  v_dot2_f32_bf16 v40, v87, v38, v40
  v_dot2_f32_bf16 v41, v87, v87, v41
  v_dot2_f32_bf16 v40, v88, v38, v40
  v_dot2_f32_bf16 v41, v88, v88, v41
  v_dot2_f32_bf16 v40, v89, v38, v40
  v_dot2_f32_bf16 v41, v89, v89, v41
  v_dot2_f32_bf16 v40, v90, v38, v40
  v_dot2_f32_bf16 v41, v90, v90, v41
  v_dot2_f32_bf16 v40, v91, v38, v40
  v_dot2_f32_bf16 v41, v91, v91, v41
  v_dot2_f32_bf16 v40, v92, v38, v40
  v_dot2_f32_bf16 v41, v92, v92, v41
  v_dot2_f32_bf16 v40, v93, v38, v40
  v_dot2_f32_bf16 v41, v93, v93, v41
  v_dot2_f32_bf16 v40, v94, v38, v40
  v_dot2_f32_bf16 v41, v94, v94, v41
  v_dot2_f32_bf16 v40, v95, v38, v40
  v_dot2_f32_bf16 v41, v95, v95, v41
  v_dot2_f32_bf16 v40, v96, v38, v40
  v_dot2_f32_bf16 v41, v96, v96, v41
  v_dot2_f32_bf16 v40, v97, v38, v40
  v_dot2_f32_bf16 v41, v97, v97, v41
  v_dot2_f32_bf16 v40, v98, v38, v40
  v_dot2_f32_bf16 v41, v98, v98, v41
  v_dot2_f32_bf16 v40, v99, v38, v40
  v_dot2_f32_bf16 v41, v99, v99, v41
  s_nop 1
  v_add_f32_dpp v40, v40, v40 row_ror:8 row_mask:0xf bank_mask:0xf
  v_add_f32_dpp v41, v41, v41 row_ror:8 row_mask:0xf bank_mask:0xf
  v_mov_b32 v42, v40
  v_mov_b32 v43, v41
  s_nop 0
  v_permlane16_swap_b32 v40, v42
  v_permlane16_swap_b32 v41, v43
  v_add_f32 v40, v40, v42
  v_add_f32 v41, v41, v43
  v_mov_b32 v42, v40
  v_mov_b32 v43, v41
  s_nop 0
  v_permlane32_swap_b32 v40, v42
  v_permlane32_swap_b32 v41, v43
  v_add_f32 v40, v40, v42
  v_add_f32 v41, v41, v43
  s_lshl_b32 s22, s3, 6
  s_add_u32 s22, s22, 136192
  v_lshl_add_u32 v12, v30, 3, s22
  v_xor_b32 v13, 0x80, v12
  ds_write_b64 v12, v[40:41]
  v_lshlrev_b32 v160, 16, v80
  v_and_b32 v161, 0xffff0000, v80
  v_lshlrev_b32 v162, 16, v81
  v_and_b32 v163, 0xffff0000, v81
  v_lshlrev_b32 v164, 16, v82
  v_and_b32 v165, 0xffff0000, v82
  v_lshlrev_b32 v166, 16, v83
  v_and_b32 v167, 0xffff0000, v83
  v_lshlrev_b32 v168, 16, v84
  v_and_b32 v169, 0xffff0000, v84
  v_lshlrev_b32 v170, 16, v85
  v_and_b32 v171, 0xffff0000, v85
  v_lshlrev_b32 v172, 16, v86
  v_and_b32 v173, 0xffff0000, v86
  v_lshlrev_b32 v174, 16, v87
  v_and_b32 v175, 0xffff0000, v87
  v_lshlrev_b32 v176, 16, v88
  v_and_b32 v177, 0xffff0000, v88
  v_lshlrev_b32 v178, 16, v89
  v_and_b32 v179, 0xffff0000, v89
  v_lshlrev_b32 v180, 16, v90
  v_and_b32 v181, 0xffff0000, v90
  v_lshlrev_b32 v182, 16, v91
  v_and_b32 v183, 0xffff0000, v91
  v_lshlrev_b32 v184, 16, v92
  v_and_b32 v185, 0xffff0000, v92
  v_lshlrev_b32 v186, 16, v93
  v_and_b32 v187, 0xffff0000, v93
  v_lshlrev_b32 v188, 16, v94
  v_and_b32 v189, 0xffff0000, v94
  v_lshlrev_b32 v190, 16, v95
  v_and_b32 v191, 0xffff0000, v95
  v_lshlrev_b32 v192, 16, v96
  v_and_b32 v193, 0xffff0000, v96
  v_lshlrev_b32 v194, 16, v97
  v_and_b32 v195, 0xffff0000, v97
  v_lshlrev_b32 v196, 16, v98
  v_and_b32 v197, 0xffff0000, v98
  v_lshlrev_b32 v198, 16, v99
  v_and_b32 v199, 0xffff0000, v99
  s_waitcnt lgkmcnt(0)
  s_barrier
  ds_read_b64 v[42:43], v13
  s_lshl_b32 s24, s3, 10
  s_lshl_b32 s25, s3, 8
  s_add_u32 s25, s25, 4096
  v_and_b32 v11, 0xf0, v2
  s_add_u32 s22, s24, 0
  s_add_u32 s23, s25, 0
  buffer_load_dwordx4 v[48:51], v2, s[4:7], s22 offen sc1
  buffer_load_dwordx4 v[64:67], v11, s[4:7], s23 offen sc1
  s_add_u32 s22, s24, 15360
  s_add_u32 s23, s25, 15360
  buffer_load_dwordx4 v[52:55], v2, s[4:7], s22 offen sc1
  buffer_load_dwordx4 v[68:71], v11, s[4:7], s23 offen sc1
  s_add_u32 s22, s24, 30720
  s_add_u32 s23, s25, 30720
  buffer_load_dwordx4 v[56:59], v2, s[4:7], s22 offen sc1
  buffer_load_dwordx4 v[72:75], v11, s[4:7], s23 offen sc1
  s_add_u32 s22, s24, 46080
  s_add_u32 s23, s25, 46080
  buffer_load_dwordx4 v[60:63], v2, s[4:7], s22 offen sc1
  buffer_load_dwordx4 v[76:79], v11, s[4:7], s23 offen sc1
  s_waitcnt lgkmcnt(0)
  v_add_f32 v40, v40, v42
  v_add_f32 v41, v41, v43
  v_mul_f32 v40, 986500301, v40
  v_mul_f32 v41, 986500301, v41
  v_fma_f32 v41, -v40, v40, v41
  v_max_f32 v41, 0, v41
  v_cvt_pk_bf16_f32 v41, v41, v41
  v_and_b32 v41, 0xffff0000, v41
  v_add_f32 v41, 925353388, v41
  v_cvt_pk_bf16_f32 v41, v41, v41
  v_and_b32 v41, 0xffff0000, v41
  v_sqrt_f32 v41, v41
  v_cvt_pk_bf16_f32 v40, v40, v40
  v_and_b32 v40, 0xffff0000, v40
  v_cvt_pk_bf16_f32 v41, v41, v41
  v_and_b32 v41, 0xffff0000, v41
  v_rcp_f32 v42, v41
  s_nop 0
  v_mul_f32 v44, -v40, v42
  v_mov_b32 v43, v42
  v_mov_b32 v45, v44
  v_pk_fma_f32 v[160:161], v[160:161], v[42:43], v[44:45]
  v_pk_fma_f32 v[162:163], v[162:163], v[42:43], v[44:45]
  v_pk_fma_f32 v[164:165], v[164:165], v[42:43], v[44:45]
  v_pk_fma_f32 v[166:167], v[166:167], v[42:43], v[44:45]
  v_pk_fma_f32 v[168:169], v[168:169], v[42:43], v[44:45]
  v_pk_fma_f32 v[170:171], v[170:171], v[42:43], v[44:45]
  v_pk_fma_f32 v[172:173], v[172:173], v[42:43], v[44:45]
  v_pk_fma_f32 v[174:175], v[174:175], v[42:43], v[44:45]
  v_pk_fma_f32 v[176:177], v[176:177], v[42:43], v[44:45]
  v_pk_fma_f32 v[178:179], v[178:179], v[42:43], v[44:45]
  v_pk_fma_f32 v[180:181], v[180:181], v[42:43], v[44:45]
  v_pk_fma_f32 v[182:183], v[182:183], v[42:43], v[44:45]
  v_pk_fma_f32 v[184:185], v[184:185], v[42:43], v[44:45]
  v_pk_fma_f32 v[186:187], v[186:187], v[42:43], v[44:45]
  v_pk_fma_f32 v[188:189], v[188:189], v[42:43], v[44:45]
  v_pk_fma_f32 v[190:191], v[190:191], v[42:43], v[44:45]
  v_pk_fma_f32 v[192:193], v[192:193], v[42:43], v[44:45]
  v_pk_fma_f32 v[194:195], v[194:195], v[42:43], v[44:45]
  v_pk_fma_f32 v[196:197], v[196:197], v[42:43], v[44:45]
  v_pk_fma_f32 v[198:199], v[198:199], v[42:43], v[44:45]
  s_lshr_b32 s22, s3, 1
  s_mul_i32 s23, s22, 1280
  s_add_u32 s23, s23, 131072
  v_lshl_add_u32 v16, v31, 5, s23
  v_add_u32 v12, s24, v2
  v_cmp_lt_u32 vcc, 2559, v12
  s_nop 1
  v_cndmask_b32_e64 v19, 0, 1.0, vcc
  v_add_u32 v12, 131072, v12
  s_add_u32 s23, s25, 131072
  v_add_u32 v13, s23, v11
  s_mul_i32 s31, s20, 20480
  s_mul_i32 s22, s22, 10240
  s_add_u32 s31, s31, s22
  s_and_b32 s22, s3, 1
  s_lshl_b32 s22, s22, 7
  s_add_u32 s31, s31, s22
  s_add_u32 s31, s31, 1048576
  v_lshlrev_b32 v10, 8, v31
  v_lshl_add_u32 v10, v30, 4, v10
  v_and_b32 v28, 3, v1
  v_lshlrev_b32 v28, 3, v28
  v_lshrrev_b32 v28, v28, s36
  s_waitcnt vmcnt(14)
  v_mov_b32 v32, 0
  v_mov_b32 v33, 0
  v_mov_b32 v34, 0
  v_mov_b32 v35, 0
  v_mov_b32 v36, 0
  v_mov_b32 v37, 0
  v_mov_b32 v38, 0
  v_mov_b32 v39, 0
  v_dot2c_f32_bf16 v32, v100, v221
  v_dot2c_f32_bf16 v33, v100, v226
  v_dot2c_f32_bf16 v34, v101, v221
  v_dot2c_f32_bf16 v35, v101, v226
  v_dot2c_f32_bf16 v36, v102, v221
  v_dot2c_f32_bf16 v37, v102, v226
  v_dot2c_f32_bf16 v38, v103, v221
  v_dot2c_f32_bf16 v39, v103, v226
  v_dot2c_f32_bf16 v32, v104, v222
  v_dot2c_f32_bf16 v33, v104, v227
  v_dot2c_f32_bf16 v34, v105, v222
  v_dot2c_f32_bf16 v35, v105, v227
  v_dot2c_f32_bf16 v36, v106, v222
  v_dot2c_f32_bf16 v37, v106, v227
  v_dot2c_f32_bf16 v38, v107, v222
  v_dot2c_f32_bf16 v39, v107, v227
  v_dot2c_f32_bf16 v32, v108, v223
  v_dot2c_f32_bf16 v33, v108, v228
  v_dot2c_f32_bf16 v34, v109, v223
  v_dot2c_f32_bf16 v35, v109, v228
  v_dot2c_f32_bf16 v36, v110, v223
  v_dot2c_f32_bf16 v37, v110, v228
  v_dot2c_f32_bf16 v38, v111, v223
  v_dot2c_f32_bf16 v39, v111, v228
  v_dot2c_f32_bf16 v32, v112, v224
  v_dot2c_f32_bf16 v33, v112, v229
  v_dot2c_f32_bf16 v34, v113, v224
  v_dot2c_f32_bf16 v35, v113, v229
  v_dot2c_f32_bf16 v36, v114, v224
  v_dot2c_f32_bf16 v37, v114, v229
  v_dot2c_f32_bf16 v38, v115, v224
  v_dot2c_f32_bf16 v39, v115, v229
  v_dot2c_f32_bf16 v32, v116, v225
  v_dot2c_f32_bf16 v33, v116, v230
  v_dot2c_f32_bf16 v34, v117, v225
  v_dot2c_f32_bf16 v35, v117, v230
  v_dot2c_f32_bf16 v36, v118, v225
  v_dot2c_f32_bf16 v37, v118, v230
  v_dot2c_f32_bf16 v38, v119, v225
  v_dot2c_f32_bf16 v39, v119, v230
  v_permlane32_swap_b32 v32, v36
  v_permlane32_swap_b32 v33, v37
  v_permlane32_swap_b32 v34, v38
  v_permlane32_swap_b32 v35, v39
  v_add_f32 v32, v32, v36
  v_add_f32 v33, v33, v37
  v_add_f32 v34, v34, v38
  v_add_f32 v35, v35, v39
  s_nop 0
  v_permlane16_swap_b32 v32, v34
  v_permlane16_swap_b32 v33, v35
  v_add_f32 v32, v32, v34
  v_add_f32 v33, v33, v35
  s_nop 0
  v_add_f32_dpp v32, v32, v32 row_ror:8 row_mask:0xf bank_mask:0xf
  v_add_f32_dpp v33, v33, v33 row_ror:8 row_mask:0xf bank_mask:0xf
  ds_write_b64 v249, v[32:33] offset:1024
  s_waitcnt lgkmcnt(0)
  s_barrier
  s_cmp_lg_u32 s3, 1
  s_cbranch_scc1 PUB_2
  ds_read2st64_b32 v[32:33], v250 offset0:4 offset1:5
  ds_read2st64_b32 v[34:35], v250 offset0:6 offset1:7
  v_bfe_u32 v252, v1, 2, 2
  v_lshlrev_b32 v252, 3, v252
  v_lshrrev_b32 v252, v252, s36
  v_and_b32 v251, 3, v1
  v_cmp_eq_u32 vcc, 0, v251
  v_mov_b32 v251, 0xff
  s_nop 0
  v_cndmask_b32_e64 v251, 0, v251, vcc
  s_waitcnt lgkmcnt(0)
  v_add_f32 v32, v32, v33
  v_add_f32 v34, v34, v35
  v_add_f32 v32, v32, v34
  v_bfi_b32 v32, v251, v252, v32
  buffer_store_dword v32, v248, s[4:7], s30 offen sc0 sc1
PUB_2:
  s_waitcnt vmcnt(1)
  s_cmp_eq_u32 s3, 1
  s_cbranch_scc1 P_GL0
  s_waitcnt vmcnt(0)
P_GL0:
  s_mov_b32 s27, 400000
P_GL:
  v_xor_b32 v29, v28, v48
  v_bitop3_b32 v29, v29, v28, v52 bitop3:0xf6
  v_bitop3_b32 v29, v29, v28, v56 bitop3:0xf6
  v_bitop3_b32 v29, v29, v28, v60 bitop3:0xf6
  v_bitop3_b32 v29, v29, v28, v64 bitop3:0xf6
  v_bitop3_b32 v29, v29, v28, v68 bitop3:0xf6
  v_bitop3_b32 v29, v29, v28, v72 bitop3:0xf6
  v_bitop3_b32 v29, v29, v28, v76 bitop3:0xf6
  v_and_b32 v29, 0xff, v29
  v_cmp_eq_u32 vcc, 0, v29
  s_nop 0
  s_cmp_eq_u64 vcc, -1
  s_cbranch_scc1 P_GK
  s_add_u32 s22, s24, 0
  s_add_u32 s23, s25, 0
  buffer_load_dwordx4 v[48:51], v2, s[4:7], s22 offen sc1
  buffer_load_dwordx4 v[64:67], v11, s[4:7], s23 offen sc1
  s_add_u32 s22, s24, 15360
  s_add_u32 s23, s25, 15360
  buffer_load_dwordx4 v[52:55], v2, s[4:7], s22 offen sc1
  buffer_load_dwordx4 v[68:71], v11, s[4:7], s23 offen sc1
  s_add_u32 s22, s24, 30720
  s_add_u32 s23, s25, 30720
  buffer_load_dwordx4 v[56:59], v2, s[4:7], s22 offen sc1
  buffer_load_dwordx4 v[72:75], v11, s[4:7], s23 offen sc1
  s_add_u32 s22, s24, 46080
  s_add_u32 s23, s25, 46080
  buffer_load_dwordx4 v[60:63], v2, s[4:7], s22 offen sc1
  buffer_load_dwordx4 v[76:79], v11, s[4:7], s23 offen sc1
  s_waitcnt vmcnt(0)
  s_sub_u32 s27, s27, 1
  s_cmp_lg_u32 s27, 0
  s_cbranch_scc1 P_GL
  s_waitcnt vmcnt(0)
P_GK:
  v_and_b32 v48, 0xffffff00, v48
  v_and_b32 v52, 0xffffff00, v52
  v_and_b32 v56, 0xffffff00, v56
  v_and_b32 v60, 0xffffff00, v60
  v_pk_add_f32 v[48:49], v[48:49], v[52:53]
  v_pk_add_f32 v[56:57], v[56:57], v[60:61]
  v_pk_add_f32 v[50:51], v[50:51], v[54:55]
  v_pk_add_f32 v[58:59], v[58:59], v[62:63]
  v_pk_add_f32 v[48:49], v[48:49], v[56:57]
  v_pk_add_f32 v[50:51], v[50:51], v[58:59]
  v_cvt_pk_bf16_f32 v52, v48, v49
  v_cvt_pk_bf16_f32 v53, v50, v51
  v_lshlrev_b32 v48, 16, v52
  v_and_b32 v49, 0xffff0000, v52
  v_lshlrev_b32 v50, 16, v53
  v_and_b32 v51, 0xffff0000, v53
  v_add_f32 v48, v19, v48
  v_add_f32 v49, v19, v49
  v_add_f32 v50, v19, v50
  v_add_f32 v51, v19, v51
  v_cvt_pk_bf16_f32 v52, v48, v49
  v_cvt_pk_bf16_f32 v53, v50, v51
  v_lshlrev_b32 v48, 16, v52
  v_and_b32 v49, 0xffff0000, v52
  v_lshlrev_b32 v50, 16, v53
  v_and_b32 v51, 0xffff0000, v53
  ds_write_b128 v12, v[48:51]
  v_and_b32 v64, 0xffffff00, v64
  v_and_b32 v68, 0xffffff00, v68
  v_and_b32 v72, 0xffffff00, v72
  v_and_b32 v76, 0xffffff00, v76
  v_pk_add_f32 v[64:65], v[64:65], v[68:69]
  v_pk_add_f32 v[72:73], v[72:73], v[76:77]
  v_pk_add_f32 v[66:67], v[66:67], v[70:71]
  v_pk_add_f32 v[74:75], v[74:75], v[78:79]
  v_pk_add_f32 v[64:65], v[64:65], v[72:73]
  v_pk_add_f32 v[66:67], v[66:67], v[74:75]
  v_cvt_pk_bf16_f32 v68, v64, v65
  v_cvt_pk_bf16_f32 v69, v66, v67
  v_lshlrev_b32 v64, 16, v68
  v_and_b32 v65, 0xffff0000, v68
  v_lshlrev_b32 v66, 16, v69
  v_and_b32 v67, 0xffff0000, v69
  v_add_f32 v64, 1.0, v64
  v_add_f32 v65, 1.0, v65
  v_add_f32 v66, 1.0, v66
  v_add_f32 v67, 1.0, v67
  v_cvt_pk_bf16_f32 v68, v64, v65
  v_cvt_pk_bf16_f32 v69, v66, v67
  v_lshlrev_b32 v64, 16, v68
  v_and_b32 v65, 0xffff0000, v68
  v_lshlrev_b32 v66, 16, v69
  v_and_b32 v67, 0xffff0000, v69
  ds_write_b128 v13, v[64:67]
  s_waitcnt lgkmcnt(0)
  s_barrier
  ds_read_b128 v[48:51], v16 offset:2560
  ds_read_b128 v[52:55], v16 offset:2576
  ds_read_b128 v[56:59], v16 offset:0
  s_branch WOVER_1
  .p2align 12
WARM_1:
  s_setpc_b64 s[94:95]
  s_nop 0
WOVER_1:
  ds_read_b128 v[60:63], v16 offset:16
  ds_read_b128 v[64:67], v16 offset:2816
  ds_read_b128 v[68:71], v16 offset:2832
  ds_read_b128 v[72:75], v16 offset:256
  ds_read_b128 v[76:79], v16 offset:272
  ds_read_b128 v[80:83], v16 offset:3072
  ds_read_b128 v[84:87], v16 offset:3088
  ds_read_b128 v[88:91], v16 offset:512
  ds_read_b128 v[92:95], v16 offset:528
  ds_read_b128 v[120:123], v16 offset:3328
  ds_read_b128 v[124:127], v16 offset:3344
  ds_read_b128 v[128:131], v16 offset:768
  ds_read_b128 v[132:135], v16 offset:784
  ds_read_b128 v[136:139], v16 offset:3584
  ds_read_b128 v[140:143], v16 offset:3600
  ds_read_b128 v[144:147], v16 offset:1024
  ds_read_b128 v[148:151], v16 offset:1040
  s_waitcnt lgkmcnt(15)
  v_pk_fma_f32 v[160:161], v[160:161], v[48:49], v[56:57]
  v_pk_fma_f32 v[162:163], v[162:163], v[50:51], v[58:59]
  v_pk_fma_f32 v[164:165], v[164:165], v[52:53], v[60:61]
  v_pk_fma_f32 v[166:167], v[166:167], v[54:55], v[62:63]
  v_cvt_pk_bf16_f32 v200, v160, v161
  v_cvt_pk_bf16_f32 v201, v162, v163
  v_cvt_pk_bf16_f32 v202, v164, v165
  v_cvt_pk_bf16_f32 v203, v166, v167
  buffer_store_dwordx4 v[200:203], v10, s[4:7], s31 offen offset:0 sc0 sc1
  s_waitcnt lgkmcnt(12)
  v_pk_fma_f32 v[168:169], v[168:169], v[64:65], v[72:73]
  v_pk_fma_f32 v[170:171], v[170:171], v[66:67], v[74:75]
  v_pk_fma_f32 v[172:173], v[172:173], v[68:69], v[76:77]
  v_pk_fma_f32 v[174:175], v[174:175], v[70:71], v[78:79]
  v_cvt_pk_bf16_f32 v204, v168, v169
  v_cvt_pk_bf16_f32 v205, v170, v171
  v_cvt_pk_bf16_f32 v206, v172, v173
  v_cvt_pk_bf16_f32 v207, v174, v175
  buffer_store_dwordx4 v[204:207], v10, s[4:7], s31 offen offset:2048 sc0 sc1
  s_add_u32 s31, s31, 4096
  s_waitcnt lgkmcnt(8)
  v_pk_fma_f32 v[176:177], v[176:177], v[80:81], v[88:89]
  v_pk_fma_f32 v[178:179], v[178:179], v[82:83], v[90:91]
  v_pk_fma_f32 v[180:181], v[180:181], v[84:85], v[92:93]
  v_pk_fma_f32 v[182:183], v[182:183], v[86:87], v[94:95]
  v_cvt_pk_bf16_f32 v208, v176, v177
  v_cvt_pk_bf16_f32 v209, v178, v179
  v_cvt_pk_bf16_f32 v210, v180, v181
  v_cvt_pk_bf16_f32 v211, v182, v183
  buffer_store_dwordx4 v[208:211], v10, s[4:7], s31 offen offset:0 sc0 sc1
  s_waitcnt lgkmcnt(4)
  v_pk_fma_f32 v[184:185], v[184:185], v[120:121], v[128:129]
  v_pk_fma_f32 v[186:187], v[186:187], v[122:123], v[130:131]
  v_pk_fma_f32 v[188:189], v[188:189], v[124:125], v[132:133]
  v_pk_fma_f32 v[190:191], v[190:191], v[126:127], v[134:135]
  v_cvt_pk_bf16_f32 v212, v184, v185
  v_cvt_pk_bf16_f32 v213, v186, v187
  v_cvt_pk_bf16_f32 v214, v188, v189
  v_cvt_pk_bf16_f32 v215, v190, v191
  buffer_store_dwordx4 v[212:215], v10, s[4:7], s31 offen offset:2048 sc0 sc1
  s_add_u32 s31, s31, 4096
  s_waitcnt lgkmcnt(0)
  v_pk_fma_f32 v[192:193], v[192:193], v[136:137], v[144:145]
  v_pk_fma_f32 v[194:195], v[194:195], v[138:139], v[146:147]
  v_pk_fma_f32 v[196:197], v[196:197], v[140:141], v[148:149]
  v_pk_fma_f32 v[198:199], v[198:199], v[142:143], v[150:151]
  v_cvt_pk_bf16_f32 v216, v192, v193
  v_cvt_pk_bf16_f32 v217, v194, v195
  v_cvt_pk_bf16_f32 v218, v196, v197
  v_cvt_pk_bf16_f32 v219, v198, v199
  buffer_store_dwordx4 v[216:219], v10, s[4:7], s31 offen offset:0 sc0 sc1
  s_cmp_lg_u32 s3, 1
  s_cbranch_scc1 P_HW
  s_mul_i32 s23, s17, 40
  s_add_u32 s24, s23, 39
  s_lshr_b32 s23, s23, 6
  s_lshr_b32 s24, s24, 6
  s_sub_u32 s24, s24, s23
  v_bfe_u32 v13, v1, 2, 1
  v_mul_u32_u24 v13, s24, v13
  v_add_u32 v13, s23, v13
  v_min_u32 v14, 2, v31
  v_mad_u32_u24 v13, v14, 10, v13
  v_and_b32 v14, 3, v1
  v_lshl_add_u32 v13, v13, 2, v14
  s_mul_i32 s23, s19, 80
  s_lshr_b32 s23, s23, 6
  s_lshl_b32 s23, s23, 3
  s_sub_u32 s23, s23, 48
  v_add_u32 v14, s23, v1
  v_cmp_gt_u32 vcc, 48, v1
  s_nop 1
  v_cndmask_b32_e64 v13, v14, v13, vcc
  v_lshlrev_b32 v13, 7, v13
  s_mov_b32 s26, 950272
  buffer_load_dword v251, v13, s[4:7], s26 offen sc1
  s_call_b64 s[94:95], EARLY_SETUP
  s_waitcnt vmcnt(4)
  s_barrier
  s_waitcnt vmcnt(3)
  v_cmp_eq_u32 vcc, s36, v251
  s_nop 0
  s_cmp_eq_u64 vcc, -1
  s_cbranch_scc1 P_H1F
  s_mov_b32 s27, 400000
  buffer_load_dword v250, v13, s[4:7], s26 offen sc1
POLL_3:
  s_waitcnt vmcnt(0)
  v_cmp_eq_u32 vcc, s36, v250
  s_nop 0
  s_cmp_eq_u64 vcc, -1
  s_cbranch_scc1 P_H1F
  s_sleep 2
  buffer_load_dword v250, v13, s[4:7], s26 offen sc1
  s_sub_u32 s27, s27, 1
  s_cmp_lg_u32 s27, 0
  s_cbranch_scc1 POLL_3
  s_branch P_H1F
P_HW:
  s_call_b64 s[94:95], EARLY_SETUP
  s_waitcnt vmcnt(3)
  s_barrier
  s_cmp_lg_u32 s3, 0
  s_cbranch_scc1 P_H1F
  v_mov_b32 v20, s36
  v_mov_b32 v21, s36
  v_mov_b32 v22, s36
  v_mov_b32 v23, s36
  s_mov_b64 exec, 0xff
  buffer_store_dwordx4 v[20:23], v2, s[4:7], s39 offen sc0 sc1
  s_mov_b64 exec, -1
P_H1F:
  s_cmp_lg_u32 s3, 3
  s_cbranch_scc1 P_MFN
  s_cmp_lt_u32 s20, 116
  s_cbranch_scc1 P_MFN
  s_sub_u32 s30, s20, 116
  s_lshl_b32 s62, s30, 7
  s_add_u32 s62, s62, 917504
  s_mul_i32 s22, s30, 640
  s_add_u32 s22, s22, 5120
  s_cmp_lt_u32 s30, 4
  s_cselect_b32 s23, 0, 5120
  s_cmp_lt_u32 s30, 8
  s_cselect_b32 s23, s23, 0
  s_cselect_b32 s25, 0, 1.0
  s_add_u32 s22, s22, s23
  s_add_u32 s23, s22, 65536
  v_cmp_gt_u32 vcc, 40, v1
  v_and_b32 v18, 0x30, v2
  s_nop 0
  v_cndmask_b32_e64 v19, v18, v2, vcc
  s_mov_b32 s24, s22
  buffer_load_dwordx4 v[80:83], v19, s[4:7], s24 offen sc1
  s_add_u32 s24, s24, 15360
  buffer_load_dwordx4 v[84:87], v19, s[4:7], s24 offen sc1
  s_add_u32 s24, s24, 15360
  buffer_load_dwordx4 v[88:91], v19, s[4:7], s24 offen sc1
  s_add_u32 s24, s24, 15360
  buffer_load_dwordx4 v[92:95], v19, s[4:7], s24 offen sc1
  s_add_u32 s24, s24, 15360
P_MFN:
  s_mul_i32 s48, s17, 153600
  s_add_u32 s48, s48, 4194304
  s_lshl_b32 s50, s3, 11
  v_add_u32 v10, s50, v2
  v_lshrrev_b32 v22, 4, v1
  v_and_b32 v23, 7, v1
  v_lshlrev_b32 v22, 7, v22
  v_lshl_add_u32 v22, v23, 4, v22
  v_add_u32 v22, 6144, v22
  s_cmp_eq_u32 s3, 3
  s_cselect_b64 vcc, -1, 0
  s_cselect_b32 s80, 0x00ff00ff, -1
  s_mov_b32 s81, s80
  v_cndmask_b32_e64 v11, v10, v22, vcc
  s_barrier
  s_add_u32 m0, s50, 0
  s_nop 0
  buffer_load_dwordx4 v10, s[4:7], s48 offen sc1 lds
  s_mov_b64 exec, s[80:81]
  buffer_load_dwordx4 v11, s[4:7], s48 offen offset:1024 sc1 lds
  s_mov_b64 exec, -1
  s_add_u32 s48, s48, 7680
  s_add_u32 m0, s50, 8192
  s_nop 0
  buffer_load_dwordx4 v10, s[4:7], s48 offen sc1 lds
  s_mov_b64 exec, s[80:81]
  buffer_load_dwordx4 v11, s[4:7], s48 offen offset:1024 sc1 lds
  s_mov_b64 exec, -1
  s_add_u32 s48, s48, 7680
  s_add_u32 m0, s50, 16384
  s_nop 0
  buffer_load_dwordx4 v10, s[4:7], s48 offen sc1 lds
  s_mov_b64 exec, s[80:81]
  buffer_load_dwordx4 v11, s[4:7], s48 offen offset:1024 sc1 lds
  s_mov_b64 exec, -1
  s_add_u32 s48, s48, 7680
  s_add_u32 m0, s50, 24576
  s_nop 0
  buffer_load_dwordx4 v10, s[4:7], s48 offen sc1 lds
  s_mov_b64 exec, s[80:81]
  buffer_load_dwordx4 v11, s[4:7], s48 offen offset:1024 sc1 lds
  s_mov_b64 exec, -1
  s_add_u32 s48, s48, 7680
  s_add_u32 m0, s50, 32768
  s_nop 0
  buffer_load_dwordx4 v10, s[4:7], s48 offen sc1 lds
  s_mov_b64 exec, s[80:81]
  buffer_load_dwordx4 v11, s[4:7], s48 offen offset:1024 sc1 lds
  s_mov_b64 exec, -1
  s_add_u32 s48, s48, 7680
  s_add_u32 m0, s50, 40960
  s_nop 0
  buffer_load_dwordx4 v10, s[4:7], s48 offen sc1 lds
  s_mov_b64 exec, s[80:81]
  buffer_load_dwordx4 v11, s[4:7], s48 offen offset:1024 sc1 lds
  s_mov_b64 exec, -1
  s_add_u32 s48, s48, 7680
  s_add_u32 m0, s50, 49152
  s_nop 0
  buffer_load_dwordx4 v10, s[4:7], s48 offen sc1 lds
  s_mov_b64 exec, s[80:81]
  buffer_load_dwordx4 v11, s[4:7], s48 offen offset:1024 sc1 lds
  s_mov_b64 exec, -1
  s_add_u32 s48, s48, 7680
  s_add_u32 m0, s50, 57344
  s_nop 0
  buffer_load_dwordx4 v10, s[4:7], s48 offen sc1 lds
  s_mov_b64 exec, s[80:81]
  buffer_load_dwordx4 v11, s[4:7], s48 offen offset:1024 sc1 lds
  s_mov_b64 exec, -1
  s_add_u32 s48, s48, 7680
  s_cmp_eq_u32 s3, 0
  s_cbranch_scc1 P_POLL
  s_cmp_lg_u32 s3, 0
  s_cbranch_scc1 P_I10
  s_call_b64 s[94:95], WARM_5
  s_branch P_I1e
P_I10:
  s_cmp_lg_u32 s3, 1
  s_cbranch_scc1 P_I11
  s_call_b64 s[94:95], WARM_6
  s_branch P_I1e
P_I11:
  s_cmp_lg_u32 s3, 2
  s_cbranch_scc1 P_I12
  s_call_b64 s[94:95], WARM_7
  s_branch P_I1e
P_I12:
  s_call_b64 s[94:95], WARM_8
P_I1e:
  s_cmp_lg_u32 s3, 0
  s_cbranch_scc1 P_J20
  s_call_b64 s[94:95], WARM_9
  s_branch P_J2e
P_J20:
  s_cmp_lg_u32 s3, 1
  s_cbranch_scc1 P_J21
  s_call_b64 s[94:95], WARM_10
  s_branch P_J2e
P_J21:
  s_cmp_lg_u32 s3, 2
  s_cbranch_scc1 P_J22
  s_branch P_J2e
P_J22:
P_J2e:
  s_cmp_eq_u32 s62, 0
  s_cbranch_scc1 P_JOIN
  s_mov_b32 s27, 400000
  s_waitcnt vmcnt(16)
P_MFL:
  v_xor_b32 v29, v28, v80
  v_bitop3_b32 v29, v29, v28, v84 bitop3:0xf6
  v_bitop3_b32 v29, v29, v28, v88 bitop3:0xf6
  v_bitop3_b32 v29, v29, v28, v92 bitop3:0xf6
  v_and_b32 v29, 0xff, v29
  v_cmp_eq_u32 vcc, 0, v29
  s_nop 0
  s_cmp_eq_u64 vcc, -1
  s_cbranch_scc1 P_MFK
  s_sleep 4
  s_mov_b32 s24, s22
  buffer_load_dwordx4 v[80:83], v19, s[4:7], s24 offen sc1
  s_add_u32 s24, s24, 15360
  buffer_load_dwordx4 v[84:87], v19, s[4:7], s24 offen sc1
  s_add_u32 s24, s24, 15360
  buffer_load_dwordx4 v[88:91], v19, s[4:7], s24 offen sc1
  s_add_u32 s24, s24, 15360
  buffer_load_dwordx4 v[92:95], v19, s[4:7], s24 offen sc1
  s_add_u32 s24, s24, 15360
  s_waitcnt vmcnt(0)
  s_sub_u32 s27, s27, 1
  s_cmp_lg_u32 s27, 0
  s_cbranch_scc1 P_MFL
P_MFK:
  v_and_b32 v80, 0xffffff00, v80
  v_and_b32 v84, 0xffffff00, v84
  v_and_b32 v88, 0xffffff00, v88
  v_and_b32 v92, 0xffffff00, v92
  v_pk_add_f32 v[80:81], v[80:81], v[84:85]
  v_pk_add_f32 v[88:89], v[88:89], v[92:93]
  v_pk_add_f32 v[82:83], v[82:83], v[86:87]
  v_pk_add_f32 v[90:91], v[90:91], v[94:95]
  v_pk_add_f32 v[80:81], v[80:81], v[88:89]
  v_pk_add_f32 v[82:83], v[82:83], v[90:91]
  v_cvt_pk_bf16_f32 v84, v80, v81
  v_cvt_pk_bf16_f32 v85, v82, v83
  v_lshlrev_b32 v80, 16, v84
  v_and_b32 v81, 0xffff0000, v84
  v_lshlrev_b32 v82, 16, v85
  v_and_b32 v83, 0xffff0000, v85
  v_add_f32 v80, s25, v80
  v_add_f32 v81, s25, v81
  v_add_f32 v82, s25, v82
  v_add_f32 v83, s25, v83
  v_cvt_pk_bf16_f32 v84, v80, v81
  v_cvt_pk_bf16_f32 v85, v82, v83
  v_lshlrev_b32 v80, 16, v84
  v_and_b32 v81, 0xffff0000, v84
  v_lshlrev_b32 v82, 16, v85
  v_and_b32 v83, 0xffff0000, v85
  buffer_store_dwordx4 v[80:83], v19, s[4:7], s23 offen sc0 sc1
  s_branch P_JOIN
EARLY_SETUP:
  s_lshl_b32 s22, s16, 3
  s_lshl_b32 s49, s3, 1
  s_add_u32 s49, s49, s22
  s_mul_i32 s46, s49, 20480
  s_add_u32 s46, s46, 1048576
  s_max_u32 s22, s22, 1
  s_sub_u32 s22, s22, 1
  s_mul_i32 s47, s22, 20480
  s_lshl_b32 s22, s3, 10
  s_add_u32 s47, s47, s22
  s_add_u32 s47, s47, 1048576
  s_lshl_b32 s51, s3, 13
  s_mov_b32 s82, 0xff00ff00
  s_mov_b32 s83, s82
  v_add_u32 v120, 20480, v2
  s_mov_b32 s40, 0
  s_mov_b32 s41, 0x00ff00ff
  s_mov_b32 s42, 0xffff
  s_mov_b32 s43, 0
  v_and_b32 v132, 15, v1
  v_lshrrev_b32 v133, 4, v1
  v_lshlrev_b32 v133, 2, v133
  v_sub_u32 v132, v132, v133
  v_cndmask_b32 v133, 0, 16, s[40:41]
  v_add_u32 v132, v132, v133
  v_mov_b32 v134, 4048155338
  v_subrev_u32 v133, 0, v132
  v_cmp_lt_u32 vcc, 7, v133
  s_nop 1
  v_cndmask_b32_e64 v124, 0, v134, vcc
  v_subrev_u32 v133, 1, v132
  v_cmp_lt_u32 vcc, 7, v133
  s_nop 1
  v_cndmask_b32_e64 v125, 0, v134, vcc
  v_subrev_u32 v133, 2, v132
  v_cmp_lt_u32 vcc, 7, v133
  s_nop 1
  v_cndmask_b32_e64 v126, 0, v134, vcc
  v_subrev_u32 v133, 3, v132
  v_cmp_lt_u32 vcc, 7, v133
  s_nop 1
  v_cndmask_b32_e64 v127, 0, v134, vcc
  s_and_b32 s22, s49, 63
  s_cmp_eq_u32 s22, 0
  s_cselect_b64 vcc, s[40:41], 0
  v_cndmask_b32_e64 v128, v124, v134, vcc
  v_cndmask_b32_e64 v129, v125, v134, vcc
  v_cndmask_b32_e64 v130, v126, v134, vcc
  v_cndmask_b32_e64 v131, v127, v134, vcc
  s_mul_i32 s58, s19, 102400
  s_add_u32 s58, s58, 7340032
  s_mul_i32 s59, s17, 258048
  s_add_u32 s59, s59, 8388608
  s_mul_i32 s60, s19, 245760
  s_add_u32 s60, s60, 12582912
  s_lshl_b32 s54, s18, 2
  s_add_u32 s54, s54, s3
  s_lshr_b32 s57, s54, 1
  s_and_b32 s22, s54, 63
  s_lshl_b32 s22, s22, 5
  s_lshr_b32 s23, s54, 6
  s_add_u32 s22, s22, s23
  s_mul_i32 s53, s22, 1280
  s_mul_i32 s22, s19, 160
  s_add_u32 s53, s53, s22
  v_and_b32 v138, 15, v1
  v_lshrrev_b32 v139, 4, v1
  v_mul_u32_u24 v136, 2560, v138
  v_lshl_add_u32 v137, v139, 3, v136
  v_lshl_add_u32 v136, v139, 4, v136
  v_lshlrev_b32 v140, 5, v139
  v_lshlrev_b32 v141, 4, v139
  s_mul_i32 s22, s17, 96
  s_lshr_b32 s22, s22, 6
  v_bfe_u32 v216, v1, 3, 1
  v_add_u32 v216, s22, v216
  v_bfe_u32 v217, v1, 4, 1
  v_mad_u32_u24 v216, v217, 24, v216
  v_and_b32 v218, 7, v1
  v_mad_u32_u24 v216, v218, 48, v216
  v_mul_u32_u24 v218, 683, v216
  v_lshrrev_b32 v218, 11, v218
  v_add_u32 v216, v216, v218
  v_add_u32 v216, 512, v216
  s_lshr_b32 s22, s19, 1
  v_and_b32 v219, 0x12, v1
  v_cmp_eq_u32 vcc, 2, v219
  s_nop 1
  v_cndmask_b32_e64 v219, v217, 2, vcc
  v_lshl_add_u32 v219, v219, 2, s22
  v_cmp_lt_u32 vcc, 31, v1
  s_nop 1
  v_cndmask_b32_e64 v216, v216, v219, vcc
  v_lshlrev_b32 v216, 7, v216
  s_mul_i32 s52, s49, 20480
  s_mul_i32 s22, s17, 1280
  s_add_u32 s52, s52, s22
  s_add_u32 s52, s52, 14680064
  s_mul_i32 s22, s3, 3072
  v_lshrrev_b32 v134, 1, v2
  s_add_u32 s22, s22, 0x10000
  v_add_u32 v218, s22, v134
  s_max_u32 s22, s3, 1
  s_lshl_b32 s23, s22, 9
  s_add_u32 s23, s23, 65024
  v_add_u32 v215, s23, v134
  s_cmp_eq_u32 s3, 3
  s_cselect_b32 s24, 256, 0
  v_xor_b32 v217, s24, v215
  s_lshl_b32 s22, s22, 10
  v_add_u32 v212, s22, v2
  v_add_u32 v213, s22, v3
  v_add_u32 v214, s22, v4
  v_lshlrev_b32 v219, 4, v138
  v_mul_u32_u24 v134, 20480, v139
  v_add_u32 v219, v219, v134
  v_cmp_lt_u32 vcc, 31, v1
  v_mov_b32 v133, 1073741824
  s_nop 0
  v_cndmask_b32_e64 v219, v219, v133, vcc
  s_mul_i32 s22, s2, 171
  s_lshr_b32 s22, s22, 12
  s_mul_i32 s23, s22, 24
  s_sub_u32 s23, s2, s23
  s_lshl_b32 s23, s23, 1
  s_lshr_b32 s24, s3, 1
  s_add_u32 s23, s23, s24
  s_and_b32 s24, s3, 1
  s_lshl_b32 s25, s22, 6
  v_mov_b32 v200, v124
  v_mov_b32 v201, v125
  v_mov_b32 v202, v126
  v_mov_b32 v203, v127
  v_add_u32 v122, s25, v1
  v_min_u32 v122, 639, v122
  v_mul_u32_u24 v124, 205, v122
  v_lshrrev_b32 v124, 14, v124
  v_mul_u32_u24 v125, 80, v124
  v_sub_u32 v125, v122, v125
  v_mul_u32_u24 v123, 245760, v124
  v_lshrrev_b32 v126, 5, v125
  v_lshlrev_b32 v126, 11, v126
  v_add_u32 v123, v123, v126
  v_bfe_u32 v126, v125, 2, 1
  v_lshlrev_b32 v126, 10, v126
  v_bfe_u32 v127, v125, 3, 2
  v_lshl_add_u32 v126, v127, 6, v126
  v_and_b32 v127, 3, v125
  v_lshl_add_u32 v126, v127, 4, v126
  v_and_b32 v127, 15, v125
  v_lshlrev_b32 v127, 4, v127
  v_cmp_gt_u32 vcc, 64, v125
  s_nop 1
  v_cndmask_b32_e64 v126, v127, v126, vcc
  v_add_u32 v123, v123, v126
  v_add_u32 v123, 12582912, v123
  s_mul_i32 s25, s23, 86
  s_lshr_b32 s25, s25, 8
  s_mul_i32 s27, s25, 3
  s_sub_u32 s27, s23, s27
  s_lshl_b32 s27, s27, 4
  s_add_u32 s23, s27, s25
  s_mul_i32 s79, s23, 5120
  s_lshl_b32 s24, s24, 9
  s_add_u32 s79, s79, s24
  s_cmp_lt_u32 s2, 240
  s_cselect_b32 s79, s79, 1073741824
  v_mov_b32 v209, v123
  v_mov_b32 v124, v200
  v_mov_b32 v125, v201
  v_mov_b32 v126, v202
  v_mov_b32 v127, v203
  v_bfe_u32 v210, v1, 2, 2
  v_lshlrev_b32 v210, 7, v210
  v_lshl_add_u32 v210, v139, 5, v210
  v_and_b32 v134, 3, v1
  v_lshl_add_u32 v210, v134, 3, v210
  s_lshl_b32 s55, s3, 11
  s_add_u32 s55, s55, 122880
  v_add_u32 v210, s55, v210
  buffer_load_dwordx4 v[240:243], v136, s[8:11], s53 offen
  buffer_load_dwordx4 v[244:247], v136, s[8:11], s53 offen offset:64
  buffer_load_dwordx2 v[248:249], v137, s[8:11], s53 offen offset:128
  v_add_u32 v208, s55, v2
  v_accvgpr_write_b32 a200, v120
  v_accvgpr_write_b32 a201, v124
  v_accvgpr_write_b32 a202, v125
  v_accvgpr_write_b32 a203, v126
  v_accvgpr_write_b32 a204, v127
  v_accvgpr_write_b32 a205, v128
  v_accvgpr_write_b32 a206, v129
  v_accvgpr_write_b32 a207, v130
  v_accvgpr_write_b32 a208, v131
  v_accvgpr_write_b32 a209, v136
  v_accvgpr_write_b32 a210, v137
  v_accvgpr_write_b32 a211, v138
  v_accvgpr_write_b32 a212, v139
  v_accvgpr_write_b32 a213, v140
  v_accvgpr_write_b32 a214, v141
  v_accvgpr_write_b32 a215, v208
  v_accvgpr_write_b32 a216, v209
  v_accvgpr_write_b32 a217, v210
  v_accvgpr_write_b32 a218, v212
  v_accvgpr_write_b32 a219, v213
  v_accvgpr_write_b32 a220, v214
  v_accvgpr_write_b32 a221, v215
  v_accvgpr_write_b32 a222, v216
  v_accvgpr_write_b32 a223, v217
  v_accvgpr_write_b32 a224, v218
  v_accvgpr_write_b32 a225, v219
  s_setpc_b64 s[94:95]
P_RE:
  v_mov_b32 v253, 0
  s_mul_i32 s100, s3, 15360
  s_add_u32 s100, s100, 81920
  s_lshr_b32 s101, s20, 2
  s_and_b32 s24, s20, 3
  s_lshl_b32 s24, s24, 2
  s_add_u32 s24, s24, s3
  s_mul_i32 s24, s24, 5
  s_mul_i32 s22, s24, 30720
  s_lshl_b32 s23, s101, 7
  s_add_u32 s22, s22, s23
  s_cmp_lt_u32 s20, 120
  s_cselect_b32 s22, s22, 1073741824
  v_mul_u32_u24 v10, 3840, v31
  v_lshl_add_u32 v10, v30, 4, v10
  s_mov_b32 s98, s24
  s_waitcnt lgkmcnt(0)
  s_mov_b32 s88, s66
  s_mov_b32 s89, s67
  s_mov_b32 s90, 2457600
  s_mov_b32 s91, 0x20000
  s_add_u32 m0, s100, 0
  s_nop 0
  buffer_load_dwordx4 v10, s[88:91], s22 offen nt lds
  s_add_u32 s22, s22, 30720
  s_add_u32 m0, s100, 1024
  s_nop 0
  buffer_load_dwordx4 v10, s[88:91], s22 offen nt lds
  s_add_u32 s22, s22, 30720
  s_add_u32 m0, s100, 2048
  s_nop 0
  buffer_load_dwordx4 v10, s[88:91], s22 offen nt lds
  s_add_u32 s22, s22, 30720
  s_add_u32 m0, s100, 3072
  s_nop 0
  buffer_load_dwordx4 v10, s[88:91], s22 offen nt lds
  s_add_u32 s22, s22, 30720
  s_add_u32 m0, s100, 4096
  s_nop 0
  buffer_load_dwordx4 v10, s[88:91], s22 offen nt lds
  s_add_u32 s22, s22, 30720
  global_load_dword v19, v20, s[84:85] sc1
  s_cmp_eq_u32 s3, 3
  s_cbranch_scc1 P_RO
  s_mul_i32 s30, s20, 3
  s_add_u32 s30, s30, s3
  s_mul_i32 s31, s30, 1366
  s_lshr_b32 s23, s31, 16
  s_mul_i32 s31, s23, 48
  s_sub_u32 s31, s30, s31
  s_mov_b32 s30, s23
  s_cmp_ge_u32 s31, 24
  s_cselect_b32 s88, s74, s72
  s_cselect_b32 s89, s75, s73
  s_cselect_b32 s22, 24, 0
  s_cselect_b32 s61, 2048, 0
  s_mov_b32 s90, 1966080
  s_mov_b32 s91, 0x20000
  s_sub_u32 s31, s31, s22
  s_mul_i32 s99, s30, 10
  s_mul_i32 s22, s99, 24576
  s_lshl_b32 s23, s31, 7
  s_add_u32 s22, s22, s23
  v_mul_u32_u24 v10, 3072, v31
  v_lshl_add_u32 v10, v30, 4, v10
  s_mov_b32 s37, s22
  v_mov_b32 v9, v10
  s_branch P_RC
P_RO:
  s_lshr_b32 s30, s20, 3
  s_and_b32 s31, s20, 7
  s_mov_b32 s88, s68
  s_mov_b32 s89, s69
  s_mov_b32 s90, 819200
  s_mov_b32 s91, 0x20000
  s_mul_i32 s22, s31, 102400
  s_lshl_b32 s23, s30, 7
  s_add_u32 s22, s22, s23
  s_cmp_lt_u32 s20, 80
  s_cselect_b32 s22, s22, 1073741824
  s_mul_i32 s99, s31, 10
  v_and_b32 v10, 3, v31
  v_lshrrev_b32 v11, 2, v31
  v_lshl_add_u32 v10, v11, 4, v10
  v_mul_u32_u24 v10, 1280, v10
  v_lshl_add_u32 v10, v30, 4, v10
  v_mul_u32_u24 v11, 1280, v31
  v_lshl_add_u32 v11, v30, 4, v11
  s_add_u32 m0, s100, 5120
  s_nop 0
  buffer_load_dwordx4 v10, s[88:91], s22 offen nt lds
  s_add_u32 s22, s22, 5120
  s_add_u32 m0, s100, 6144
  s_nop 0
  buffer_load_dwordx4 v10, s[88:91], s22 offen nt lds
  s_add_u32 s22, s22, 5120
  s_add_u32 m0, s100, 7168
  s_nop 0
  buffer_load_dwordx4 v10, s[88:91], s22 offen nt lds
  s_add_u32 s22, s22, 5120
  s_add_u32 m0, s100, 8192
  s_nop 0
  buffer_load_dwordx4 v10, s[88:91], s22 offen nt lds
  s_add_u32 s22, s22, 5120
  s_add_u32 s22, s22, 20480
  s_add_u32 m0, s100, 9216
  s_nop 0
  buffer_load_dwordx4 v11, s[88:91], s22 offen nt lds
  s_add_u32 s22, s22, 10240
  s_add_u32 m0, s100, 10240
  s_nop 0
  buffer_load_dwordx4 v10, s[88:91], s22 offen nt lds
  s_add_u32 s22, s22, 5120
  s_add_u32 m0, s100, 11264
  s_nop 0
  buffer_load_dwordx4 v10, s[88:91], s22 offen nt lds
  s_add_u32 s22, s22, 5120
  s_add_u32 m0, s100, 12288
  s_nop 0
  buffer_load_dwordx4 v10, s[88:91], s22 offen nt lds
  s_add_u32 s22, s22, 5120
  s_add_u32 m0, s100, 13312
  s_nop 0
  buffer_load_dwordx4 v10, s[88:91], s22 offen nt lds
  s_add_u32 s22, s22, 5120
  s_add_u32 s22, s22, 20480
  s_add_u32 m0, s100, 14336
  s_nop 0
  buffer_load_dwordx4 v11, s[88:91], s22 offen nt lds
  s_add_u32 s22, s22, 10240
  s_lshl_b32 s22, s30, 6
  v_add_u32 v10, s22, v1
  v_min_u32 v10, 639, v10
  v_mul_u32_u24 v12, 205, v10
  v_lshrrev_b32 v12, 14, v12
  v_mul_u32_u24 v13, 80, v12
  v_sub_u32 v13, v10, v13
  v_mul_u32_u24 v11, 102400, v12
  v_lshrrev_b32 v14, 5, v13
  v_lshlrev_b32 v14, 11, v14
  v_add_u32 v11, v11, v14
  v_bfe_u32 v14, v13, 2, 1
  v_lshlrev_b32 v14, 10, v14
  v_bfe_u32 v15, v13, 3, 2
  v_lshl_add_u32 v14, v15, 6, v14
  v_and_b32 v15, 3, v13
  v_lshl_add_u32 v14, v15, 4, v14
  v_and_b32 v15, 15, v13
  v_lshlrev_b32 v15, 4, v15
  v_cmp_gt_u32 vcc, 64, v13
  s_nop 1
  v_cndmask_b32_e64 v14, v15, v14, vcc
  v_add_u32 v11, v11, v14
  v_add_u32 v11, 7340032, v11
  s_cmp_lt_u32 s20, 80
  s_cselect_b32 s22, 0, 1073741824
  v_add_u32 v9, s22, v11
P_RC:
  v_bfe_u32 v17, v1, 2, 2
  v_lshlrev_b32 v17, 7, v17
  v_lshrrev_b32 v18, 4, v1
  v_lshl_add_u32 v17, v18, 5, v17
  v_and_b32 v18, 3, v1
  s_branch WOVER_2
  .p2align 12
WARM_2:
  s_setpc_b64 s[94:95]
  s_nop 0
WOVER_2:
  v_lshl_add_u32 v17, v18, 3, v17
  v_add_u32 v17, s100, v17
  s_mul_i32 s24, s101, 26
  s_lshr_b32 s24, s24, 8
  s_mul_i32 s22, s24, 10
  s_sub_u32 s22, s101, s22
  s_lshl_b32 s22, s22, 6
  v_add_u32 v10, s22, v1
  v_mul_u32_u24 v12, 205, v10
  v_lshrrev_b32 v12, 13, v12
  v_mul_u32_u24 v13, 40, v12
  v_sub_u32 v13, v10, v13
  v_mul_u32_u24 v18, 153600, v12
  s_cmp_eq_u32 s24, 1
  s_cselect_b32 s22, 2048, 0
  s_cselect_b32 s23, 128, 0
  s_add_u32 s23, s23, 4096
  s_mov_b32 s25, 256
  s_cmp_eq_u32 s24, 2
  s_cselect_b32 s22, 5120, s22
  s_cselect_b32 s23, 7168, s23
  s_cselect_b32 s25, 128, s25
  v_lshrrev_b32 v14, 4, v13
  v_lshlrev_b32 v14, 10, v14
  v_add_u32 v14, s22, v14
  v_mov_b32 v15, s23
  v_cmp_gt_u32 vcc, 32, v13
  v_mov_b32 v8, s25
  v_mov_b32 v10, 256
  v_cndmask_b32_e64 v14, v15, v14, vcc
  v_cndmask_b32_e64 v8, v8, v10, vcc
  v_and_b32 v15, 15, v13
  v_lshl_add_u32 v14, v15, 4, v14
  v_add_u32 v18, v18, v14
  s_cmp_lt_u32 s20, 120
  s_cselect_b32 s22, 4194304, 0
  s_cselect_b32 s23, 0, 1073741824
  s_add_u32 s22, s22, s23
  v_add_u32 v18, s22, v18
  s_waitcnt vmcnt(0)
  ds_read_b64_tr_b16 v[176:177], v17 offset:0
  ds_read_b64_tr_b16 v[178:179], v17 offset:512
  ds_read_b64_tr_b16 v[180:181], v17 offset:1024
  ds_read_b64_tr_b16 v[182:183], v17 offset:1536
  ds_read_b64_tr_b16 v[184:185], v17 offset:2048
  ds_read_b64_tr_b16 v[186:187], v17 offset:2560
  ds_read_b64_tr_b16 v[188:189], v17 offset:3072
  ds_read_b64_tr_b16 v[190:191], v17 offset:3584
  ds_read_b64_tr_b16 v[192:193], v17 offset:4096
  ds_read_b64_tr_b16 v[194:195], v17 offset:4608
  s_add_u32 s22, s98, 0
  s_lshr_b32 s23, s22, 2
  s_mul_i32 s23, s23, 7680
  s_and_b32 s22, s22, 3
  v_mad_u32_u24 v16, v8, s22, v18
  s_waitcnt lgkmcnt(8)
  buffer_store_dwordx4 v[176:179], v16, s[4:7], s23 offen sc0 sc1
  s_add_u32 s22, s98, 1
  s_lshr_b32 s23, s22, 2
  s_mul_i32 s23, s23, 7680
  s_and_b32 s22, s22, 3
  v_mad_u32_u24 v16, v8, s22, v18
  s_waitcnt lgkmcnt(6)
  buffer_store_dwordx4 v[180:183], v16, s[4:7], s23 offen sc0 sc1
  s_add_u32 s22, s98, 2
  s_lshr_b32 s23, s22, 2
  s_mul_i32 s23, s23, 7680
  s_and_b32 s22, s22, 3
  v_mad_u32_u24 v16, v8, s22, v18
  s_waitcnt lgkmcnt(4)
  buffer_store_dwordx4 v[184:187], v16, s[4:7], s23 offen sc0 sc1
  s_add_u32 s22, s98, 3
  s_lshr_b32 s23, s22, 2
  s_mul_i32 s23, s23, 7680
  s_and_b32 s22, s22, 3
  v_mad_u32_u24 v16, v8, s22, v18
  s_waitcnt lgkmcnt(2)
  buffer_store_dwordx4 v[188:191], v16, s[4:7], s23 offen sc0 sc1
  s_add_u32 s22, s98, 4
  s_lshr_b32 s23, s22, 2
  s_mul_i32 s23, s23, 7680
  s_and_b32 s22, s22, 3
  v_mad_u32_u24 v16, v8, s22, v18
  s_waitcnt lgkmcnt(0)
  buffer_store_dwordx4 v[192:195], v16, s[4:7], s23 offen sc0 sc1
  s_cmp_lg_u32 s3, 3
  s_cbranch_scc1 P_RG
  ds_read_b64_tr_b16 v[32:33], v17 offset:5120
  ds_read_b64_tr_b16 v[34:35], v17 offset:5632
  ds_read_b64_tr_b16 v[36:37], v17 offset:6144
  ds_read_b64_tr_b16 v[38:39], v17 offset:6656
  ds_read_b64_tr_b16 v[40:41], v17 offset:7168
  ds_read_b64_tr_b16 v[42:43], v17 offset:7680
  ds_read_b64_tr_b16 v[44:45], v17 offset:8192
  ds_read_b64_tr_b16 v[46:47], v17 offset:8704
  ds_read_b64_tr_b16 v[48:49], v17 offset:9216
  ds_read_b64_tr_b16 v[50:51], v17 offset:9728
  ds_read_b64_tr_b16 v[52:53], v17 offset:10240
  ds_read_b64_tr_b16 v[54:55], v17 offset:10752
  ds_read_b64_tr_b16 v[56:57], v17 offset:11264
  ds_read_b64_tr_b16 v[58:59], v17 offset:11776
  ds_read_b64_tr_b16 v[60:61], v17 offset:12288
  ds_read_b64_tr_b16 v[62:63], v17 offset:12800
  ds_read_b64_tr_b16 v[64:65], v17 offset:13312
  ds_read_b64_tr_b16 v[66:67], v17 offset:13824
  ds_read_b64_tr_b16 v[68:69], v17 offset:14336
  ds_read_b64_tr_b16 v[70:71], v17 offset:14848
  s_add_u32 s22, s99, 0
  s_lshr_b32 s23, s22, 2
  s_mul_i32 s23, s23, 5120
  s_and_b32 s22, s22, 3
  s_lshl_b32 s22, s22, 8
  s_add_u32 s23, s23, s22
  s_waitcnt lgkmcnt(15)
  buffer_store_dwordx4 v[32:35], v9, s[4:7], s23 offen sc0 sc1
  s_add_u32 s22, s99, 1
  s_lshr_b32 s23, s22, 2
  s_mul_i32 s23, s23, 5120
  s_and_b32 s22, s22, 3
  s_lshl_b32 s22, s22, 8
  s_add_u32 s23, s23, s22
  s_waitcnt lgkmcnt(15)
  buffer_store_dwordx4 v[36:39], v9, s[4:7], s23 offen sc0 sc1
  s_add_u32 s22, s99, 2
  s_lshr_b32 s23, s22, 2
  s_mul_i32 s23, s23, 5120
  s_and_b32 s22, s22, 3
  s_lshl_b32 s22, s22, 8
  s_add_u32 s23, s23, s22
  s_waitcnt lgkmcnt(14)
  buffer_store_dwordx4 v[40:43], v9, s[4:7], s23 offen sc0 sc1
  s_add_u32 s22, s99, 3
  s_lshr_b32 s23, s22, 2
  s_mul_i32 s23, s23, 5120
  s_and_b32 s22, s22, 3
  s_lshl_b32 s22, s22, 8
  s_add_u32 s23, s23, s22
  s_waitcnt lgkmcnt(12)
  buffer_store_dwordx4 v[44:47], v9, s[4:7], s23 offen sc0 sc1
  s_add_u32 s22, s99, 4
  s_lshr_b32 s23, s22, 2
  s_mul_i32 s23, s23, 5120
  s_and_b32 s22, s22, 3
  s_lshl_b32 s22, s22, 8
  s_add_u32 s23, s23, s22
  s_waitcnt lgkmcnt(10)
  buffer_store_dwordx4 v[48:51], v9, s[4:7], s23 offen sc0 sc1
  s_add_u32 s22, s99, 5
  s_lshr_b32 s23, s22, 2
  s_mul_i32 s23, s23, 5120
  s_and_b32 s22, s22, 3
  s_lshl_b32 s22, s22, 8
  s_add_u32 s23, s23, s22
  s_waitcnt lgkmcnt(8)
  buffer_store_dwordx4 v[52:55], v9, s[4:7], s23 offen sc0 sc1
  s_add_u32 s22, s99, 6
  s_lshr_b32 s23, s22, 2
  s_mul_i32 s23, s23, 5120
  s_and_b32 s22, s22, 3
  s_lshl_b32 s22, s22, 8
  s_add_u32 s23, s23, s22
  s_waitcnt lgkmcnt(6)
  buffer_store_dwordx4 v[56:59], v9, s[4:7], s23 offen sc0 sc1
  s_add_u32 s22, s99, 7
  s_lshr_b32 s23, s22, 2
  s_mul_i32 s23, s23, 5120
  s_and_b32 s22, s22, 3
  s_lshl_b32 s22, s22, 8
  s_add_u32 s23, s23, s22
  s_waitcnt lgkmcnt(4)
  buffer_store_dwordx4 v[60:63], v9, s[4:7], s23 offen sc0 sc1
  s_add_u32 s22, s99, 8
  s_lshr_b32 s23, s22, 2
  s_mul_i32 s23, s23, 5120
  s_and_b32 s22, s22, 3
  s_lshl_b32 s22, s22, 8
  s_add_u32 s23, s23, s22
  s_waitcnt lgkmcnt(2)
  buffer_store_dwordx4 v[64:67], v9, s[4:7], s23 offen sc0 sc1
  s_add_u32 s22, s99, 9
  s_lshr_b32 s23, s22, 2
  s_mul_i32 s23, s23, 5120
  s_and_b32 s22, s22, 3
  s_lshl_b32 s22, s22, 8
  s_add_u32 s23, s23, s22
  s_waitcnt lgkmcnt(0)
  buffer_store_dwordx4 v[68:71], v9, s[4:7], s23 offen sc0 sc1
  s_barrier
  s_mov_b32 s27, 400000
P_NPD:
  v_readfirstlane_b32 s22, v19
  s_sub_u32 s27, s27, 1
  s_cmp_eq_u32 s27, 0
  s_cbranch_scc1 P_NOKD
  s_cmp_eq_u32 s22, 0
  s_cbranch_scc1 P_NRD
  s_sub_u32 s23, s38, s22
  s_add_u32 s23, s23, 2000
  s_cmp_lt_u32 s23, 4000
  s_cbranch_scc1 P_NOKD
  s_cmp_lt_u32 s27, 399936
  s_cbranch_scc1 P_NOKD
P_NRD:
  global_load_dword v19, v20, s[84:85] sc1
  s_waitcnt vmcnt(0)
  s_branch P_NPD
P_NOKD:
  s_mul_i32 s22, s22, 0x9e3779b1
  s_lshr_b32 s23, s22, 15
  s_xor_b32 s22, s22, s23
  s_mul_i32 s22, s22, 0x85ebca6b
  s_max_u32 s36, s22, 1
  s_lshl_b32 s39, s20, 7
  s_add_u32 s39, s39, 950272
  s_waitcnt vmcnt(0)
  s_barrier
  v_mov_b32 v20, s36
  v_mov_b32 v21, s36
  v_mov_b32 v22, s36
  v_mov_b32 v23, s36
  s_mov_b64 exec, 0xff
  buffer_store_dwordx4 v[20:23], v2, s[4:7], s39 offen sc0 sc1
  s_mov_b64 exec, -1
  s_branch P_RH
P_RG:
  s_barrier
  s_add_u32 m0, s100, 5120
  s_nop 0
  buffer_load_dwordx4 v9, s[88:91], s37 offen nt lds
  s_add_u32 s37, s37, 24576
  s_add_u32 m0, s100, 6144
  s_nop 0
  buffer_load_dwordx4 v9, s[88:91], s37 offen nt lds
  s_add_u32 s37, s37, 24576
  s_add_u32 m0, s100, 7168
  s_nop 0
  buffer_load_dwordx4 v9, s[88:91], s37 offen nt lds
  s_add_u32 s37, s37, 24576
  s_add_u32 m0, s100, 8192
  s_nop 0
  buffer_load_dwordx4 v9, s[88:91], s37 offen nt lds
  s_add_u32 s37, s37, 24576
  s_add_u32 m0, s100, 9216
  s_nop 0
  buffer_load_dwordx4 v9, s[88:91], s37 offen nt lds
  s_add_u32 s37, s37, 24576
  s_add_u32 m0, s100, 10240
  s_nop 0
  buffer_load_dwordx4 v9, s[88:91], s37 offen nt lds
  s_add_u32 s37, s37, 24576
  s_add_u32 m0, s100, 11264
  s_nop 0
  buffer_load_dwordx4 v9, s[88:91], s37 offen nt lds
  s_add_u32 s37, s37, 24576
  s_add_u32 m0, s100, 12288
  s_nop 0
  buffer_load_dwordx4 v9, s[88:91], s37 offen nt lds
  s_add_u32 s37, s37, 24576
  s_add_u32 m0, s100, 13312
  s_nop 0
  buffer_load_dwordx4 v9, s[88:91], s37 offen nt lds
  s_add_u32 s37, s37, 24576
  s_add_u32 m0, s100, 14336
  s_nop 0
  buffer_load_dwordx4 v9, s[88:91], s37 offen nt lds
  s_add_u32 s37, s37, 24576
  s_waitcnt vmcnt(10)
  s_barrier
  s_mov_b32 s27, 400000
P_NPG:
  v_readfirstlane_b32 s22, v19
  s_sub_u32 s27, s27, 1
  s_cmp_eq_u32 s27, 0
  s_cbranch_scc1 P_NOKG
  s_cmp_eq_u32 s22, 0
  s_cbranch_scc1 P_NRG
  s_sub_u32 s23, s38, s22
  s_add_u32 s23, s23, 2000
  s_cmp_lt_u32 s23, 4000
  s_cbranch_scc1 P_NOKG
  s_cmp_lt_u32 s27, 399936
  s_cbranch_scc1 P_NOKG
P_NRG:
  global_load_dword v19, v20, s[84:85] sc1
  s_waitcnt vmcnt(0)
  s_branch P_NPG
P_NOKG:
  s_mul_i32 s22, s22, 0x9e3779b1
  s_lshr_b32 s23, s22, 15
  s_xor_b32 s22, s22, s23
  s_mul_i32 s22, s22, 0x85ebca6b
  s_max_u32 s36, s22, 1
P_RH:
  s_mul_i32 s22, s2, 171
  s_lshr_b32 s22, s22, 12
  s_mul_i32 s23, s22, 24
  s_sub_u32 s23, s2, s23
  s_lshl_b32 s23, s23, 2
  s_add_u32 s23, s23, s3
  s_mul_i32 s23, s23, 20480
  s_lshl_b32 s22, s22, 7
  s_add_u32 s22, s22, s23
  s_cmp_lt_u32 s2, 240
  s_cselect_b32 s22, s22, 1073741824
  s_add_u32 s23, s22, 10240
  v_mul_u32_u24 v21, 1280, v31
  v_lshl_add_u32 v21, v30, 4, v21
  s_mov_b32 s32, s76
  s_mov_b32 s33, s77
  s_mov_b32 s34, 1966080
  s_mov_b32 s35, 0x20000
  buffer_load_dwordx4 a[240:243], v21, s[32:35], s22 offen nt
  buffer_load_dwordx4 a[244:247], v21, s[32:35], s23 offen nt
  v_mov_b32 v7, 0
  v_mov_b32 v9, 0
  s_mov_b32 s63, 0
  s_mov_b32 s62, 0
  s_mov_b32 s52, 0xff
  v_add_u32 v3, 0x10000, v2
  v_add_u32 v4, 0x20000, v2
  s_and_b32 s22, s2, 7
  s_lshr_b32 s23, s2, 3
  s_lshr_b32 s24, s23, 3
  s_and_b32 s19, s23, 7
  s_lshl_b32 s18, s22, 2
  s_add_u32 s18, s18, s24
  s_lshr_b32 s16, s22, 1
  s_lshl_b32 s16, s16, 2
  s_add_u32 s16, s16, s24
  s_and_b32 s17, s22, 1
  s_lshl_b32 s17, s17, 3
  s_add_u32 s17, s17, s19
  s_lshl_b32 s44, s3, 12
  v_add_u32 v5, s44, v2
  s_lshl_b32 s45, s3, 10
  s_add_u32 s45, s45, 16384
  v_add_u32 v6, s45, v2
  s_mov_b32 s12, s82
  s_mov_b32 s13, s83
  s_mov_b32 s14, 2621440
  s_mov_b32 s15, 0x20000
  s_lshl_b32 s62, s20, 2
  s_add_u32 s62, s62, s3
  s_lshl_b32 s62, s62, 7
  s_add_u32 s62, s62, 983040
  s_mov_b32 s53, s62
  s_cmp_eq_u32 s3, 3
  s_cselect_b32 s62, 0, s62
  v_mov_b32 v24, 0
  v_mov_b32 v25, 0
  v_mov_b32 v26, 0
  v_mov_b32 v27, 0
  s_lshl_b32 s46, s16, 2
  s_add_u32 s46, s46, s3
  s_lshl_b32 s46, s46, 4
  s_add_u32 s46, s46, s17
  s_lshl_b32 s46, s46, 7
  s_add_u32 s46, s46, 229376
  s_lshl_b32 s47, s18, 2
  s_add_u32 s47, s47, s3
  s_lshl_b32 s47, s47, 3
  s_add_u32 s47, s47, s19
  s_lshl_b32 s47, s47, 7
  s_add_u32 s47, s47, 753664
  v_lshlrev_b32 v22, 17, v31
  v_lshl_add_u32 v22, v30, 4, v22
  s_mov_b64 exec, 0xffffffff
  buffer_store_dwordx4 v[24:27], v22, s[4:7], s46 offen sc0 sc1
  s_mov_b64 exec, 0xff
  buffer_store_dwordx4 v[24:27], v2, s[4:7], s47 offen sc0 sc1
  buffer_store_dwordx4 v[24:27], v2, s[4:7], s53 offen sc0 sc1
  s_mov_b32 exec_lo, s52
  buffer_store_dwordx4 v[24:27], v2, s[4:7], s53 offen sc0 sc1
  s_mov_b64 exec, -1
  s_cmp_lg_u32 s3, 0
  s_cbranch_scc1 P_R00
  s_call_b64 s[94:95], WARM_1
  s_branch P_R0e
P_R00:
  s_cmp_lg_u32 s3, 1
  s_cbranch_scc1 P_R01
  s_call_b64 s[94:95], WARM_2
  s_branch P_R0e
P_R01:
  s_cmp_lg_u32 s3, 2
  s_cbranch_scc1 P_R02
  s_call_b64 s[94:95], WARM_3
  s_branch P_R0e
P_R02:
  s_call_b64 s[94:95], WARM_4
P_R0e:
  s_cmp_eq_u32 s3, 3
  s_cbranch_scc1 P_W3
  s_lshl_b32 s23, s31, 6
  v_add_u32 v10, s23, v1
  v_mul_u32_u24 v12, 683, v10
  v_lshrrev_b32 v12, 16, v12
  v_mul_u32_u24 v13, 96, v12
  v_sub_u32 v13, v10, v13
  v_lshrrev_b32 v14, 5, v13
  v_mad_u32_u24 v16, v12, 3, v14
  v_mul_u32_u24 v11, 86016, v16
  v_bfe_u32 v14, v13, 2, 1
  v_lshlrev_b32 v14, 10, v14
  v_bfe_u32 v15, v13, 3, 2
  v_lshl_add_u32 v14, v15, 6, v14
  v_and_b32 v15, 3, v13
  v_lshl_add_u32 v14, v15, 4, v14
  v_add_u32 v11, v11, v14
  s_add_u32 s25, s61, 8388608
  v_add_u32 v7, s25, v11
  s_mul_i32 s22, s3, 512
  s_add_u32 s22, s22, 159744
  v_mov_b32 v10, s22
  s_mul_i32 s26, s30, 320
  s_add_u32 s26, s26, 7680
  v_cmp_gt_u32 vcc, 20, v1
  v_and_b32 v12, 0x30, v2
  s_nop 0
  v_cndmask_b32_e64 v12, v12, v2, vcc
  v_add_u32 v13, v10, v12
  v_lshrrev_b32 v14, 1, v12
  v_add_u32 v14, v10, v14
  s_add_u32 s22, s99, 0
  s_lshr_b32 s23, s22, 2
  s_lshl_b32 s23, s23, 12
  s_and_b32 s22, s22, 3
  s_lshl_b32 s22, s22, 8
  s_add_u32 s64, s23, s22
  s_add_u32 s22, s99, 1
  s_lshr_b32 s23, s22, 2
  s_lshl_b32 s23, s23, 12
  s_and_b32 s22, s22, 3
  s_lshl_b32 s22, s22, 8
  s_add_u32 s65, s23, s22
  s_add_u32 s22, s99, 2
  s_lshr_b32 s23, s22, 2
  s_lshl_b32 s23, s23, 12
  s_and_b32 s22, s22, 3
  s_lshl_b32 s22, s22, 8
  s_add_u32 s66, s23, s22
  s_add_u32 s22, s99, 3
  s_lshr_b32 s23, s22, 2
  s_lshl_b32 s23, s23, 12
  s_and_b32 s22, s22, 3
  s_lshl_b32 s22, s22, 8
  s_add_u32 s67, s23, s22
  s_add_u32 s22, s99, 4
  s_lshr_b32 s23, s22, 2
  s_lshl_b32 s23, s23, 12
  s_and_b32 s22, s22, 3
  s_lshl_b32 s22, s22, 8
  s_add_u32 s68, s23, s22
  s_add_u32 s22, s99, 5
  s_lshr_b32 s23, s22, 2
  s_lshl_b32 s23, s23, 12
  s_and_b32 s22, s22, 3
  s_lshl_b32 s22, s22, 8
  s_add_u32 s69, s23, s22
  s_add_u32 s22, s99, 6
  s_lshr_b32 s23, s22, 2
  s_lshl_b32 s23, s23, 12
  s_and_b32 s22, s22, 3
  s_lshl_b32 s22, s22, 8
  s_add_u32 s70, s23, s22
  s_add_u32 s22, s99, 7
  s_lshr_b32 s23, s22, 2
  s_lshl_b32 s23, s23, 12
  s_and_b32 s22, s22, 3
  s_lshl_b32 s22, s22, 8
  s_add_u32 s71, s23, s22
  s_add_u32 s22, s99, 8
  s_lshr_b32 s23, s22, 2
  s_lshl_b32 s23, s23, 12
  s_and_b32 s22, s22, 3
  s_lshl_b32 s22, s22, 8
  s_add_u32 s72, s23, s22
  s_add_u32 s22, s99, 9
  s_lshr_b32 s23, s22, 2
  s_lshl_b32 s23, s23, 12
  s_and_b32 s22, s22, 3
  s_lshl_b32 s22, s22, 8
  s_add_u32 s73, s23, s22
  s_call_b64 s[94:95], EARLY_SETUP
  s_cmp_lg_u32 s3, 0
  s_cbranch_scc1 P_G10
  s_call_b64 s[94:95], WARM_5
  s_branch P_G1e
P_G10:
  s_cmp_lg_u32 s3, 1
  s_cbranch_scc1 P_G11
  s_call_b64 s[94:95], WARM_6
  s_branch P_G1e
P_G11:
  s_cmp_lg_u32 s3, 2
  s_cbranch_scc1 P_G12
  s_call_b64 s[94:95], WARM_7
  s_branch P_G1e
P_G12:
  s_call_b64 s[94:95], WARM_8
P_G1e:
  s_waitcnt vmcnt(9)
  v_and_b32 v28, 3, v1
  v_lshlrev_b32 v28, 3, v28
  v_lshrrev_b32 v28, v28, s36
  s_mov_b32 s22, s26
  buffer_load_dwordx4 v[32:35], v12, s[4:7], s22 offen sc1
  buffer_load_dwordx4 v[36:39], v12, s[4:7], s22 offen offset:2560 sc1
  s_add_u32 s22, s22, 15360
  buffer_load_dwordx4 v[40:43], v12, s[4:7], s22 offen sc1
  buffer_load_dwordx4 v[44:47], v12, s[4:7], s22 offen offset:2560 sc1
  s_add_u32 s22, s22, 15360
  buffer_load_dwordx4 v[48:51], v12, s[4:7], s22 offen sc1
  buffer_load_dwordx4 v[52:55], v12, s[4:7], s22 offen offset:2560 sc1
  s_add_u32 s22, s22, 15360
  buffer_load_dwordx4 v[56:59], v12, s[4:7], s22 offen sc1
  buffer_load_dwordx4 v[60:63], v12, s[4:7], s22 offen offset:2560 sc1
  s_add_u32 s22, s22, 15360
  ds_read_b64_tr_b16 v[128:129], v17 offset:5120
  ds_read_b64_tr_b16 v[130:131], v17 offset:5632
  ds_read_b64_tr_b16 v[132:133], v17 offset:6144
  ds_read_b64_tr_b16 v[134:135], v17 offset:6656
  ds_read_b64_tr_b16 v[136:137], v17 offset:7168
  ds_read_b64_tr_b16 v[138:139], v17 offset:7680
  ds_read_b64_tr_b16 v[140:141], v17 offset:8192
  ds_read_b64_tr_b16 v[142:143], v17 offset:8704
  ds_read_b64_tr_b16 v[144:145], v17 offset:9216
  ds_read_b64_tr_b16 v[146:147], v17 offset:9728
  ds_read_b64_tr_b16 v[148:149], v17 offset:10240
  ds_read_b64_tr_b16 v[150:151], v17 offset:10752
  ds_read_b64_tr_b16 v[152:153], v17 offset:11264
  ds_read_b64_tr_b16 v[154:155], v17 offset:11776
  ds_read_b64_tr_b16 v[156:157], v17 offset:12288
  ds_read_b64_tr_b16 v[158:159], v17 offset:12800
  ds_read_b64_tr_b16 v[160:161], v17 offset:13312
  ds_read_b64_tr_b16 v[162:163], v17 offset:13824
  ds_read_b64_tr_b16 v[164:165], v17 offset:14336
  ds_read_b64_tr_b16 v[166:167], v17 offset:14848
  s_waitcnt lgkmcnt(15)
  buffer_store_dwordx4 v[128:131], v7, s[4:7], s64 offen sc0 sc1
  s_waitcnt lgkmcnt(15)
  buffer_store_dwordx4 v[132:135], v7, s[4:7], s65 offen sc0 sc1
  s_waitcnt lgkmcnt(14)
  buffer_store_dwordx4 v[136:139], v7, s[4:7], s66 offen sc0 sc1
  s_waitcnt lgkmcnt(12)
  buffer_store_dwordx4 v[140:143], v7, s[4:7], s67 offen sc0 sc1
  s_waitcnt lgkmcnt(10)
  buffer_store_dwordx4 v[144:147], v7, s[4:7], s68 offen sc0 sc1
  s_waitcnt lgkmcnt(8)
  buffer_store_dwordx4 v[148:151], v7, s[4:7], s69 offen sc0 sc1
  s_waitcnt lgkmcnt(6)
  buffer_store_dwordx4 v[152:155], v7, s[4:7], s70 offen sc0 sc1
  s_waitcnt lgkmcnt(4)
  buffer_store_dwordx4 v[156:159], v7, s[4:7], s71 offen sc0 sc1
  s_waitcnt lgkmcnt(2)
  buffer_store_dwordx4 v[160:163], v7, s[4:7], s72 offen sc0 sc1
  s_waitcnt lgkmcnt(0)
  buffer_store_dwordx4 v[164:167], v7, s[4:7], s73 offen sc0 sc1
  s_mov_b32 s63, 0
  s_cmp_lg_u32 s3, 0
  s_cbranch_scc1 P_K20
  s_call_b64 s[94:95], WARM_9
  s_branch P_K2e
P_K20:
  s_cmp_lg_u32 s3, 1
  s_cbranch_scc1 P_K21
  s_call_b64 s[94:95], WARM_10
  s_branch P_K2e
P_K21:
  s_cmp_lg_u32 s3, 2
  s_cbranch_scc1 P_K22
  s_branch P_K2e
P_K22:
P_K2e:
  s_waitcnt vmcnt(10)
  s_mov_b32 s27, 400000
P_HL:
  v_xor_b32 v29, v28, v32
  v_bitop3_b32 v29, v29, v28, v36 bitop3:0xf6
  v_bitop3_b32 v29, v29, v28, v40 bitop3:0xf6
  v_bitop3_b32 v29, v29, v28, v44 bitop3:0xf6
  v_bitop3_b32 v29, v29, v28, v48 bitop3:0xf6
  v_bitop3_b32 v29, v29, v28, v52 bitop3:0xf6
  v_bitop3_b32 v29, v29, v28, v56 bitop3:0xf6
  v_bitop3_b32 v29, v29, v28, v60 bitop3:0xf6
  v_and_b32 v29, 0xff, v29
  v_cmp_eq_u32 vcc, 0, v29
  s_nop 0
  s_cmp_eq_u64 vcc, -1
  s_cbranch_scc1 P_HK
  s_sleep 2
  s_mov_b32 s22, s26
  buffer_load_dwordx4 v[32:35], v12, s[4:7], s22 offen sc1
  buffer_load_dwordx4 v[36:39], v12, s[4:7], s22 offen offset:2560 sc1
  s_add_u32 s22, s22, 15360
  buffer_load_dwordx4 v[40:43], v12, s[4:7], s22 offen sc1
  buffer_load_dwordx4 v[44:47], v12, s[4:7], s22 offen offset:2560 sc1
  s_add_u32 s22, s22, 15360
  buffer_load_dwordx4 v[48:51], v12, s[4:7], s22 offen sc1
  buffer_load_dwordx4 v[52:55], v12, s[4:7], s22 offen offset:2560 sc1
  s_add_u32 s22, s22, 15360
  buffer_load_dwordx4 v[56:59], v12, s[4:7], s22 offen sc1
  buffer_load_dwordx4 v[60:63], v12, s[4:7], s22 offen offset:2560 sc1
  s_add_u32 s22, s22, 15360
  s_waitcnt vmcnt(0)
  s_sub_u32 s27, s27, 1
  s_cmp_lg_u32 s27, 0
  s_cbranch_scc1 P_HL
  s_waitcnt vmcnt(0)
P_HK:
  v_and_b32 v32, 0xffffff00, v32
  v_and_b32 v40, 0xffffff00, v40
  v_and_b32 v48, 0xffffff00, v48
  v_and_b32 v56, 0xffffff00, v56
  v_pk_add_f32 v[32:33], v[32:33], v[40:41]
  v_pk_add_f32 v[48:49], v[48:49], v[56:57]
  v_pk_add_f32 v[34:35], v[34:35], v[42:43]
  v_pk_add_f32 v[50:51], v[50:51], v[58:59]
  v_pk_add_f32 v[32:33], v[32:33], v[48:49]
  v_pk_add_f32 v[34:35], v[34:35], v[50:51]
  v_and_b32 v36, 0xffffff00, v36
  v_and_b32 v44, 0xffffff00, v44
  v_and_b32 v52, 0xffffff00, v52
  v_and_b32 v60, 0xffffff00, v60
  v_pk_add_f32 v[36:37], v[36:37], v[44:45]
  v_pk_add_f32 v[52:53], v[52:53], v[60:61]
  v_pk_add_f32 v[38:39], v[38:39], v[46:47]
  v_pk_add_f32 v[54:55], v[54:55], v[62:63]
  v_pk_add_f32 v[36:37], v[36:37], v[52:53]
  v_pk_add_f32 v[38:39], v[38:39], v[54:55]
  v_cvt_pk_bf16_f32 v40, v32, v33
  v_cvt_pk_bf16_f32 v41, v34, v35
  v_cvt_pk_bf16_f32 v42, v36, v37
  v_cvt_pk_bf16_f32 v43, v38, v39
  v_lshlrev_b32 v36, 16, v42
  v_and_b32 v37, 0xffff0000, v42
  v_lshlrev_b32 v38, 16, v43
  v_and_b32 v39, 0xffff0000, v43
  v_add_f32 v36, 1.0, v36
  v_add_f32 v37, 1.0, v37
  v_add_f32 v38, 1.0, v38
  v_add_f32 v39, 1.0, v39
  v_cvt_pk_bf16_f32 v42, v36, v37
  v_cvt_pk_bf16_f32 v43, v38, v39
  ds_write_b64 v14, v[40:41] offset:256
  ds_write_b64 v14, v[42:43]
  s_waitcnt lgkmcnt(0)
  ds_read_b128 v[40:43], v10 offset:0
  ds_read_b128 v[44:47], v10 offset:256
  ds_read_b128 v[48:51], v10 offset:16
  ds_read_b128 v[52:55], v10 offset:272
  ds_read_b128 v[56:59], v10 offset:32
  ds_read_b128 v[60:63], v10 offset:288
  ds_read_b128 v[64:67], v10 offset:48
  ds_read_b128 v[68:71], v10 offset:304
  ds_read_b128 v[72:75], v10 offset:64
  ds_read_b128 v[76:79], v10 offset:320
  ds_read_b128 v[80:83], v10 offset:80
  ds_read_b128 v[84:87], v10 offset:336
  ds_read_b128 v[88:91], v10 offset:96
  ds_read_b128 v[92:95], v10 offset:352
  ds_read_b128 v[96:99], v10 offset:112
  ds_read_b128 v[100:103], v10 offset:368
  ds_read_b128 v[104:107], v10 offset:128
  ds_read_b128 v[108:111], v10 offset:384
  ds_read_b128 v[112:115], v10 offset:144
  ds_read_b128 v[116:119], v10 offset:400
  s_waitcnt lgkmcnt(15)
  v_dot2_f32_bf16 v124, v128, v40, 0
  v_dot2_f32_bf16 v125, v128, v44, 0
  v_dot2_f32_bf16 v124, v129, v41, v124
  v_dot2_f32_bf16 v125, v129, v45, v125
  v_dot2_f32_bf16 v124, v130, v42, v124
  v_dot2_f32_bf16 v125, v130, v46, v125
  v_dot2_f32_bf16 v124, v131, v43, v124
  v_dot2_f32_bf16 v125, v131, v47, v125
  s_waitcnt lgkmcnt(15)
  v_dot2_f32_bf16 v124, v132, v48, v124
  v_dot2_f32_bf16 v125, v132, v52, v125
  v_dot2_f32_bf16 v124, v133, v49, v124
  v_dot2_f32_bf16 v125, v133, v53, v125
  v_dot2_f32_bf16 v124, v134, v50, v124
  v_dot2_f32_bf16 v125, v134, v54, v125
  v_dot2_f32_bf16 v124, v135, v51, v124
  v_dot2_f32_bf16 v125, v135, v55, v125
  s_waitcnt lgkmcnt(14)
  v_dot2_f32_bf16 v124, v136, v56, v124
  v_dot2_f32_bf16 v125, v136, v60, v125
  v_dot2_f32_bf16 v124, v137, v57, v124
  v_dot2_f32_bf16 v125, v137, v61, v125
  v_dot2_f32_bf16 v124, v138, v58, v124
  v_dot2_f32_bf16 v125, v138, v62, v125
  v_dot2_f32_bf16 v124, v139, v59, v124
  v_dot2_f32_bf16 v125, v139, v63, v125
  s_waitcnt lgkmcnt(12)
  v_dot2_f32_bf16 v124, v140, v64, v124
  v_dot2_f32_bf16 v125, v140, v68, v125
  v_dot2_f32_bf16 v124, v141, v65, v124
  v_dot2_f32_bf16 v125, v141, v69, v125
  v_dot2_f32_bf16 v124, v142, v66, v124
  v_dot2_f32_bf16 v125, v142, v70, v125
  v_dot2_f32_bf16 v124, v143, v67, v124
  v_dot2_f32_bf16 v125, v143, v71, v125
  s_waitcnt lgkmcnt(10)
  v_dot2_f32_bf16 v124, v144, v72, v124
  v_dot2_f32_bf16 v125, v144, v76, v125
  v_dot2_f32_bf16 v124, v145, v73, v124
  v_dot2_f32_bf16 v125, v145, v77, v125
  v_dot2_f32_bf16 v124, v146, v74, v124
  v_dot2_f32_bf16 v125, v146, v78, v125
  v_dot2_f32_bf16 v124, v147, v75, v124
  v_dot2_f32_bf16 v125, v147, v79, v125
  s_waitcnt lgkmcnt(8)
  v_dot2_f32_bf16 v124, v148, v80, v124
  v_dot2_f32_bf16 v125, v148, v84, v125
  v_dot2_f32_bf16 v124, v149, v81, v124
  v_dot2_f32_bf16 v125, v149, v85, v125
  s_branch WOVER_3
  .p2align 12
WARM_3:
  s_setpc_b64 s[94:95]
  s_nop 0
WOVER_3:
  v_dot2_f32_bf16 v124, v150, v82, v124
  v_dot2_f32_bf16 v125, v150, v86, v125
  v_dot2_f32_bf16 v124, v151, v83, v124
  v_dot2_f32_bf16 v125, v151, v87, v125
  s_waitcnt lgkmcnt(6)
  v_dot2_f32_bf16 v124, v152, v88, v124
  v_dot2_f32_bf16 v125, v152, v92, v125
  v_dot2_f32_bf16 v124, v153, v89, v124
  v_dot2_f32_bf16 v125, v153, v93, v125
  v_dot2_f32_bf16 v124, v154, v90, v124
  v_dot2_f32_bf16 v125, v154, v94, v125
  v_dot2_f32_bf16 v124, v155, v91, v124
  v_dot2_f32_bf16 v125, v155, v95, v125
  s_waitcnt lgkmcnt(4)
  v_dot2_f32_bf16 v124, v156, v96, v124
  v_dot2_f32_bf16 v125, v156, v100, v125
  v_dot2_f32_bf16 v124, v157, v97, v124
  v_dot2_f32_bf16 v125, v157, v101, v125
  v_dot2_f32_bf16 v124, v158, v98, v124
  v_dot2_f32_bf16 v125, v158, v102, v125
  v_dot2_f32_bf16 v124, v159, v99, v124
  v_dot2_f32_bf16 v125, v159, v103, v125
  s_waitcnt lgkmcnt(2)
  v_dot2_f32_bf16 v124, v160, v104, v124
  v_dot2_f32_bf16 v125, v160, v108, v125
  v_dot2_f32_bf16 v124, v161, v105, v124
  v_dot2_f32_bf16 v125, v161, v109, v125
  v_dot2_f32_bf16 v124, v162, v106, v124
  v_dot2_f32_bf16 v125, v162, v110, v125
  v_dot2_f32_bf16 v124, v163, v107, v124
  v_dot2_f32_bf16 v125, v163, v111, v125
  s_waitcnt lgkmcnt(0)
  v_dot2_f32_bf16 v124, v164, v112, v124
  v_dot2_f32_bf16 v125, v164, v116, v125
  v_dot2_f32_bf16 v124, v165, v113, v124
  v_dot2_f32_bf16 v125, v165, v117, v125
  v_dot2_f32_bf16 v124, v166, v114, v124
  v_dot2_f32_bf16 v125, v166, v118, v125
  v_dot2_f32_bf16 v124, v167, v115, v124
  v_dot2_f32_bf16 v125, v167, v119, v125
  s_nop 1
  v_cvt_pk_bf16_f32 v122, v124, v124
  v_and_b32 v122, 0xffff0000, v122
  v_cvt_pk_bf16_f32 v123, v125, v125
  v_and_b32 v123, 0xffff0000, v123
  v_sub_f32 v124, v124, v122
  v_sub_f32 v125, v125, v123
  v_cvt_pk_bf16_f32 v120, v122, v124
  v_cvt_pk_bf16_f32 v121, v123, v125
  s_lshr_b32 s22, s30, 1
  s_lshl_b32 s22, s22, 8
  s_and_b32 s23, s30, 1
  s_lshl_b32 s23, s23, 3
  s_add_u32 s22, s22, s23
  s_add_u32 s22, s22, 81920
  buffer_store_dwordx2 v[120:121], v7, s[4:7], s22 offen sc0 sc1
  s_branch P_JOIN
P_W3:
  s_call_b64 s[94:95], EARLY_SETUP
  s_cmp_lg_u32 s3, 0
  s_cbranch_scc1 P_D10
  s_call_b64 s[94:95], WARM_5
  s_branch P_D1e
P_D10:
  s_cmp_lg_u32 s3, 1
  s_cbranch_scc1 P_D11
  s_call_b64 s[94:95], WARM_6
  s_branch P_D1e
P_D11:
  s_cmp_lg_u32 s3, 2
  s_cbranch_scc1 P_D12
  s_call_b64 s[94:95], WARM_7
  s_branch P_D1e
P_D12:
  s_call_b64 s[94:95], WARM_8
P_D1e:
  s_cmp_lg_u32 s3, 0
  s_cbranch_scc1 P_L20
  s_call_b64 s[94:95], WARM_9
  s_branch P_L2e
P_L20:
  s_cmp_lg_u32 s3, 1
  s_cbranch_scc1 P_L21
  s_call_b64 s[94:95], WARM_10
  s_branch P_L2e
P_L21:
  s_cmp_lg_u32 s3, 2
  s_cbranch_scc1 P_L22
  s_branch P_L2e
P_L22:
P_L2e:
  s_mul_i32 s23, s17, 40
  s_add_u32 s24, s23, 39
  s_lshr_b32 s23, s23, 6
  s_lshr_b32 s24, s24, 6
  s_sub_u32 s24, s24, s23
  v_bfe_u32 v13, v1, 2, 1
  v_mul_u32_u24 v13, s24, v13
  v_add_u32 v13, s23, v13
  v_min_u32 v14, 2, v31
  v_mad_u32_u24 v13, v14, 10, v13
  v_and_b32 v14, 3, v1
  v_lshl_add_u32 v13, v13, 2, v14
  s_mul_i32 s23, s19, 80
  s_lshr_b32 s23, s23, 6
  s_lshl_b32 s23, s23, 3
  s_sub_u32 s23, s23, 48
  v_add_u32 v14, s23, v1
  v_cmp_gt_u32 vcc, 48, v1
  s_nop 1
  v_cndmask_b32_e64 v13, v14, v13, vcc
  v_lshlrev_b32 v13, 7, v13
  s_mov_b32 s26, 950272
  s_mov_b32 s27, 400000
  buffer_load_dword v250, v13, s[4:7], s26 offen sc1
POLL_4:
  s_waitcnt vmcnt(0)
  v_cmp_eq_u32 vcc, s36, v250
  s_nop 0
  s_cmp_eq_u64 vcc, -1
  s_cbranch_scc1 POK_5
  s_sleep 2
  buffer_load_dword v250, v13, s[4:7], s26 offen sc1
  s_sub_u32 s27, s27, 1
  s_cmp_lg_u32 s27, 0
  s_cbranch_scc1 POLL_4
POK_5:
  v_add_u32 v10, 4096, v2
  v_lshrrev_b32 v11, 4, v1
  v_lshlrev_b32 v11, 7, v11
  v_lshl_add_u32 v11, v30, 4, v11
  v_add_u32 v11, 4096, v11
  s_mov_b32 s80, 0x00ff00ff
  s_mov_b32 s81, s80
  s_mul_i32 s22, s17, 153600
  s_add_u32 s22, s22, 4194304
  s_mov_b32 m0, 0
  s_nop 0
  buffer_load_dwordx4 v2, s[4:7], s22 offen offset:0 sc1 lds
  buffer_load_dwordx4 v2, s[4:7], s22 offen offset:1024 sc1 lds
  buffer_load_dwordx4 v2, s[4:7], s22 offen offset:2048 sc1 lds
  buffer_load_dwordx4 v2, s[4:7], s22 offen offset:3072 sc1 lds
  s_mov_b32 m0, 4096
  s_nop 0
  buffer_load_dwordx4 v10, s[4:7], s22 offen offset:0 sc1 lds
  buffer_load_dwordx4 v10, s[4:7], s22 offen offset:1024 sc1 lds
  buffer_load_dwordx4 v10, s[4:7], s22 offen offset:2048 sc1 lds
  s_mov_b64 exec, s[80:81]
  buffer_load_dwordx4 v11, s[4:7], s22 offen offset:3072 sc1 lds
  s_mov_b64 exec, -1
  s_add_u32 s22, s22, 7680
  s_mov_b32 m0, 8192
  s_nop 0
  buffer_load_dwordx4 v2, s[4:7], s22 offen offset:0 sc1 lds
  buffer_load_dwordx4 v2, s[4:7], s22 offen offset:1024 sc1 lds
  buffer_load_dwordx4 v2, s[4:7], s22 offen offset:2048 sc1 lds
  buffer_load_dwordx4 v2, s[4:7], s22 offen offset:3072 sc1 lds
  s_mov_b32 m0, 12288
  s_nop 0
  buffer_load_dwordx4 v10, s[4:7], s22 offen offset:0 sc1 lds
  buffer_load_dwordx4 v10, s[4:7], s22 offen offset:1024 sc1 lds
  buffer_load_dwordx4 v10, s[4:7], s22 offen offset:2048 sc1 lds
  s_mov_b64 exec, s[80:81]
  buffer_load_dwordx4 v11, s[4:7], s22 offen offset:3072 sc1 lds
  s_mov_b64 exec, -1
  s_add_u32 s22, s22, 7680
  s_mov_b32 m0, 16384
  s_nop 0
  buffer_load_dwordx4 v2, s[4:7], s22 offen offset:0 sc1 lds
  buffer_load_dwordx4 v2, s[4:7], s22 offen offset:1024 sc1 lds
  buffer_load_dwordx4 v2, s[4:7], s22 offen offset:2048 sc1 lds
  buffer_load_dwordx4 v2, s[4:7], s22 offen offset:3072 sc1 lds
  s_mov_b32 m0, 20480
  s_nop 0
  buffer_load_dwordx4 v10, s[4:7], s22 offen offset:0 sc1 lds
  buffer_load_dwordx4 v10, s[4:7], s22 offen offset:1024 sc1 lds
  buffer_load_dwordx4 v10, s[4:7], s22 offen offset:2048 sc1 lds
  s_mov_b64 exec, s[80:81]
  buffer_load_dwordx4 v11, s[4:7], s22 offen offset:3072 sc1 lds
  s_mov_b64 exec, -1
  s_add_u32 s22, s22, 7680
  s_mov_b32 m0, 24576
  s_nop 0
  buffer_load_dwordx4 v2, s[4:7], s22 offen offset:0 sc1 lds
  buffer_load_dwordx4 v2, s[4:7], s22 offen offset:1024 sc1 lds
  buffer_load_dwordx4 v2, s[4:7], s22 offen offset:2048 sc1 lds
  buffer_load_dwordx4 v2, s[4:7], s22 offen offset:3072 sc1 lds
  s_mov_b32 m0, 28672
  s_nop 0
  buffer_load_dwordx4 v10, s[4:7], s22 offen offset:0 sc1 lds
  buffer_load_dwordx4 v10, s[4:7], s22 offen offset:1024 sc1 lds
  buffer_load_dwordx4 v10, s[4:7], s22 offen offset:2048 sc1 lds
  s_mov_b64 exec, s[80:81]
  buffer_load_dwordx4 v11, s[4:7], s22 offen offset:3072 sc1 lds
  s_mov_b64 exec, -1
  s_add_u32 s22, s22, 7680
  s_mov_b32 m0, 32768
  s_nop 0
  buffer_load_dwordx4 v2, s[4:7], s22 offen offset:0 sc1 lds
  buffer_load_dwordx4 v2, s[4:7], s22 offen offset:1024 sc1 lds
  buffer_load_dwordx4 v2, s[4:7], s22 offen offset:2048 sc1 lds
  buffer_load_dwordx4 v2, s[4:7], s22 offen offset:3072 sc1 lds
  s_mov_b32 m0, 36864
  s_nop 0
  buffer_load_dwordx4 v10, s[4:7], s22 offen offset:0 sc1 lds
  buffer_load_dwordx4 v10, s[4:7], s22 offen offset:1024 sc1 lds
  buffer_load_dwordx4 v10, s[4:7], s22 offen offset:2048 sc1 lds
  s_mov_b64 exec, s[80:81]
  buffer_load_dwordx4 v11, s[4:7], s22 offen offset:3072 sc1 lds
  s_mov_b64 exec, -1
  s_add_u32 s22, s22, 7680
  s_mov_b32 m0, 40960
  s_nop 0
  buffer_load_dwordx4 v2, s[4:7], s22 offen offset:0 sc1 lds
  buffer_load_dwordx4 v2, s[4:7], s22 offen offset:1024 sc1 lds
  buffer_load_dwordx4 v2, s[4:7], s22 offen offset:2048 sc1 lds
  buffer_load_dwordx4 v2, s[4:7], s22 offen offset:3072 sc1 lds
  s_mov_b32 m0, 45056
  s_nop 0
  buffer_load_dwordx4 v10, s[4:7], s22 offen offset:0 sc1 lds
  buffer_load_dwordx4 v10, s[4:7], s22 offen offset:1024 sc1 lds
  buffer_load_dwordx4 v10, s[4:7], s22 offen offset:2048 sc1 lds
  s_mov_b64 exec, s[80:81]
  buffer_load_dwordx4 v11, s[4:7], s22 offen offset:3072 sc1 lds
  s_mov_b64 exec, -1
  s_add_u32 s22, s22, 7680
  s_waitcnt vmcnt(14)
  s_mov_b32 m0, 49152
  s_nop 0
  buffer_load_dwordx4 v2, s[4:7], s22 offen offset:0 sc1 lds
  buffer_load_dwordx4 v2, s[4:7], s22 offen offset:1024 sc1 lds
  buffer_load_dwordx4 v2, s[4:7], s22 offen offset:2048 sc1 lds
  buffer_load_dwordx4 v2, s[4:7], s22 offen offset:3072 sc1 lds
  s_mov_b32 m0, 53248
  s_nop 0
  buffer_load_dwordx4 v10, s[4:7], s22 offen offset:0 sc1 lds
  buffer_load_dwordx4 v10, s[4:7], s22 offen offset:1024 sc1 lds
  buffer_load_dwordx4 v10, s[4:7], s22 offen offset:2048 sc1 lds
  s_mov_b64 exec, s[80:81]
  buffer_load_dwordx4 v11, s[4:7], s22 offen offset:3072 sc1 lds
  s_mov_b64 exec, -1
  s_add_u32 s22, s22, 7680
  s_mov_b32 m0, 57344
  s_nop 0
  buffer_load_dwordx4 v2, s[4:7], s22 offen offset:0 sc1 lds
  buffer_load_dwordx4 v2, s[4:7], s22 offen offset:1024 sc1 lds
  buffer_load_dwordx4 v2, s[4:7], s22 offen offset:2048 sc1 lds
  buffer_load_dwordx4 v2, s[4:7], s22 offen offset:3072 sc1 lds
  s_mov_b32 m0, 61440
  s_nop 0
  buffer_load_dwordx4 v10, s[4:7], s22 offen offset:0 sc1 lds
  buffer_load_dwordx4 v10, s[4:7], s22 offen offset:1024 sc1 lds
  buffer_load_dwordx4 v10, s[4:7], s22 offen offset:2048 sc1 lds
  s_mov_b64 exec, s[80:81]
  buffer_load_dwordx4 v11, s[4:7], s22 offen offset:3072 sc1 lds
  s_mov_b64 exec, -1
  s_add_u32 s22, s22, 7680
P_POLL:
  s_lshl_b32 s22, s16, 3
  v_min_u32 v253, 8, v1
  v_add_u32 v253, s22, v253
  v_max_u32 v253, 1, v253
  v_lshlrev_b32 v253, 7, v253
  s_mov_b32 s26, 884608
  buffer_load_dword v251, v253, s[4:7], s26 offen sc1
  s_mov_b32 s39, 1
  s_branch P_PRE
P_JOIN:
  s_mov_b32 s39, 0
P_PRE:
  s_mul_i32 s48, s17, 153600
  s_add_u32 s48, s48, 4255744
  s_lshl_b32 s50, s3, 11
  v_add_u32 v10, s50, v2
  v_lshrrev_b32 v22, 4, v1
  v_and_b32 v23, 7, v1
  v_lshlrev_b32 v22, 7, v22
  v_lshl_add_u32 v22, v23, 4, v22
  v_add_u32 v22, 6144, v22
  s_cmp_eq_u32 s3, 3
  s_cselect_b64 vcc, -1, 0
  s_cselect_b32 s80, 0x00ff00ff, -1
  s_mov_b32 s81, s80
  v_cndmask_b32_e64 v11, v10, v22, vcc
  v_accvgpr_read_b32 v8, a200
  v_accvgpr_read_b32 v12, a201
  v_accvgpr_read_b32 v13, a202
  v_accvgpr_read_b32 v14, a203
  v_accvgpr_read_b32 v15, a204
  v_accvgpr_read_b32 v16, a205
  v_accvgpr_read_b32 v17, a206
  v_accvgpr_read_b32 v18, a207
  v_accvgpr_read_b32 v19, a208
  v_accvgpr_read_b32 v24, a209
  v_accvgpr_read_b32 v25, a210
  v_accvgpr_read_b32 v26, a211
  v_accvgpr_read_b32 v27, a212
  v_accvgpr_read_b32 v28, a213
  v_accvgpr_read_b32 v29, a214
  v_accvgpr_read_b32 v228, a215
  v_accvgpr_read_b32 v229, a216
  v_accvgpr_read_b32 v230, a217
  v_accvgpr_read_b32 v232, a218
  v_accvgpr_read_b32 v233, a219
  v_accvgpr_read_b32 v234, a220
  v_accvgpr_read_b32 v235, a221
  v_accvgpr_read_b32 v236, a222
  v_accvgpr_read_b32 v237, a223
  v_accvgpr_read_b32 v238, a224
  v_accvgpr_read_b32 v239, a225
  s_cmp_eq_u32 s39, 0
  s_cbranch_scc1 B_JOIN
  s_mov_b32 s26, 884608
  s_waitcnt vmcnt(0)
  v_cmp_eq_u32 vcc, s36, v251
  s_nop 0
  s_cmp_eq_u64 vcc, -1
  s_cbranch_scc1 B_JOIN
  s_mov_b32 s27, 400000
  buffer_load_dword v250, v253, s[4:7], s26 offen sc1
POLL_6:
  s_waitcnt vmcnt(0)
  v_cmp_eq_u32 vcc, s36, v250
  s_nop 0
  s_cmp_eq_u64 vcc, -1
  s_cbranch_scc1 POK_7
  s_sleep 2
  buffer_load_dword v250, v253, s[4:7], s26 offen sc1
  s_sub_u32 s27, s27, 1
  s_cmp_lg_u32 s27, 0
  s_cbranch_scc1 POLL_6
POK_7:
B_JOIN:
  s_barrier
  s_mov_b64 exec, s[82:83]
  s_add_u32 m0, s51, 7168
  s_nop 0
  buffer_load_dwordx4 v2, s[4:7], s47 offen sc1 lds
  s_add_u32 s47, s47, 4096
  s_add_u32 m0, s51, 39936
  s_nop 0
  buffer_load_dwordx4 v2, s[4:7], s47 offen sc1 lds
  s_add_u32 s47, s47, 4096
  s_add_u32 m0, s51, 72704
  s_nop 0
  buffer_load_dwordx4 v2, s[4:7], s47 offen sc1 lds
  s_add_u32 s47, s47, 4096
  s_add_u32 m0, s51, 105472
  s_nop 0
  buffer_load_dwordx4 v2, s[4:7], s47 offen sc1 lds
  s_add_u32 s47, s47, 4096
  s_add_u32 m0, s51, 138240
  s_nop 0
  buffer_load_dwordx4 v2, s[4:7], s47 offen sc1 lds
  s_add_u32 s47, s47, 4096
  s_mov_b64 exec, -1
  buffer_load_dwordx4 a[80:83], v2, s[4:7], s46 offen sc1
  buffer_load_dwordx4 a[84:87], v8, s[4:7], s46 offen sc1
  s_add_u32 s46, s46, 1024
  buffer_load_dwordx4 a[88:91], v2, s[4:7], s46 offen sc1
  buffer_load_dwordx4 a[92:95], v8, s[4:7], s46 offen sc1
  s_add_u32 s46, s46, 1024
  buffer_load_dwordx4 a[96:99], v2, s[4:7], s46 offen sc1
  buffer_load_dwordx4 a[100:103], v8, s[4:7], s46 offen sc1
  s_add_u32 s46, s46, 1024
  buffer_load_dwordx4 a[104:107], v2, s[4:7], s46 offen sc1
  buffer_load_dwordx4 a[108:111], v8, s[4:7], s46 offen sc1
  s_add_u32 s46, s46, 1024
  buffer_load_dwordx4 a[112:115], v2, s[4:7], s46 offen sc1
  buffer_load_dwordx4 a[116:119], v8, s[4:7], s46 offen sc1
  s_add_u32 s46, s46, 1024
  s_waitcnt vmcnt(8)
  s_barrier
  s_cmp_eq_u32 s62, 0
  s_cbranch_scc1 BF_8
  v_mov_b32 v20, s36
  v_mov_b32 v21, s36
  v_mov_b32 v22, s36
  v_mov_b32 v23, s36
  s_mov_b64 exec, 0xff
  buffer_store_dwordx4 v[20:23], v2, s[4:7], s62 offen sc0 sc1
  s_mov_b64 exec, -1
BF_8:
  ds_read_b128 a[0:3], v2 offset:0
  ds_read_b128 a[4:7], v2 offset:1024
  ds_read_b128 a[8:11], v2 offset:2048
  ds_read_b128 a[12:15], v2 offset:3072
  ds_read_b128 a[16:19], v2 offset:4096
  ds_read_b128 a[20:23], v2 offset:5120
  ds_read_b128 a[24:27], v2 offset:6144
  ds_read_b128 a[28:31], v2 offset:7168
  ds_read_b128 a[32:35], v232 offset:1024
  ds_read_b128 a[36:39], v232 offset:4096
  s_waitcnt lgkmcnt(6)
  v_mfma_f32_16x16x32_bf16 v[32:35], a[0:3], a[80:83], 0
  v_mfma_f32_16x16x32_bf16 v[64:67], a[0:3], a[84:87], 0
  ds_read_b128 a[40:43], v2 offset:8192
  v_mfma_f32_16x16x32_bf16 v[36:39], a[4:7], a[80:83], 0
  ds_read_b128 a[44:47], v2 offset:9216
  v_mfma_f32_16x16x32_bf16 v[68:71], a[4:7], a[84:87], 0
  buffer_load_dwordx4 a[120:123], v2, s[4:7], s46 offen sc1
  v_mfma_f32_16x16x32_bf16 v[40:43], a[8:11], a[80:83], 0
  v_mfma_f32_16x16x32_bf16 v[72:75], a[8:11], a[84:87], 0
  ds_read_b128 a[48:51], v2 offset:10240
  v_mfma_f32_16x16x32_bf16 v[44:47], a[12:15], a[80:83], 0
  ds_read_b128 a[52:55], v2 offset:11264
  v_mfma_f32_16x16x32_bf16 v[76:79], a[12:15], a[84:87], 0
  buffer_load_dwordx4 a[124:127], v8, s[4:7], s46 offen sc1
  s_add_u32 s46, s46, 1024
  s_waitcnt lgkmcnt(4)
  v_mfma_f32_16x16x32_bf16 v[48:51], a[16:19], a[80:83], 0
  ds_read_b128 a[56:59], v2 offset:12288
  v_mfma_f32_16x16x32_bf16 v[80:83], a[16:19], a[84:87], 0
  v_mfma_f32_16x16x32_bf16 v[52:55], a[80:83], a[20:23], 0
  ds_read_b128 a[60:63], v2 offset:13312
  v_mfma_f32_16x16x32_bf16 v[84:87], a[84:87], a[20:23], 0
  s_add_u32 m0, s50, 65536
  s_nop 0
  buffer_load_dwordx4 v10, s[4:7], s48 offen sc1 lds
  v_mfma_f32_16x16x32_bf16 v[56:59], a[80:83], a[24:27], 0
  ds_read_b128 a[64:67], v2 offset:14336
  v_mfma_f32_16x16x32_bf16 v[88:91], a[84:87], a[24:27], 0
  v_mfma_f32_16x16x32_bf16 v[60:63], a[80:83], a[28:31], 0
  ds_read_b128 a[68:71], v2 offset:15360
  v_mfma_f32_16x16x32_bf16 v[92:95], a[84:87], a[28:31], 0
  s_mov_b64 exec, s[80:81]
  buffer_load_dwordx4 v11, s[4:7], s48 offen offset:1024 sc1 lds
  s_mov_b64 exec, -1
  s_add_u32 s48, s48, 7680
  v_mfma_f32_16x16x32_bf16 v[96:99], a[32:35], a[28:31], 0
  ds_read_b128 a[72:75], v232 offset:9216
  v_mfma_f32_16x16x32_bf16 v[100:103], a[28:31], a[36:39], 0
  ds_read_b128 a[76:79], v232 offset:12288
  s_waitcnt vmcnt(10)
  s_waitcnt lgkmcnt(6)
  v_mfma_f32_16x16x32_bf16 v[32:35], a[40:43], a[88:91], v[32:35]
  v_mfma_f32_16x16x32_bf16 v[64:67], a[40:43], a[92:95], v[64:67]
  ds_read_b128 a[0:3], v2 offset:16384
  v_mfma_f32_16x16x32_bf16 v[36:39], a[44:47], a[88:91], v[36:39]
  ds_read_b128 a[4:7], v2 offset:17408
  v_mfma_f32_16x16x32_bf16 v[68:71], a[44:47], a[92:95], v[68:71]
  buffer_load_dwordx4 a[128:131], v2, s[4:7], s46 offen sc1
  v_mfma_f32_16x16x32_bf16 v[40:43], a[48:51], a[88:91], v[40:43]
  v_mfma_f32_16x16x32_bf16 v[72:75], a[48:51], a[92:95], v[72:75]
  ds_read_b128 a[8:11], v2 offset:18432
  v_mfma_f32_16x16x32_bf16 v[44:47], a[52:55], a[88:91], v[44:47]
  ds_read_b128 a[12:15], v2 offset:19456
  v_mfma_f32_16x16x32_bf16 v[76:79], a[52:55], a[92:95], v[76:79]
  buffer_load_dwordx4 a[132:135], v8, s[4:7], s46 offen sc1
  s_add_u32 s46, s46, 1024
  s_waitcnt lgkmcnt(4)
  v_mfma_f32_16x16x32_bf16 v[48:51], a[56:59], a[88:91], v[48:51]
  ds_read_b128 a[16:19], v2 offset:20480
  v_mfma_f32_16x16x32_bf16 v[80:83], a[56:59], a[92:95], v[80:83]
  v_mfma_f32_16x16x32_bf16 v[52:55], a[88:91], a[60:63], v[52:55]
  ds_read_b128 a[20:23], v2 offset:21504
  v_mfma_f32_16x16x32_bf16 v[84:87], a[92:95], a[60:63], v[84:87]
  s_add_u32 m0, s50, 73728
  s_nop 0
  buffer_load_dwordx4 v10, s[4:7], s48 offen sc1 lds
  v_mfma_f32_16x16x32_bf16 v[56:59], a[88:91], a[64:67], v[56:59]
  ds_read_b128 a[24:27], v2 offset:22528
  v_mfma_f32_16x16x32_bf16 v[88:91], a[92:95], a[64:67], v[88:91]
  v_mfma_f32_16x16x32_bf16 v[60:63], a[88:91], a[68:71], v[60:63]
  ds_read_b128 a[28:31], v2 offset:23552
  v_mfma_f32_16x16x32_bf16 v[92:95], a[92:95], a[68:71], v[92:95]
  s_mov_b64 exec, s[80:81]
  buffer_load_dwordx4 v11, s[4:7], s48 offen offset:1024 sc1 lds
  s_mov_b64 exec, -1
  s_add_u32 s48, s48, 7680
  v_mfma_f32_16x16x32_bf16 v[96:99], a[72:75], a[68:71], v[96:99]
  ds_read_b128 a[32:35], v232 offset:17408
  v_mfma_f32_16x16x32_bf16 v[100:103], a[68:71], a[76:79], v[100:103]
  ds_read_b128 a[36:39], v232 offset:20480
  s_waitcnt vmcnt(12)
  s_waitcnt lgkmcnt(6)
  v_mfma_f32_16x16x32_bf16 v[32:35], a[0:3], a[96:99], v[32:35]
  v_mfma_f32_16x16x32_bf16 v[64:67], a[0:3], a[100:103], v[64:67]
  ds_read_b128 a[40:43], v2 offset:24576
  v_mfma_f32_16x16x32_bf16 v[36:39], a[4:7], a[96:99], v[36:39]
  ds_read_b128 a[44:47], v2 offset:25600
  v_mfma_f32_16x16x32_bf16 v[68:71], a[4:7], a[100:103], v[68:71]
  buffer_load_dwordx4 a[136:139], v2, s[4:7], s46 offen sc1
  v_mfma_f32_16x16x32_bf16 v[40:43], a[8:11], a[96:99], v[40:43]
  v_mfma_f32_16x16x32_bf16 v[72:75], a[8:11], a[100:103], v[72:75]
  ds_read_b128 a[48:51], v2 offset:26624
  v_mfma_f32_16x16x32_bf16 v[44:47], a[12:15], a[96:99], v[44:47]
  ds_read_b128 a[52:55], v2 offset:27648
  v_mfma_f32_16x16x32_bf16 v[76:79], a[12:15], a[100:103], v[76:79]
  buffer_load_dwordx4 a[140:143], v8, s[4:7], s46 offen sc1
  s_add_u32 s46, s46, 1024
  s_waitcnt lgkmcnt(4)
  v_mfma_f32_16x16x32_bf16 v[48:51], a[16:19], a[96:99], v[48:51]
  ds_read_b128 a[56:59], v2 offset:28672
  v_mfma_f32_16x16x32_bf16 v[80:83], a[16:19], a[100:103], v[80:83]
  v_mfma_f32_16x16x32_bf16 v[52:55], a[96:99], a[20:23], v[52:55]
  ds_read_b128 a[60:63], v2 offset:29696
  v_mfma_f32_16x16x32_bf16 v[84:87], a[100:103], a[20:23], v[84:87]
  s_add_u32 m0, s50, 81920
  s_nop 0
  buffer_load_dwordx4 v10, s[4:7], s48 offen sc1 lds
  v_mfma_f32_16x16x32_bf16 v[56:59], a[96:99], a[24:27], v[56:59]
  ds_read_b128 a[64:67], v2 offset:30720
  v_mfma_f32_16x16x32_bf16 v[88:91], a[100:103], a[24:27], v[88:91]
  v_mfma_f32_16x16x32_bf16 v[60:63], a[96:99], a[28:31], v[60:63]
  ds_read_b128 a[68:71], v2 offset:31744
  v_mfma_f32_16x16x32_bf16 v[92:95], a[100:103], a[28:31], v[92:95]
  s_mov_b64 exec, s[80:81]
  buffer_load_dwordx4 v11, s[4:7], s48 offen offset:1024 sc1 lds
  s_mov_b64 exec, -1
  s_add_u32 s48, s48, 7680
  v_mfma_f32_16x16x32_bf16 v[96:99], a[32:35], a[28:31], v[96:99]
  ds_read_b128 a[72:75], v232 offset:25600
  v_mfma_f32_16x16x32_bf16 v[100:103], a[28:31], a[36:39], v[100:103]
  ds_read_b128 a[76:79], v232 offset:28672
  s_waitcnt vmcnt(14)
  s_waitcnt lgkmcnt(6)
  v_mfma_f32_16x16x32_bf16 v[32:35], a[40:43], a[104:107], v[32:35]
  v_mfma_f32_16x16x32_bf16 v[64:67], a[40:43], a[108:111], v[64:67]
  ds_read_b128 a[0:3], v2 offset:32768
  v_mfma_f32_16x16x32_bf16 v[36:39], a[44:47], a[104:107], v[36:39]
  ds_read_b128 a[4:7], v2 offset:33792
  v_mfma_f32_16x16x32_bf16 v[68:71], a[44:47], a[108:111], v[68:71]
  buffer_load_dwordx4 a[144:147], v2, s[4:7], s46 offen sc1
  v_mfma_f32_16x16x32_bf16 v[40:43], a[48:51], a[104:107], v[40:43]
  v_mfma_f32_16x16x32_bf16 v[72:75], a[48:51], a[108:111], v[72:75]
  ds_read_b128 a[8:11], v2 offset:34816
  v_mfma_f32_16x16x32_bf16 v[44:47], a[52:55], a[104:107], v[44:47]
  ds_read_b128 a[12:15], v2 offset:35840
  v_mfma_f32_16x16x32_bf16 v[76:79], a[52:55], a[108:111], v[76:79]
  buffer_load_dwordx4 a[148:151], v8, s[4:7], s46 offen sc1
  s_add_u32 s46, s46, 1024
  s_waitcnt lgkmcnt(4)
  v_mfma_f32_16x16x32_bf16 v[48:51], a[56:59], a[104:107], v[48:51]
  ds_read_b128 a[16:19], v2 offset:36864
  v_mfma_f32_16x16x32_bf16 v[80:83], a[56:59], a[108:111], v[80:83]
  v_mfma_f32_16x16x32_bf16 v[52:55], a[104:107], a[60:63], v[52:55]
  ds_read_b128 a[20:23], v2 offset:37888
  v_mfma_f32_16x16x32_bf16 v[84:87], a[108:111], a[60:63], v[84:87]
  s_add_u32 m0, s50, 90112
  s_nop 0
  buffer_load_dwordx4 v10, s[4:7], s48 offen sc1 lds
  v_mfma_f32_16x16x32_bf16 v[56:59], a[104:107], a[64:67], v[56:59]
  ds_read_b128 a[24:27], v2 offset:38912
  v_mfma_f32_16x16x32_bf16 v[88:91], a[108:111], a[64:67], v[88:91]
  v_mfma_f32_16x16x32_bf16 v[60:63], a[104:107], a[68:71], v[60:63]
  ds_read_b128 a[28:31], v2 offset:39936
  v_mfma_f32_16x16x32_bf16 v[92:95], a[108:111], a[68:71], v[92:95]
  s_mov_b64 exec, s[80:81]
  buffer_load_dwordx4 v11, s[4:7], s48 offen offset:1024 sc1 lds
  s_mov_b64 exec, -1
  s_add_u32 s48, s48, 7680
  v_mfma_f32_16x16x32_bf16 v[96:99], a[72:75], a[68:71], v[96:99]
  ds_read_b128 a[32:35], v232 offset:33792
  v_mfma_f32_16x16x32_bf16 v[100:103], a[68:71], a[76:79], v[100:103]
  ds_read_b128 a[36:39], v232 offset:36864
  s_waitcnt vmcnt(16)
  s_waitcnt lgkmcnt(6)
  v_mfma_f32_16x16x32_bf16 v[32:35], a[0:3], a[112:115], v[32:35]
  v_mfma_f32_16x16x32_bf16 v[64:67], a[0:3], a[116:119], v[64:67]
  ds_read_b128 a[40:43], v2 offset:40960
  v_mfma_f32_16x16x32_bf16 v[36:39], a[4:7], a[112:115], v[36:39]
  ds_read_b128 a[44:47], v2 offset:41984
  v_mfma_f32_16x16x32_bf16 v[68:71], a[4:7], a[116:119], v[68:71]
  buffer_load_dwordx4 a[152:155], v2, s[4:7], s46 offen sc1
  v_mfma_f32_16x16x32_bf16 v[40:43], a[8:11], a[112:115], v[40:43]
  v_mfma_f32_16x16x32_bf16 v[72:75], a[8:11], a[116:119], v[72:75]
  ds_read_b128 a[48:51], v2 offset:43008
  v_mfma_f32_16x16x32_bf16 v[44:47], a[12:15], a[112:115], v[44:47]
  ds_read_b128 a[52:55], v2 offset:44032
  v_mfma_f32_16x16x32_bf16 v[76:79], a[12:15], a[116:119], v[76:79]
  buffer_load_dwordx4 a[156:159], v8, s[4:7], s46 offen sc1
  s_add_u32 s46, s46, 1024
  s_waitcnt lgkmcnt(4)
  v_mfma_f32_16x16x32_bf16 v[48:51], a[16:19], a[112:115], v[48:51]
  ds_read_b128 a[56:59], v2 offset:45056
  v_mfma_f32_16x16x32_bf16 v[80:83], a[16:19], a[116:119], v[80:83]
  v_mfma_f32_16x16x32_bf16 v[52:55], a[112:115], a[20:23], v[52:55]
  ds_read_b128 a[60:63], v2 offset:46080
  v_mfma_f32_16x16x32_bf16 v[84:87], a[116:119], a[20:23], v[84:87]
  s_add_u32 m0, s50, 98304
  s_nop 0
  buffer_load_dwordx4 v10, s[4:7], s48 offen sc1 lds
  v_mfma_f32_16x16x32_bf16 v[56:59], a[112:115], a[24:27], v[56:59]
  ds_read_b128 a[64:67], v2 offset:47104
  v_mfma_f32_16x16x32_bf16 v[88:91], a[116:119], a[24:27], v[88:91]
  v_mfma_f32_16x16x32_bf16 v[60:63], a[112:115], a[28:31], v[60:63]
  ds_read_b128 a[68:71], v2 offset:48128
  v_mfma_f32_16x16x32_bf16 v[92:95], a[116:119], a[28:31], v[92:95]
  s_mov_b64 exec, s[80:81]
  buffer_load_dwordx4 v11, s[4:7], s48 offen offset:1024 sc1 lds
  s_mov_b64 exec, -1
  s_add_u32 s48, s48, 7680
  v_mfma_f32_16x16x32_bf16 v[96:99], a[32:35], a[28:31], v[96:99]
  ds_read_b128 a[72:75], v232 offset:41984
  v_mfma_f32_16x16x32_bf16 v[100:103], a[28:31], a[36:39], v[100:103]
  ds_read_b128 a[76:79], v232 offset:45056
  s_waitcnt vmcnt(18)
  s_waitcnt lgkmcnt(6)
  v_mfma_f32_16x16x32_bf16 v[32:35], a[40:43], a[120:123], v[32:35]
  v_mfma_f32_16x16x32_bf16 v[64:67], a[40:43], a[124:127], v[64:67]
  ds_read_b128 a[0:3], v2 offset:49152
  v_mfma_f32_16x16x32_bf16 v[36:39], a[44:47], a[120:123], v[36:39]
  ds_read_b128 a[4:7], v2 offset:50176
  v_mfma_f32_16x16x32_bf16 v[68:71], a[44:47], a[124:127], v[68:71]
  buffer_load_dwordx4 a[160:163], v2, s[4:7], s46 offen sc1
  v_mfma_f32_16x16x32_bf16 v[40:43], a[48:51], a[120:123], v[40:43]
  v_mfma_f32_16x16x32_bf16 v[72:75], a[48:51], a[124:127], v[72:75]
  ds_read_b128 a[8:11], v2 offset:51200
  v_mfma_f32_16x16x32_bf16 v[44:47], a[52:55], a[120:123], v[44:47]
  ds_read_b128 a[12:15], v2 offset:52224
  v_mfma_f32_16x16x32_bf16 v[76:79], a[52:55], a[124:127], v[76:79]
  buffer_load_dwordx4 a[164:167], v8, s[4:7], s46 offen sc1
  s_add_u32 s46, s46, 1024
  s_waitcnt lgkmcnt(4)
  v_mfma_f32_16x16x32_bf16 v[48:51], a[56:59], a[120:123], v[48:51]
  ds_read_b128 a[16:19], v2 offset:53248
  v_mfma_f32_16x16x32_bf16 v[80:83], a[56:59], a[124:127], v[80:83]
  v_mfma_f32_16x16x32_bf16 v[52:55], a[120:123], a[60:63], v[52:55]
  s_branch WOVER_4
  .p2align 12
WARM_4:
  s_setpc_b64 s[94:95]
  s_nop 0
WOVER_4:
  ds_read_b128 a[20:23], v2 offset:54272
  v_mfma_f32_16x16x32_bf16 v[84:87], a[124:127], a[60:63], v[84:87]
  s_add_u32 m0, s50, 106496
  s_nop 0
  buffer_load_dwordx4 v10, s[4:7], s48 offen sc1 lds
  v_mfma_f32_16x16x32_bf16 v[56:59], a[120:123], a[64:67], v[56:59]
  ds_read_b128 a[24:27], v2 offset:55296
  v_mfma_f32_16x16x32_bf16 v[88:91], a[124:127], a[64:67], v[88:91]
  v_mfma_f32_16x16x32_bf16 v[60:63], a[120:123], a[68:71], v[60:63]
  ds_read_b128 a[28:31], v2 offset:56320
  v_mfma_f32_16x16x32_bf16 v[92:95], a[124:127], a[68:71], v[92:95]
  s_mov_b64 exec, s[80:81]
  buffer_load_dwordx4 v11, s[4:7], s48 offen offset:1024 sc1 lds
  s_mov_b64 exec, -1
  s_add_u32 s48, s48, 7680
  v_mfma_f32_16x16x32_bf16 v[96:99], a[72:75], a[68:71], v[96:99]
  ds_read_b128 a[32:35], v232 offset:50176
  v_mfma_f32_16x16x32_bf16 v[100:103], a[68:71], a[76:79], v[100:103]
  ds_read_b128 a[36:39], v232 offset:53248
  s_waitcnt vmcnt(18)
  s_waitcnt lgkmcnt(6)
  v_mfma_f32_16x16x32_bf16 v[32:35], a[0:3], a[128:131], v[32:35]
  v_mfma_f32_16x16x32_bf16 v[64:67], a[0:3], a[132:135], v[64:67]
  ds_read_b128 a[40:43], v2 offset:57344
  v_mfma_f32_16x16x32_bf16 v[36:39], a[4:7], a[128:131], v[36:39]
  ds_read_b128 a[44:47], v2 offset:58368
  v_mfma_f32_16x16x32_bf16 v[68:71], a[4:7], a[132:135], v[68:71]
  buffer_load_dwordx4 a[168:171], v2, s[4:7], s46 offen sc1
  v_mfma_f32_16x16x32_bf16 v[40:43], a[8:11], a[128:131], v[40:43]
  v_mfma_f32_16x16x32_bf16 v[72:75], a[8:11], a[132:135], v[72:75]
  ds_read_b128 a[48:51], v2 offset:59392
  v_mfma_f32_16x16x32_bf16 v[44:47], a[12:15], a[128:131], v[44:47]
  ds_read_b128 a[52:55], v2 offset:60416
  v_mfma_f32_16x16x32_bf16 v[76:79], a[12:15], a[132:135], v[76:79]
  buffer_load_dwordx4 a[172:175], v8, s[4:7], s46 offen sc1
  s_add_u32 s46, s46, 1024
  s_waitcnt lgkmcnt(4)
  v_mfma_f32_16x16x32_bf16 v[48:51], a[16:19], a[128:131], v[48:51]
  ds_read_b128 a[56:59], v2 offset:61440
  v_mfma_f32_16x16x32_bf16 v[80:83], a[16:19], a[132:135], v[80:83]
  v_mfma_f32_16x16x32_bf16 v[52:55], a[128:131], a[20:23], v[52:55]
  ds_read_b128 a[60:63], v2 offset:62464
  v_mfma_f32_16x16x32_bf16 v[84:87], a[132:135], a[20:23], v[84:87]
  s_add_u32 m0, s50, 114688
  s_nop 0
  buffer_load_dwordx4 v10, s[4:7], s48 offen sc1 lds
  v_mfma_f32_16x16x32_bf16 v[56:59], a[128:131], a[24:27], v[56:59]
  ds_read_b128 a[64:67], v2 offset:63488
  v_mfma_f32_16x16x32_bf16 v[88:91], a[132:135], a[24:27], v[88:91]
  v_mfma_f32_16x16x32_bf16 v[60:63], a[128:131], a[28:31], v[60:63]
  ds_read_b128 a[68:71], v2 offset:64512
  v_mfma_f32_16x16x32_bf16 v[92:95], a[132:135], a[28:31], v[92:95]
  s_mov_b64 exec, s[80:81]
  buffer_load_dwordx4 v11, s[4:7], s48 offen offset:1024 sc1 lds
  s_mov_b64 exec, -1
  s_add_u32 s48, s48, 7680
  v_mfma_f32_16x16x32_bf16 v[96:99], a[32:35], a[28:31], v[96:99]
  ds_read_b128 a[72:75], v232 offset:58368
  v_mfma_f32_16x16x32_bf16 v[100:103], a[28:31], a[36:39], v[100:103]
  ds_read_b128 a[76:79], v232 offset:61440
  s_waitcnt vmcnt(18)
  s_waitcnt lgkmcnt(6)
  v_mfma_f32_16x16x32_bf16 v[32:35], a[40:43], a[136:139], v[32:35]
  v_mfma_f32_16x16x32_bf16 v[64:67], a[40:43], a[140:143], v[64:67]
  v_mfma_f32_16x16x32_bf16 v[36:39], a[44:47], a[136:139], v[36:39]
  s_barrier
  v_mfma_f32_16x16x32_bf16 v[68:71], a[44:47], a[140:143], v[68:71]
  ds_read_b128 a[0:3], v3 offset:0
  v_mfma_f32_16x16x32_bf16 v[40:43], a[48:51], a[136:139], v[40:43]
  ds_read_b128 a[4:7], v3 offset:1024
  v_mfma_f32_16x16x32_bf16 v[72:75], a[48:51], a[140:143], v[72:75]
  buffer_load_dwordx4 a[176:179], v2, s[4:7], s46 offen sc1
  v_mfma_f32_16x16x32_bf16 v[44:47], a[52:55], a[136:139], v[44:47]
  ds_read_b128 a[8:11], v3 offset:2048
  v_mfma_f32_16x16x32_bf16 v[76:79], a[52:55], a[140:143], v[76:79]
  ds_read_b128 a[12:15], v3 offset:3072
  s_waitcnt lgkmcnt(4)
  v_mfma_f32_16x16x32_bf16 v[48:51], a[56:59], a[136:139], v[48:51]
  buffer_load_dwordx4 a[180:183], v8, s[4:7], s46 offen sc1
  s_add_u32 s46, s46, 1024
  v_mfma_f32_16x16x32_bf16 v[80:83], a[56:59], a[140:143], v[80:83]
  v_mfma_f32_16x16x32_bf16 v[52:55], a[136:139], a[60:63], v[52:55]
  ds_read_b128 a[16:19], v3 offset:4096
  v_mfma_f32_16x16x32_bf16 v[84:87], a[140:143], a[60:63], v[84:87]
  ds_read_b128 a[20:23], v3 offset:5120
  v_mfma_f32_16x16x32_bf16 v[56:59], a[136:139], a[64:67], v[56:59]
  s_add_u32 m0, s50, 122880
  s_nop 0
  buffer_load_dwordx4 v10, s[4:7], s48 offen sc1 lds
  v_mfma_f32_16x16x32_bf16 v[88:91], a[140:143], a[64:67], v[88:91]
  ds_read_b128 a[24:27], v3 offset:6144
  v_mfma_f32_16x16x32_bf16 v[60:63], a[136:139], a[68:71], v[60:63]
  ds_read_b128 a[28:31], v3 offset:7168
  v_mfma_f32_16x16x32_bf16 v[92:95], a[140:143], a[68:71], v[92:95]
  s_mov_b64 exec, s[80:81]
  buffer_load_dwordx4 v11, s[4:7], s48 offen offset:1024 sc1 lds
  s_mov_b64 exec, -1
  s_add_u32 s48, s48, 7680
  v_mfma_f32_16x16x32_bf16 v[96:99], a[72:75], a[68:71], v[96:99]
  ds_read_b128 a[32:35], v233 offset:1024
  v_mfma_f32_16x16x32_bf16 v[100:103], a[68:71], a[76:79], v[100:103]
  ds_read_b128 a[36:39], v233 offset:4096
  s_waitcnt vmcnt(18)
  s_waitcnt lgkmcnt(6)
  v_mfma_f32_16x16x32_bf16 v[32:35], a[0:3], a[144:147], v[32:35]
  v_mfma_f32_16x16x32_bf16 v[64:67], a[0:3], a[148:151], v[64:67]
  ds_read_b128 a[40:43], v3 offset:8192
  v_mfma_f32_16x16x32_bf16 v[36:39], a[4:7], a[144:147], v[36:39]
  ds_read_b128 a[44:47], v3 offset:9216
  v_mfma_f32_16x16x32_bf16 v[68:71], a[4:7], a[148:151], v[68:71]
  buffer_load_dwordx4 a[184:187], v2, s[4:7], s46 offen sc1
  v_mfma_f32_16x16x32_bf16 v[40:43], a[8:11], a[144:147], v[40:43]
  v_mfma_f32_16x16x32_bf16 v[72:75], a[8:11], a[148:151], v[72:75]
  ds_read_b128 a[48:51], v3 offset:10240
  v_mfma_f32_16x16x32_bf16 v[44:47], a[12:15], a[144:147], v[44:47]
  ds_read_b128 a[52:55], v3 offset:11264
  v_mfma_f32_16x16x32_bf16 v[76:79], a[12:15], a[148:151], v[76:79]
  buffer_load_dwordx4 a[188:191], v8, s[4:7], s46 offen sc1
  s_add_u32 s46, s46, 1024
  s_waitcnt lgkmcnt(4)
  v_mfma_f32_16x16x32_bf16 v[48:51], a[16:19], a[144:147], v[48:51]
  ds_read_b128 a[56:59], v3 offset:12288
  v_mfma_f32_16x16x32_bf16 v[80:83], a[16:19], a[148:151], v[80:83]
  v_mfma_f32_16x16x32_bf16 v[52:55], a[144:147], a[20:23], v[52:55]
  ds_read_b128 a[60:63], v3 offset:13312
  v_mfma_f32_16x16x32_bf16 v[84:87], a[148:151], a[20:23], v[84:87]
  s_add_u32 m0, s50, 131072
  s_nop 0
  buffer_load_dwordx4 v10, s[4:7], s48 offen sc1 lds
  v_mfma_f32_16x16x32_bf16 v[56:59], a[144:147], a[24:27], v[56:59]
  ds_read_b128 a[64:67], v3 offset:14336
  v_mfma_f32_16x16x32_bf16 v[88:91], a[148:151], a[24:27], v[88:91]
  v_mfma_f32_16x16x32_bf16 v[60:63], a[144:147], a[28:31], v[60:63]
  ds_read_b128 a[68:71], v3 offset:15360
  v_mfma_f32_16x16x32_bf16 v[92:95], a[148:151], a[28:31], v[92:95]
  s_mov_b64 exec, s[80:81]
  buffer_load_dwordx4 v11, s[4:7], s48 offen offset:1024 sc1 lds
  s_mov_b64 exec, -1
  s_add_u32 s48, s48, 7680
  v_mfma_f32_16x16x32_bf16 v[96:99], a[32:35], a[28:31], v[96:99]
  ds_read_b128 a[72:75], v233 offset:9216
  v_mfma_f32_16x16x32_bf16 v[100:103], a[28:31], a[36:39], v[100:103]
  ds_read_b128 a[76:79], v233 offset:12288
  s_waitcnt vmcnt(18)
  s_waitcnt lgkmcnt(6)
  v_mfma_f32_16x16x32_bf16 v[32:35], a[40:43], a[152:155], v[32:35]
  v_mfma_f32_16x16x32_bf16 v[64:67], a[40:43], a[156:159], v[64:67]
  v_mfma_f32_16x16x32_bf16 v[36:39], a[44:47], a[152:155], v[36:39]
  s_barrier
  v_mfma_f32_16x16x32_bf16 v[68:71], a[44:47], a[156:159], v[68:71]
  ds_read_b128 a[0:3], v3 offset:16384
  v_mfma_f32_16x16x32_bf16 v[40:43], a[48:51], a[152:155], v[40:43]
  ds_read_b128 a[4:7], v3 offset:17408
  v_mfma_f32_16x16x32_bf16 v[72:75], a[48:51], a[156:159], v[72:75]
  buffer_load_dwordx4 a[192:195], v2, s[4:7], s46 offen sc1
  v_mfma_f32_16x16x32_bf16 v[44:47], a[52:55], a[152:155], v[44:47]
  ds_read_b128 a[8:11], v3 offset:18432
  v_mfma_f32_16x16x32_bf16 v[76:79], a[52:55], a[156:159], v[76:79]
  ds_read_b128 a[12:15], v3 offset:19456
  s_waitcnt lgkmcnt(4)
  v_mfma_f32_16x16x32_bf16 v[48:51], a[56:59], a[152:155], v[48:51]
  buffer_load_dwordx4 a[196:199], v8, s[4:7], s46 offen sc1
  s_add_u32 s46, s46, 1024
  v_mfma_f32_16x16x32_bf16 v[80:83], a[56:59], a[156:159], v[80:83]
  v_mfma_f32_16x16x32_bf16 v[52:55], a[152:155], a[60:63], v[52:55]
  ds_read_b128 a[16:19], v3 offset:20480
  v_mfma_f32_16x16x32_bf16 v[84:87], a[156:159], a[60:63], v[84:87]
  ds_read_b128 a[20:23], v3 offset:21504
  v_mfma_f32_16x16x32_bf16 v[56:59], a[152:155], a[64:67], v[56:59]
  s_add_u32 m0, s50, 139264
  s_nop 0
  buffer_load_dwordx4 v10, s[4:7], s48 offen sc1 lds
  v_mfma_f32_16x16x32_bf16 v[88:91], a[156:159], a[64:67], v[88:91]
  ds_read_b128 a[24:27], v3 offset:22528
  v_mfma_f32_16x16x32_bf16 v[60:63], a[152:155], a[68:71], v[60:63]
  ds_read_b128 a[28:31], v3 offset:23552
  v_mfma_f32_16x16x32_bf16 v[92:95], a[156:159], a[68:71], v[92:95]
  s_mov_b64 exec, s[80:81]
  buffer_load_dwordx4 v11, s[4:7], s48 offen offset:1024 sc1 lds
  s_mov_b64 exec, -1
  s_add_u32 s48, s48, 7680
  v_mfma_f32_16x16x32_bf16 v[96:99], a[72:75], a[68:71], v[96:99]
  ds_read_b128 a[32:35], v233 offset:17408
  v_mfma_f32_16x16x32_bf16 v[100:103], a[68:71], a[76:79], v[100:103]
  ds_read_b128 a[36:39], v233 offset:20480
  s_waitcnt vmcnt(18)
  s_waitcnt lgkmcnt(6)
  v_mfma_f32_16x16x32_bf16 v[32:35], a[0:3], a[160:163], v[32:35]
  v_mfma_f32_16x16x32_bf16 v[64:67], a[0:3], a[164:167], v[64:67]
  ds_read_b128 a[40:43], v3 offset:24576
  v_mfma_f32_16x16x32_bf16 v[36:39], a[4:7], a[160:163], v[36:39]
  ds_read_b128 a[44:47], v3 offset:25600
  v_mfma_f32_16x16x32_bf16 v[68:71], a[4:7], a[164:167], v[68:71]
  buffer_load_dwordx4 a[200:203], v2, s[4:7], s46 offen sc1
  v_mfma_f32_16x16x32_bf16 v[40:43], a[8:11], a[160:163], v[40:43]
  v_mfma_f32_16x16x32_bf16 v[72:75], a[8:11], a[164:167], v[72:75]
  ds_read_b128 a[48:51], v3 offset:26624
  v_mfma_f32_16x16x32_bf16 v[44:47], a[12:15], a[160:163], v[44:47]
  ds_read_b128 a[52:55], v3 offset:27648
  v_mfma_f32_16x16x32_bf16 v[76:79], a[12:15], a[164:167], v[76:79]
  buffer_load_dwordx4 a[204:207], v8, s[4:7], s46 offen sc1
  s_add_u32 s46, s46, 1024
  s_waitcnt lgkmcnt(4)
  v_mfma_f32_16x16x32_bf16 v[48:51], a[16:19], a[160:163], v[48:51]
  ds_read_b128 a[56:59], v3 offset:28672
  v_mfma_f32_16x16x32_bf16 v[80:83], a[16:19], a[164:167], v[80:83]
  v_mfma_f32_16x16x32_bf16 v[52:55], a[160:163], a[20:23], v[52:55]
  ds_read_b128 a[60:63], v3 offset:29696
  v_mfma_f32_16x16x32_bf16 v[84:87], a[164:167], a[20:23], v[84:87]
  s_add_u32 m0, s50, 147456
  s_nop 0
  buffer_load_dwordx4 v10, s[4:7], s48 offen sc1 lds
  v_mfma_f32_16x16x32_bf16 v[56:59], a[160:163], a[24:27], v[56:59]
  ds_read_b128 a[64:67], v3 offset:30720
  v_mfma_f32_16x16x32_bf16 v[88:91], a[164:167], a[24:27], v[88:91]
  v_mfma_f32_16x16x32_bf16 v[60:63], a[160:163], a[28:31], v[60:63]
  ds_read_b128 a[68:71], v3 offset:31744
  v_mfma_f32_16x16x32_bf16 v[92:95], a[164:167], a[28:31], v[92:95]
  s_mov_b64 exec, s[80:81]
  buffer_load_dwordx4 v11, s[4:7], s48 offen offset:1024 sc1 lds
  s_mov_b64 exec, -1
  s_add_u32 s48, s48, 7680
  v_mfma_f32_16x16x32_bf16 v[96:99], a[32:35], a[28:31], v[96:99]
  ds_read_b128 a[72:75], v233 offset:25600
  v_mfma_f32_16x16x32_bf16 v[100:103], a[28:31], a[36:39], v[100:103]
  ds_read_b128 a[76:79], v233 offset:28672
  s_waitcnt vmcnt(18)
  s_waitcnt lgkmcnt(6)
  v_mfma_f32_16x16x32_bf16 v[32:35], a[40:43], a[168:171], v[32:35]
  v_mfma_f32_16x16x32_bf16 v[64:67], a[40:43], a[172:175], v[64:67]
  v_mfma_f32_16x16x32_bf16 v[36:39], a[44:47], a[168:171], v[36:39]
  s_barrier
  v_mfma_f32_16x16x32_bf16 v[68:71], a[44:47], a[172:175], v[68:71]
  ds_read_b128 a[0:3], v3 offset:32768
  v_mfma_f32_16x16x32_bf16 v[40:43], a[48:51], a[168:171], v[40:43]
  ds_read_b128 a[4:7], v3 offset:33792
  v_mfma_f32_16x16x32_bf16 v[72:75], a[48:51], a[172:175], v[72:75]
  buffer_load_dwordx4 a[208:211], v2, s[4:7], s46 offen sc1
  v_mfma_f32_16x16x32_bf16 v[44:47], a[52:55], a[168:171], v[44:47]
  ds_read_b128 a[8:11], v3 offset:34816
  v_mfma_f32_16x16x32_bf16 v[76:79], a[52:55], a[172:175], v[76:79]
  ds_read_b128 a[12:15], v3 offset:35840
  s_waitcnt lgkmcnt(4)
  v_mfma_f32_16x16x32_bf16 v[48:51], a[56:59], a[168:171], v[48:51]
  buffer_load_dwordx4 a[212:215], v8, s[4:7], s46 offen sc1
  s_add_u32 s46, s46, 1024
  v_mfma_f32_16x16x32_bf16 v[80:83], a[56:59], a[172:175], v[80:83]
  v_mfma_f32_16x16x32_bf16 v[52:55], a[168:171], a[60:63], v[52:55]
  ds_read_b128 a[16:19], v3 offset:36864
  v_mfma_f32_16x16x32_bf16 v[84:87], a[172:175], a[60:63], v[84:87]
  ds_read_b128 a[20:23], v3 offset:37888
  v_mfma_f32_16x16x32_bf16 v[56:59], a[168:171], a[64:67], v[56:59]
  s_add_u32 m0, s50, 155648
  s_nop 0
  buffer_load_dwordx4 v10, s[4:7], s48 offen sc1 lds
  v_mfma_f32_16x16x32_bf16 v[88:91], a[172:175], a[64:67], v[88:91]
  ds_read_b128 a[24:27], v3 offset:38912
  v_mfma_f32_16x16x32_bf16 v[60:63], a[168:171], a[68:71], v[60:63]
  ds_read_b128 a[28:31], v3 offset:39936
  v_mfma_f32_16x16x32_bf16 v[92:95], a[172:175], a[68:71], v[92:95]
  s_mov_b64 exec, s[80:81]
  buffer_load_dwordx4 v11, s[4:7], s48 offen offset:1024 sc1 lds
  s_mov_b64 exec, -1
  s_add_u32 s48, s48, 7680
  v_mfma_f32_16x16x32_bf16 v[96:99], a[72:75], a[68:71], v[96:99]
  ds_read_b128 a[32:35], v233 offset:33792
  v_mfma_f32_16x16x32_bf16 v[100:103], a[68:71], a[76:79], v[100:103]
  ds_read_b128 a[36:39], v233 offset:36864
  s_waitcnt vmcnt(18)
  s_waitcnt lgkmcnt(6)
  v_mfma_f32_16x16x32_bf16 v[32:35], a[0:3], a[176:179], v[32:35]
  v_mfma_f32_16x16x32_bf16 v[64:67], a[0:3], a[180:183], v[64:67]
  ds_read_b128 a[40:43], v3 offset:40960
  v_mfma_f32_16x16x32_bf16 v[36:39], a[4:7], a[176:179], v[36:39]
  ds_read_b128 a[44:47], v3 offset:41984
  v_mfma_f32_16x16x32_bf16 v[68:71], a[4:7], a[180:183], v[68:71]
  v_mfma_f32_16x16x32_bf16 v[40:43], a[8:11], a[176:179], v[40:43]
  buffer_load_dwordx4 a[216:219], v2, s[4:7], s46 offen sc1
  v_mfma_f32_16x16x32_bf16 v[72:75], a[8:11], a[180:183], v[72:75]
  ds_read_b128 a[48:51], v3 offset:43008
  v_mfma_f32_16x16x32_bf16 v[44:47], a[12:15], a[176:179], v[44:47]
  v_mfma_f32_16x16x32_bf16 v[76:79], a[12:15], a[180:183], v[76:79]
  ds_read_b128 a[52:55], v3 offset:44032
  s_waitcnt lgkmcnt(4)
  v_mfma_f32_16x16x32_bf16 v[48:51], a[16:19], a[176:179], v[48:51]
  buffer_load_dwordx4 a[220:223], v8, s[4:7], s46 offen sc1
  s_add_u32 s46, s46, 1024
  v_mfma_f32_16x16x32_bf16 v[80:83], a[16:19], a[180:183], v[80:83]
  v_mfma_f32_16x16x32_bf16 v[52:55], a[176:179], a[20:23], v[52:55]
  ds_read_b128 a[56:59], v3 offset:45056
  v_mfma_f32_16x16x32_bf16 v[84:87], a[180:183], a[20:23], v[84:87]
  ds_read_b128 a[60:63], v3 offset:46080
  v_mfma_f32_16x16x32_bf16 v[56:59], a[176:179], a[24:27], v[56:59]
  v_mfma_f32_16x16x32_bf16 v[88:91], a[180:183], a[24:27], v[88:91]
  ds_read_b128 a[64:67], v3 offset:47104
  v_mfma_f32_16x16x32_bf16 v[60:63], a[176:179], a[28:31], v[60:63]
  ds_read_b128 a[68:71], v3 offset:48128
  v_mfma_f32_16x16x32_bf16 v[92:95], a[180:183], a[28:31], v[92:95]
  v_mfma_f32_16x16x32_bf16 v[96:99], a[32:35], a[28:31], v[96:99]
  ds_read_b128 a[72:75], v233 offset:41984
  v_mfma_f32_16x16x32_bf16 v[100:103], a[28:31], a[36:39], v[100:103]
  ds_read_b128 a[76:79], v233 offset:45056
  s_waitcnt vmcnt(16)
  s_waitcnt lgkmcnt(6)
  v_mfma_f32_16x16x32_bf16 v[32:35], a[40:43], a[184:187], v[32:35]
  v_mfma_f32_16x16x32_bf16 v[64:67], a[40:43], a[188:191], v[64:67]
  v_mfma_f32_16x16x32_bf16 v[36:39], a[44:47], a[184:187], v[36:39]
  s_barrier
  v_mfma_f32_16x16x32_bf16 v[68:71], a[44:47], a[188:191], v[68:71]
  ds_read_b128 a[0:3], v3 offset:49152
  v_mfma_f32_16x16x32_bf16 v[40:43], a[48:51], a[184:187], v[40:43]
  ds_read_b128 a[4:7], v3 offset:50176
  v_mfma_f32_16x16x32_bf16 v[72:75], a[48:51], a[188:191], v[72:75]
  buffer_load_dwordx4 a[224:227], v2, s[4:7], s46 offen sc1
  v_mfma_f32_16x16x32_bf16 v[44:47], a[52:55], a[184:187], v[44:47]
  ds_read_b128 a[8:11], v3 offset:51200
  v_mfma_f32_16x16x32_bf16 v[76:79], a[52:55], a[188:191], v[76:79]
  ds_read_b128 a[12:15], v3 offset:52224
  s_waitcnt lgkmcnt(4)
  v_mfma_f32_16x16x32_bf16 v[48:51], a[56:59], a[184:187], v[48:51]
  buffer_load_dwordx4 a[228:231], v8, s[4:7], s46 offen sc1
  s_add_u32 s46, s46, 1024
  v_mfma_f32_16x16x32_bf16 v[80:83], a[56:59], a[188:191], v[80:83]
  v_mfma_f32_16x16x32_bf16 v[52:55], a[184:187], a[60:63], v[52:55]
  ds_read_b128 a[16:19], v3 offset:53248
  v_mfma_f32_16x16x32_bf16 v[84:87], a[188:191], a[60:63], v[84:87]
  ds_read_b128 a[20:23], v3 offset:54272
  v_mfma_f32_16x16x32_bf16 v[56:59], a[184:187], a[64:67], v[56:59]
  s_add_u32 m0, s44, 0
  s_nop 0
  buffer_load_dwordx4 v5, s[4:7], s58 offen offset:0 sc1 lds
  v_mfma_f32_16x16x32_bf16 v[88:91], a[188:191], a[64:67], v[88:91]
  ds_read_b128 a[24:27], v3 offset:55296
  v_mfma_f32_16x16x32_bf16 v[60:63], a[184:187], a[68:71], v[60:63]
  ds_read_b128 a[28:31], v3 offset:56320
  v_mfma_f32_16x16x32_bf16 v[92:95], a[188:191], a[68:71], v[92:95]
  buffer_load_dwordx4 v5, s[4:7], s58 offen offset:1024 sc1 lds
  v_mfma_f32_16x16x32_bf16 v[96:99], a[72:75], a[68:71], v[96:99]
  ds_read_b128 a[32:35], v233 offset:50176
  v_mfma_f32_16x16x32_bf16 v[100:103], a[68:71], a[76:79], v[100:103]
  ds_read_b128 a[36:39], v233 offset:53248
  s_waitcnt vmcnt(16)
  s_waitcnt lgkmcnt(6)
  v_mfma_f32_16x16x32_bf16 v[32:35], a[0:3], a[192:195], v[32:35]
  v_mfma_f32_16x16x32_bf16 v[64:67], a[0:3], a[196:199], v[64:67]
  ds_read_b128 a[40:43], v3 offset:57344
  v_mfma_f32_16x16x32_bf16 v[36:39], a[4:7], a[192:195], v[36:39]
  ds_read_b128 a[44:47], v3 offset:58368
  v_mfma_f32_16x16x32_bf16 v[68:71], a[4:7], a[196:199], v[68:71]
  buffer_load_dwordx4 a[232:235], v2, s[4:7], s46 offen sc1
  v_mfma_f32_16x16x32_bf16 v[40:43], a[8:11], a[192:195], v[40:43]
  v_mfma_f32_16x16x32_bf16 v[72:75], a[8:11], a[196:199], v[72:75]
  ds_read_b128 a[48:51], v3 offset:59392
  v_mfma_f32_16x16x32_bf16 v[44:47], a[12:15], a[192:195], v[44:47]
  ds_read_b128 a[52:55], v3 offset:60416
  v_mfma_f32_16x16x32_bf16 v[76:79], a[12:15], a[196:199], v[76:79]
  buffer_load_dwordx4 a[236:239], v8, s[4:7], s46 offen sc1
  s_add_u32 s46, s46, 1024
  s_waitcnt lgkmcnt(4)
  v_mfma_f32_16x16x32_bf16 v[48:51], a[16:19], a[192:195], v[48:51]
  ds_read_b128 a[56:59], v3 offset:61440
  v_mfma_f32_16x16x32_bf16 v[80:83], a[16:19], a[196:199], v[80:83]
  v_mfma_f32_16x16x32_bf16 v[52:55], a[192:195], a[20:23], v[52:55]
  ds_read_b128 a[60:63], v3 offset:62464
  v_mfma_f32_16x16x32_bf16 v[84:87], a[196:199], a[20:23], v[84:87]
  buffer_load_dwordx4 v5, s[4:7], s58 offen offset:2048 sc1 lds
  v_mfma_f32_16x16x32_bf16 v[56:59], a[192:195], a[24:27], v[56:59]
  ds_read_b128 a[64:67], v3 offset:63488
  v_mfma_f32_16x16x32_bf16 v[88:91], a[196:199], a[24:27], v[88:91]
  v_mfma_f32_16x16x32_bf16 v[60:63], a[192:195], a[28:31], v[60:63]
  ds_read_b128 a[68:71], v3 offset:64512
  v_mfma_f32_16x16x32_bf16 v[92:95], a[196:199], a[28:31], v[92:95]
  buffer_load_dwordx4 v5, s[4:7], s58 offen offset:3072 sc1 lds
  v_mfma_f32_16x16x32_bf16 v[96:99], a[32:35], a[28:31], v[96:99]
  ds_read_b128 a[72:75], v233 offset:58368
  v_mfma_f32_16x16x32_bf16 v[100:103], a[28:31], a[36:39], v[100:103]
  ds_read_b128 a[76:79], v233 offset:61440
  s_waitcnt vmcnt(16)
  s_waitcnt lgkmcnt(6)
  v_mfma_f32_16x16x32_bf16 v[32:35], a[40:43], a[200:203], v[32:35]
  v_mfma_f32_16x16x32_bf16 v[64:67], a[40:43], a[204:207], v[64:67]
  v_mfma_f32_16x16x32_bf16 v[36:39], a[44:47], a[200:203], v[36:39]
  s_barrier
  v_mfma_f32_16x16x32_bf16 v[68:71], a[44:47], a[204:207], v[68:71]
  ds_read_b128 a[0:3], v4 offset:0
  v_mfma_f32_16x16x32_bf16 v[40:43], a[48:51], a[200:203], v[40:43]
  ds_read_b128 a[4:7], v4 offset:1024
  v_mfma_f32_16x16x32_bf16 v[72:75], a[48:51], a[204:207], v[72:75]
  s_add_u32 m0, s45, 0
  s_nop 0
  buffer_load_dwordx4 v6, s[4:7], s58 offen sc1 lds
  s_add_u32 s58, s58, 20480
  v_mfma_f32_16x16x32_bf16 v[44:47], a[52:55], a[200:203], v[44:47]
  ds_read_b128 a[8:11], v4 offset:2048
  v_mfma_f32_16x16x32_bf16 v[76:79], a[52:55], a[204:207], v[76:79]
  ds_read_b128 a[12:15], v4 offset:3072
  s_waitcnt lgkmcnt(4)
  v_mfma_f32_16x16x32_bf16 v[48:51], a[56:59], a[200:203], v[48:51]
  s_add_u32 m0, s44, 20480
  s_nop 0
  buffer_load_dwordx4 v5, s[4:7], s58 offen offset:0 sc1 lds
  v_mfma_f32_16x16x32_bf16 v[80:83], a[56:59], a[204:207], v[80:83]
  ds_read_b128 a[16:19], v4 offset:4096
  v_mfma_f32_16x16x32_bf16 v[52:55], a[200:203], a[60:63], v[52:55]
  ds_read_b128 a[20:23], v4 offset:5120
  v_mfma_f32_16x16x32_bf16 v[84:87], a[204:207], a[60:63], v[84:87]
  buffer_load_dwordx4 v5, s[4:7], s58 offen offset:1024 sc1 lds
  v_mfma_f32_16x16x32_bf16 v[56:59], a[200:203], a[64:67], v[56:59]
  ds_read_b128 a[24:27], v4 offset:6144
  v_mfma_f32_16x16x32_bf16 v[88:91], a[204:207], a[64:67], v[88:91]
  ds_read_b128 a[28:31], v4 offset:7168
  v_mfma_f32_16x16x32_bf16 v[60:63], a[200:203], a[68:71], v[60:63]
  buffer_load_dwordx4 v5, s[4:7], s58 offen offset:2048 sc1 lds
  v_mfma_f32_16x16x32_bf16 v[92:95], a[204:207], a[68:71], v[92:95]
  ds_read_b128 a[32:35], v234 offset:1024
  v_mfma_f32_16x16x32_bf16 v[96:99], a[72:75], a[68:71], v[96:99]
  ds_read_b128 a[36:39], v234 offset:4096
  v_mfma_f32_16x16x32_bf16 v[100:103], a[68:71], a[76:79], v[100:103]
  buffer_load_dwordx4 v5, s[4:7], s58 offen offset:3072 sc1 lds
  s_waitcnt vmcnt(17)
  s_waitcnt lgkmcnt(6)
  v_mfma_f32_16x16x32_bf16 v[32:35], a[0:3], a[208:211], v[32:35]
  v_mfma_f32_16x16x32_bf16 v[64:67], a[0:3], a[212:215], v[64:67]
  ds_read_b128 a[40:43], v4 offset:8192
  v_mfma_f32_16x16x32_bf16 v[36:39], a[4:7], a[208:211], v[36:39]
  ds_read_b128 a[44:47], v4 offset:9216
  v_mfma_f32_16x16x32_bf16 v[68:71], a[4:7], a[212:215], v[68:71]
  s_add_u32 m0, s45, 20480
  s_nop 0
  buffer_load_dwordx4 v6, s[4:7], s58 offen sc1 lds
  s_add_u32 s58, s58, 20480
  v_mfma_f32_16x16x32_bf16 v[40:43], a[8:11], a[208:211], v[40:43]
  v_mfma_f32_16x16x32_bf16 v[72:75], a[8:11], a[212:215], v[72:75]
  ds_read_b128 a[48:51], v4 offset:10240
  v_mfma_f32_16x16x32_bf16 v[44:47], a[12:15], a[208:211], v[44:47]
  ds_read_b128 a[52:55], v4 offset:11264
  v_mfma_f32_16x16x32_bf16 v[76:79], a[12:15], a[212:215], v[76:79]
  s_add_u32 m0, s44, 40960
  s_nop 0
  buffer_load_dwordx4 v5, s[4:7], s58 offen offset:0 sc1 lds
  s_waitcnt lgkmcnt(4)
  v_mfma_f32_16x16x32_bf16 v[48:51], a[16:19], a[208:211], v[48:51]
  ds_read_b128 a[56:59], v4 offset:12288
  v_mfma_f32_16x16x32_bf16 v[80:83], a[16:19], a[212:215], v[80:83]
  v_mfma_f32_16x16x32_bf16 v[52:55], a[208:211], a[20:23], v[52:55]
  ds_read_b128 a[60:63], v4 offset:13312
  v_mfma_f32_16x16x32_bf16 v[84:87], a[212:215], a[20:23], v[84:87]
  buffer_load_dwordx4 v5, s[4:7], s58 offen offset:1024 sc1 lds
  v_mfma_f32_16x16x32_bf16 v[56:59], a[208:211], a[24:27], v[56:59]
  ds_read_b128 a[64:67], v4 offset:14336
  v_mfma_f32_16x16x32_bf16 v[88:91], a[212:215], a[24:27], v[88:91]
  v_mfma_f32_16x16x32_bf16 v[60:63], a[208:211], a[28:31], v[60:63]
  ds_read_b128 a[68:71], v4 offset:15360
  v_mfma_f32_16x16x32_bf16 v[92:95], a[212:215], a[28:31], v[92:95]
  buffer_load_dwordx4 v5, s[4:7], s58 offen offset:2048 sc1 lds
  v_mfma_f32_16x16x32_bf16 v[96:99], a[32:35], a[28:31], v[96:99]
  ds_read_b128 a[72:75], v234 offset:9216
  v_mfma_f32_16x16x32_bf16 v[100:103], a[28:31], a[36:39], v[100:103]
  ds_read_b128 a[76:79], v234 offset:12288
  s_waitcnt vmcnt(17)
  s_waitcnt lgkmcnt(6)
  v_mfma_f32_16x16x32_bf16 v[32:35], a[40:43], a[216:219], v[32:35]
  v_mfma_f32_16x16x32_bf16 v[64:67], a[40:43], a[220:223], v[64:67]
  v_mfma_f32_16x16x32_bf16 v[36:39], a[44:47], a[216:219], v[36:39]
  s_barrier
  v_mfma_f32_16x16x32_bf16 v[68:71], a[44:47], a[220:223], v[68:71]
  ds_read_b128 a[0:3], v4 offset:16384
  v_mfma_f32_16x16x32_bf16 v[40:43], a[48:51], a[216:219], v[40:43]
  ds_read_b128 a[4:7], v4 offset:17408
  v_mfma_f32_16x16x32_bf16 v[72:75], a[48:51], a[220:223], v[72:75]
  buffer_load_dwordx4 v5, s[4:7], s58 offen offset:3072 sc1 lds
  v_mfma_f32_16x16x32_bf16 v[44:47], a[52:55], a[216:219], v[44:47]
  ds_read_b128 a[8:11], v4 offset:18432
  v_mfma_f32_16x16x32_bf16 v[76:79], a[52:55], a[220:223], v[76:79]
  ds_read_b128 a[12:15], v4 offset:19456
  s_waitcnt lgkmcnt(4)
  v_mfma_f32_16x16x32_bf16 v[48:51], a[56:59], a[216:219], v[48:51]
  s_add_u32 m0, s45, 40960
  s_nop 0
  buffer_load_dwordx4 v6, s[4:7], s58 offen sc1 lds
  s_add_u32 s58, s58, 20480
  v_mfma_f32_16x16x32_bf16 v[80:83], a[56:59], a[220:223], v[80:83]
  v_mfma_f32_16x16x32_bf16 v[52:55], a[216:219], a[60:63], v[52:55]
  ds_read_b128 a[16:19], v4 offset:20480
  v_mfma_f32_16x16x32_bf16 v[84:87], a[220:223], a[60:63], v[84:87]
  ds_read_b128 a[20:23], v4 offset:21504
  v_mfma_f32_16x16x32_bf16 v[56:59], a[216:219], a[64:67], v[56:59]
  s_add_u32 m0, s44, 61440
  s_nop 0
  buffer_load_dwordx4 v5, s[4:7], s58 offen offset:0 sc1 lds
  v_mfma_f32_16x16x32_bf16 v[88:91], a[220:223], a[64:67], v[88:91]
  ds_read_b128 a[24:27], v4 offset:22528
  v_mfma_f32_16x16x32_bf16 v[60:63], a[216:219], a[68:71], v[60:63]
  ds_read_b128 a[28:31], v4 offset:23552
  v_mfma_f32_16x16x32_bf16 v[92:95], a[220:223], a[68:71], v[92:95]
  buffer_load_dwordx4 v5, s[4:7], s58 offen offset:1024 sc1 lds
  v_mfma_f32_16x16x32_bf16 v[96:99], a[72:75], a[68:71], v[96:99]
  ds_read_b128 a[32:35], v234 offset:17408
  v_mfma_f32_16x16x32_bf16 v[100:103], a[68:71], a[76:79], v[100:103]
  ds_read_b128 a[36:39], v234 offset:20480
  s_waitcnt vmcnt(19)
  s_waitcnt lgkmcnt(6)
  v_mfma_f32_16x16x32_bf16 v[32:35], a[0:3], a[224:227], v[32:35]
  v_mfma_f32_16x16x32_bf16 v[64:67], a[0:3], a[228:231], v[64:67]
  ds_read_b128 a[40:43], v4 offset:24576
  v_mfma_f32_16x16x32_bf16 v[36:39], a[4:7], a[224:227], v[36:39]
  ds_read_b128 a[44:47], v4 offset:25600
  v_mfma_f32_16x16x32_bf16 v[68:71], a[4:7], a[228:231], v[68:71]
  buffer_load_dwordx4 v5, s[4:7], s58 offen offset:2048 sc1 lds
  v_mfma_f32_16x16x32_bf16 v[40:43], a[8:11], a[224:227], v[40:43]
  v_mfma_f32_16x16x32_bf16 v[72:75], a[8:11], a[228:231], v[72:75]
  ds_read_b128 a[48:51], v4 offset:26624
  v_mfma_f32_16x16x32_bf16 v[44:47], a[12:15], a[224:227], v[44:47]
  ds_read_b128 a[52:55], v4 offset:27648
  v_mfma_f32_16x16x32_bf16 v[76:79], a[12:15], a[228:231], v[76:79]
  buffer_load_dwordx4 v5, s[4:7], s58 offen offset:3072 sc1 lds
  s_waitcnt lgkmcnt(4)
  v_mfma_f32_16x16x32_bf16 v[48:51], a[16:19], a[224:227], v[48:51]
  ds_read_b128 a[56:59], v4 offset:28672
  v_mfma_f32_16x16x32_bf16 v[80:83], a[16:19], a[228:231], v[80:83]
  v_mfma_f32_16x16x32_bf16 v[52:55], a[224:227], a[20:23], v[52:55]
  ds_read_b128 a[60:63], v4 offset:29696
  v_mfma_f32_16x16x32_bf16 v[84:87], a[228:231], a[20:23], v[84:87]
  s_add_u32 m0, s45, 61440
  s_nop 0
  buffer_load_dwordx4 v6, s[4:7], s58 offen sc1 lds
  s_add_u32 s58, s58, 20480
  v_mfma_f32_16x16x32_bf16 v[56:59], a[224:227], a[24:27], v[56:59]
  ds_read_b128 a[64:67], v4 offset:30720
  v_mfma_f32_16x16x32_bf16 v[88:91], a[228:231], a[24:27], v[88:91]
  v_mfma_f32_16x16x32_bf16 v[60:63], a[224:227], a[28:31], v[60:63]
  ds_read_b128 a[68:71], v4 offset:31744
  v_mfma_f32_16x16x32_bf16 v[92:95], a[228:231], a[28:31], v[92:95]
  s_add_u32 m0, s44, 81920
  s_nop 0
  buffer_load_dwordx4 v5, s[4:7], s58 offen offset:0 sc1 lds
  v_mfma_f32_16x16x32_bf16 v[96:99], a[32:35], a[28:31], v[96:99]
  ds_read_b128 a[72:75], v234 offset:25600
  v_mfma_f32_16x16x32_bf16 v[100:103], a[28:31], a[36:39], v[100:103]
  ds_read_b128 a[76:79], v234 offset:28672
  s_waitcnt vmcnt(19)
  s_waitcnt lgkmcnt(6)
  v_mfma_f32_16x16x32_bf16 v[32:35], a[40:43], a[232:235], v[32:35]
  v_mfma_f32_16x16x32_bf16 v[64:67], a[40:43], a[236:239], v[64:67]
  v_mfma_f32_16x16x32_bf16 v[36:39], a[44:47], a[232:235], v[36:39]
  v_mfma_f32_16x16x32_bf16 v[68:71], a[44:47], a[236:239], v[68:71]
  v_mfma_f32_16x16x32_bf16 v[40:43], a[48:51], a[232:235], v[40:43]
  buffer_load_dwordx4 v5, s[4:7], s58 offen offset:1024 sc1 lds
  v_mfma_f32_16x16x32_bf16 v[72:75], a[48:51], a[236:239], v[72:75]
  v_mfma_f32_16x16x32_bf16 v[44:47], a[52:55], a[232:235], v[44:47]
  s_branch WOVER_5
  .p2align 12
WARM_5:
  s_setpc_b64 s[94:95]
  s_nop 0
WOVER_5:
  v_mfma_f32_16x16x32_bf16 v[76:79], a[52:55], a[236:239], v[76:79]
  s_waitcnt lgkmcnt(0)
  v_mfma_f32_16x16x32_bf16 v[48:51], a[56:59], a[232:235], v[48:51]
  buffer_load_dwordx4 v5, s[4:7], s58 offen offset:2048 sc1 lds
  v_mfma_f32_16x16x32_bf16 v[80:83], a[56:59], a[236:239], v[80:83]
  v_mfma_f32_16x16x32_bf16 v[52:55], a[232:235], a[60:63], v[52:55]
  v_mfma_f32_16x16x32_bf16 v[84:87], a[236:239], a[60:63], v[84:87]
  v_mfma_f32_16x16x32_bf16 v[56:59], a[232:235], a[64:67], v[56:59]
  v_mfma_f32_16x16x32_bf16 v[88:91], a[236:239], a[64:67], v[88:91]
  buffer_load_dwordx4 v5, s[4:7], s58 offen offset:3072 sc1 lds
  v_mfma_f32_16x16x32_bf16 v[60:63], a[232:235], a[68:71], v[60:63]
  v_mfma_f32_16x16x32_bf16 v[92:95], a[236:239], a[68:71], v[92:95]
  v_mfma_f32_16x16x32_bf16 v[96:99], a[72:75], a[68:71], v[96:99]
  v_mfma_f32_16x16x32_bf16 v[100:103], a[68:71], a[76:79], v[100:103]
  s_add_u32 m0, s45, 81920
  s_nop 0
  buffer_load_dwordx4 v6, s[4:7], s58 offen sc1 lds
  s_add_u32 s58, s58, 20480
  v_mov_b32 v136, 0
  v_mov_b32 v137, 0
  v_cvt_pk_bf16_f32 v132, v72, v73
  v_cvt_pk_bf16_f32 v133, v74, v75
  v_cvt_pk_bf16_f32 v134, v76, v77
  v_cvt_pk_bf16_f32 v135, v78, v79
  v_cvt_pk_bf16_f32 v170, v80, v81
  v_cvt_pk_bf16_f32 v171, v82, v83
  v_cvt_pk_bf16_f32 v142, v84, v85
  v_cvt_pk_bf16_f32 v143, v86, v87
  v_cvt_pk_bf16_f32 v148, v88, v89
  v_cvt_pk_bf16_f32 v149, v90, v91
  v_cvt_pk_bf16_f32 v154, v92, v93
  v_cvt_pk_bf16_f32 v155, v94, v95
  v_permlane32_swap_b32 v170, v136
  v_permlane32_swap_b32 v171, v137
  ds_write_b64 v238, v[132:133] offset:39936
  ds_write_b64 v238, v[134:135] offset:40448
  ds_write_b64 v238, v[136:137] offset:40960
  ds_write_b64 v238, v[142:143] offset:41472
  ds_write_b64 v238, v[148:149] offset:41984
  ds_write_b64 v238, v[154:155] offset:42496
  v_cvt_pk_bf16_f32 v204, v96, v97
  v_cvt_pk_bf16_f32 v205, v98, v99
  v_cvt_pk_bf16_f32 v206, v100, v101
  v_cvt_pk_bf16_f32 v207, v102, v103
  ds_write_b64 v237, v[204:205] offset:36864
  ds_write_b64 v235, v[206:207] offset:38400
  v_mov_b32 v130, 0
  v_mov_b32 v131, 0
  v_cvt_pk_bf16_f32 v126, v40, v41
  v_cvt_pk_bf16_f32 v127, v42, v43
  v_cvt_pk_bf16_f32 v128, v44, v45
  v_cvt_pk_bf16_f32 v129, v46, v47
  v_cvt_pk_bf16_f32 v162, v48, v49
  v_cvt_pk_bf16_f32 v163, v50, v51
  v_cvt_pk_bf16_f32 v140, v52, v53
  v_cvt_pk_bf16_f32 v141, v54, v55
  v_cvt_pk_bf16_f32 v146, v56, v57
  v_cvt_pk_bf16_f32 v147, v58, v59
  v_cvt_pk_bf16_f32 v152, v60, v61
  v_cvt_pk_bf16_f32 v153, v62, v63
  v_permlane32_swap_b32 v162, v130
  v_permlane32_swap_b32 v163, v131
  s_waitcnt vmcnt(10)
  s_waitcnt lgkmcnt(0)
  s_barrier
  ds_read_b64 v[120:121], v238 offset:36864
  ds_read_b64 v[122:123], v238 offset:37376
  ds_read_b64 v[124:125], v238 offset:37888
  ds_read_b64 v[138:139], v238 offset:38400
  ds_read_b64 v[144:145], v238 offset:38912
  ds_read_b64 v[150:151], v238 offset:39424
  v_cvt_pk_bf16_f32 v164, v64, v65
  v_cvt_pk_bf16_f32 v165, v66, v67
  v_cvt_pk_bf16_f32 v168, v68, v69
  v_cvt_pk_bf16_f32 v169, v70, v71
  v_cndmask_b32 v166, 0, v168, s[42:43]
  v_cndmask_b32 v167, 0, v169, s[42:43]
  v_xor_b32 v168, v168, v166
  v_xor_b32 v169, v169, v167
  v_cvt_pk_bf16_f32 v156, v32, v33
  v_cvt_pk_bf16_f32 v157, v34, v35
  v_cvt_pk_bf16_f32 v160, v36, v37
  v_cvt_pk_bf16_f32 v161, v38, v39
  v_cndmask_b32 v158, 0, v160, s[42:43]
  v_cndmask_b32 v159, 0, v161, s[42:43]
  v_xor_b32 v160, v160, v158
  v_xor_b32 v161, v161, v159
  s_mov_b32 s51, 917504
  buffer_load_dword v231, v236, s[4:7], s51 offen sc1
  v_mfma_f32_16x16x32_bf16 v[176:179], v[132:135], v[164:167], v[12:15]
  v_mfma_f32_16x16x32_bf16 v[172:175], v[126:129], v[164:167], v[12:15]
  v_mfma_f32_16x16x32_bf16 v[184:187], v[134:137], v[168:171], v[12:15]
  v_mfma_f32_16x16x32_bf16 v[180:183], v[128:131], v[168:171], v[12:15]
  s_waitcnt lgkmcnt(0)
  v_mfma_f32_16x16x32_bf16 v[192:195], v[126:129], v[156:159], v[16:19]
  v_mfma_f32_16x16x32_bf16 v[188:191], v[120:123], v[156:159], v[16:19]
  v_mfma_f32_16x16x32_bf16 v[200:203], v[128:131], v[160:163], v[16:19]
  v_mfma_f32_16x16x32_bf16 v[196:199], v[122:125], v[160:163], v[16:19]
  s_mov_b32 s26, 1051011932
  s_mov_b32 s27, s26
  v_cndmask_b32 v204, v176, v172, s[40:41]
  v_cndmask_b32 v205, v177, v173, s[40:41]
  v_cndmask_b32 v206, v178, v174, s[40:41]
  v_cndmask_b32 v207, v179, v175, s[40:41]
  v_max3_f32 v220, v204, v205, v206
  v_max_f32 v220, v220, v207
  v_cndmask_b32 v208, v184, v180, s[40:41]
  v_cndmask_b32 v209, v185, v181, s[40:41]
  v_cndmask_b32 v210, v186, v182, s[40:41]
  v_cndmask_b32 v211, v187, v183, s[40:41]
  v_max3_f32 v222, v208, v209, v210
  v_max_f32 v222, v222, v211
  v_cndmask_b32 v212, v192, v188, s[40:41]
  v_cndmask_b32 v213, v193, v189, s[40:41]
  v_cndmask_b32 v214, v194, v190, s[40:41]
  v_cndmask_b32 v215, v195, v191, s[40:41]
  v_max3_f32 v224, v212, v213, v214
  v_max_f32 v224, v224, v215
  v_cndmask_b32 v216, v200, v196, s[40:41]
  v_cndmask_b32 v217, v201, v197, s[40:41]
  v_cndmask_b32 v218, v202, v198, s[40:41]
  v_cndmask_b32 v219, v203, v199, s[40:41]
  v_max3_f32 v226, v216, v217, v218
  v_max_f32 v226, v226, v219
  v_permlane32_swap_b32 v220, v222
  s_nop 0
  v_permlane32_swap_b32 v224, v226
  v_max_f32 v220, v220, v222
  v_max_f32 v224, v224, v226
  s_nop 1
  v_permlane16_swap_b32 v220, v224
  v_max_f32 v220, v220, v224
  v_mul_f32 v220, 3198495580, v220
  v_mov_b32 v224, v220
  s_nop 1
  v_permlane16_swap_b32 v220, v224
  v_mov_b32 v222, v220
  v_mov_b32 v226, v224
  s_nop 0
  v_permlane32_swap_b32 v220, v222
  v_permlane32_swap_b32 v224, v226
  v_pk_fma_f32 v[204:205], v[204:205], s[26:27], v[220:221] op_sel_hi:[1,1,0]
  v_pk_fma_f32 v[206:207], v[206:207], s[26:27], v[220:221] op_sel_hi:[1,1,0]
  v_pk_fma_f32 v[208:209], v[208:209], s[26:27], v[222:223] op_sel_hi:[1,1,0]
  v_pk_fma_f32 v[210:211], v[210:211], s[26:27], v[222:223] op_sel_hi:[1,1,0]
  v_pk_fma_f32 v[212:213], v[212:213], s[26:27], v[224:225] op_sel_hi:[1,1,0]
  v_pk_fma_f32 v[214:215], v[214:215], s[26:27], v[224:225] op_sel_hi:[1,1,0]
  v_pk_fma_f32 v[216:217], v[216:217], s[26:27], v[226:227] op_sel_hi:[1,1,0]
  v_pk_fma_f32 v[218:219], v[218:219], s[26:27], v[226:227] op_sel_hi:[1,1,0]
  v_exp_f32 v204, v204
  v_exp_f32 v205, v205
  v_exp_f32 v206, v206
  v_exp_f32 v207, v207
  v_exp_f32 v208, v208
  v_exp_f32 v209, v209
  v_exp_f32 v210, v210
  v_exp_f32 v211, v211
  v_exp_f32 v212, v212
  v_exp_f32 v213, v213
  v_exp_f32 v214, v214
  v_exp_f32 v215, v215
  v_exp_f32 v216, v216
  v_exp_f32 v217, v217
  v_exp_f32 v218, v218
  v_exp_f32 v219, v219
  v_pk_add_f32 v[220:221], v[204:205], v[206:207]
  v_pk_add_f32 v[222:223], v[208:209], v[210:211]
  v_pk_add_f32 v[224:225], v[212:213], v[214:215]
  v_pk_add_f32 v[226:227], v[216:217], v[218:219]
  v_add_f32 v220, v220, v221
  v_add_f32 v222, v222, v223
  v_add_f32 v224, v224, v225
  v_add_f32 v226, v226, v227
  v_permlane32_swap_b32 v220, v222
  s_nop 0
  v_permlane32_swap_b32 v224, v226
  v_add_f32 v220, v220, v222
  v_add_f32 v224, v224, v226
  s_nop 1
  v_permlane16_swap_b32 v220, v224
  v_add_f32 v220, v220, v224
  v_rcp_f32 v220, v220
  s_nop 0
  v_mov_b32 v224, v220
  s_nop 1
  v_permlane16_swap_b32 v220, v224
  v_mov_b32 v222, v220
  v_mov_b32 v226, v224
  s_nop 0
  v_permlane32_swap_b32 v220, v222
  v_permlane32_swap_b32 v224, v226
  v_pk_mul_f32 v[204:205], v[204:205], v[220:221] op_sel_hi:[1,0]
  v_pk_mul_f32 v[206:207], v[206:207], v[220:221] op_sel_hi:[1,0]
  v_pk_mul_f32 v[208:209], v[208:209], v[222:223] op_sel_hi:[1,0]
  v_pk_mul_f32 v[210:211], v[210:211], v[222:223] op_sel_hi:[1,0]
  v_pk_mul_f32 v[212:213], v[212:213], v[224:225] op_sel_hi:[1,0]
  v_pk_mul_f32 v[214:215], v[214:215], v[224:225] op_sel_hi:[1,0]
  v_pk_mul_f32 v[216:217], v[216:217], v[226:227] op_sel_hi:[1,0]
  v_pk_mul_f32 v[218:219], v[218:219], v[226:227] op_sel_hi:[1,0]
  v_cvt_pk_bf16_f32 v174, v204, v205
  v_cvt_pk_bf16_f32 v175, v206, v207
  v_cndmask_b32 v172, 0, v174, s[40:41]
  v_cndmask_b32 v173, 0, v175, s[40:41]
  v_xor_b32 v174, v174, v172
  v_xor_b32 v175, v175, v173
  v_cvt_pk_bf16_f32 v178, v208, v209
  v_cvt_pk_bf16_f32 v179, v210, v211
  v_cndmask_b32 v176, 0, v178, s[40:41]
  v_cndmask_b32 v177, 0, v179, s[40:41]
  v_xor_b32 v178, v178, v176
  v_xor_b32 v179, v179, v177
  v_cvt_pk_bf16_f32 v182, v212, v213
  v_cvt_pk_bf16_f32 v183, v214, v215
  v_cndmask_b32 v180, 0, v182, s[40:41]
  v_cndmask_b32 v181, 0, v183, s[40:41]
  v_xor_b32 v182, v182, v180
  v_xor_b32 v183, v183, v181
  v_cvt_pk_bf16_f32 v186, v216, v217
  v_cvt_pk_bf16_f32 v187, v218, v219
  v_cndmask_b32 v184, 0, v186, s[40:41]
  v_cndmask_b32 v185, 0, v187, s[40:41]
  v_xor_b32 v186, v186, v184
  v_xor_b32 v187, v187, v185
  v_mfma_f32_16x16x32_bf16 v[80:83], v[140:143], v[172:175], 0
  v_mfma_f32_16x16x32_bf16 v[84:87], v[146:149], v[172:175], 0
  v_mfma_f32_16x16x32_bf16 v[88:91], v[146:149], v[176:179], 0
  v_mfma_f32_16x16x32_bf16 v[92:95], v[152:155], v[176:179], 0
  v_mfma_f32_16x16x32_bf16 v[64:67], v[138:141], v[180:183], 0
  v_mfma_f32_16x16x32_bf16 v[68:71], v[144:147], v[180:183], 0
  v_mfma_f32_16x16x32_bf16 v[72:75], v[144:147], v[184:187], 0
  v_mfma_f32_16x16x32_bf16 v[76:79], v[150:153], v[184:187], 0
  s_nop 0
  v_cvt_pk_bf16_f32 v36, v80, v81
  v_cvt_pk_bf16_f32 v37, v82, v83
  v_cndmask_b32 v84, v88, v84, s[42:43]
  v_cndmask_b32 v85, v89, v85, s[42:43]
  v_cndmask_b32 v86, v90, v86, s[42:43]
  v_cndmask_b32 v87, v91, v87, s[42:43]
  v_cvt_pk_bf16_f32 v42, v92, v93
  v_cvt_pk_bf16_f32 v43, v94, v95
  v_cvt_pk_bf16_f32 v38, v84, v85
  v_cvt_pk_bf16_f32 v39, v86, v87
  buffer_store_dwordx4 v[36:39], v8, s[4:7], s52 offen sc0 sc1
  v_cvt_pk_bf16_f32 v32, v64, v65
  v_cvt_pk_bf16_f32 v33, v66, v67
  v_cndmask_b32 v68, v72, v68, s[42:43]
  v_cndmask_b32 v69, v73, v69, s[42:43]
  v_cndmask_b32 v70, v74, v70, s[42:43]
  v_cndmask_b32 v71, v75, v71, s[42:43]
  v_cvt_pk_bf16_f32 v40, v76, v77
  v_cvt_pk_bf16_f32 v41, v78, v79
  v_cvt_pk_bf16_f32 v34, v68, v69
  v_cvt_pk_bf16_f32 v35, v70, v71
  buffer_store_dwordx4 v[32:35], v2, s[4:7], s52 offen sc0 sc1
  v_permlane16_swap_b32 v40, v42
  v_permlane16_swap_b32 v41, v43
  buffer_store_dwordx4 v[40:43], v239, s[4:7], s52 offen offset:1024 sc0 sc1
  s_lshr_b32 s61, s49, 1
  ds_write_b128 v228, a[240:243] offset:0
  ds_write_b128 v228, a[244:247] offset:1024
  ds_read_b128 a[0:3], v2 offset:0
  ds_read_b128 a[4:7], v2 offset:1024
  ds_read_b128 a[8:11], v2 offset:2048
  ds_read_b128 a[12:15], v2 offset:3072
  ds_read_b128 a[16:19], v2 offset:4096
  ds_read_b128 a[20:23], v2 offset:5120
  ds_read_b128 a[24:27], v2 offset:6144
  ds_read_b128 a[28:31], v2 offset:7168
  ds_read_b128 a[32:35], v2 offset:8192
  ds_read_b128 a[36:39], v2 offset:9216
  ds_read_b128 a[40:43], v2 offset:10240
  ds_read_b128 a[44:47], v2 offset:11264
  ds_read_b128 a[48:51], v2 offset:12288
  ds_read_b128 a[52:55], v2 offset:13312
  ds_read_b128 a[56:59], v2 offset:14336
  ds_read_b128 a[60:63], v2 offset:15360
  ds_read_b128 a[64:67], v2 offset:16384
  ds_read_b128 a[68:71], v2 offset:17408
  ds_read_b128 a[72:75], v2 offset:18432
  ds_read_b128 a[76:79], v2 offset:19456
  ds_read_b128 a[80:83], v2 offset:20480
  ds_read_b128 a[84:87], v2 offset:21504
  ds_read_b128 a[88:91], v2 offset:22528
  ds_read_b128 a[92:95], v2 offset:23552
  ds_read_b128 a[96:99], v2 offset:24576
  ds_read_b128 a[100:103], v2 offset:25600
  ds_read_b128 a[104:107], v2 offset:26624
  ds_read_b128 a[108:111], v2 offset:27648
  ds_read_b128 a[112:115], v2 offset:28672
  ds_read_b128 a[116:119], v2 offset:29696
  ds_read_b128 a[120:123], v2 offset:30720
  ds_read_b128 a[124:127], v2 offset:31744
  ds_read_b128 a[128:131], v2 offset:32768
  ds_read_b128 a[132:135], v2 offset:33792
  ds_read_b128 a[136:139], v2 offset:34816
  ds_read_b128 a[140:143], v2 offset:35840
  ds_read_b128 a[144:147], v2 offset:36864
  ds_read_b128 a[148:151], v2 offset:37888
  ds_read_b128 a[152:155], v2 offset:38912
  ds_read_b128 a[156:159], v2 offset:39936
  s_mul_i32 s46, s54, 20480
  s_add_u32 s55, s46, 17825792
  s_add_u32 s46, s46, 14680064
  s_mul_i32 s26, s19, 2560
  s_add_u32 s55, s55, s26
  v_lshrrev_b32 v8, 5, v1
  v_lshlrev_b32 v8, 8, v8
  v_lshl_add_u32 v8, v26, 4, v8
  v_and_b32 v9, 16, v1
  v_cmp_eq_u32 vcc, 0, v9
  v_mov_b32 v9, 1073741824
  s_nop 0
  v_cndmask_b32_e64 v8, v9, v8, vcc
  v_lshlrev_b32 v10, 3, v1
  v_cndmask_b32 v9, v9, v10, s[42:43]
  s_lshl_b32 s47, s54, 3
  s_add_u32 s47, s47, s19
  s_lshl_b32 s47, s47, 7
  s_add_u32 s47, s47, 98304
  s_lshl_b32 s26, s61, 11
  s_lshl_b32 s27, s17, 7
  s_add_u32 s26, s26, s27
  s_add_u32 s26, s26, 229376
  s_waitcnt vmcnt(0)
  v_mov_b32 v20, s36
  v_mov_b32 v21, s36
  v_mov_b32 v22, s36
  v_mov_b32 v23, s36
  s_mov_b64 exec, 0xff
  buffer_store_dwordx4 v[20:23], v2, s[4:7], s26 offen sc0 sc1
  s_mov_b64 exec, -1
  s_lshl_b32 s28, s57, 11
  s_add_u32 s28, s28, 229376
  v_lshlrev_b32 v30, 7, v26
  v_lshl_add_u32 v30, v27, 2, v30
  v_cmp_eq_u32 vcc, s36, v231
  s_nop 0
  s_cmp_eq_u64 vcc, -1
  s_cbranch_scc1 W2OK_9
  s_mov_b32 s27, 400000
  buffer_load_dword v250, v236, s[4:7], s51 offen sc1
POLL_10:
  s_waitcnt vmcnt(0)
  v_cmp_eq_u32 vcc, s36, v250
  s_nop 0
  s_cmp_eq_u64 vcc, -1
  s_cbranch_scc1 W2OK_9
  buffer_load_dword v250, v236, s[4:7], s51 offen sc1
  s_sub_u32 s27, s27, 1
  s_cmp_lg_u32 s27, 0
  s_cbranch_scc1 POLL_10
W2OK_9:
  s_mul_i32 s26, s19, 320
  s_add_u32 s26, s26, 70656
  buffer_load_dwordx4 v[52:55], v28, s[4:7], s26 offen offset:0 sc1
  buffer_load_dwordx4 v[56:59], v28, s[4:7], s26 offen offset:16 sc1
  buffer_load_dwordx4 v[60:63], v28, s[4:7], s26 offen offset:128 sc1
  buffer_load_dwordx4 v[64:67], v28, s[4:7], s26 offen offset:144 sc1
  buffer_load_dwordx4 v[68:71], v29, s[4:7], s26 offen offset:256 sc1
  ds_read_b64_tr_b16 v[44:45], v230 offset:0
  ds_read_b64_tr_b16 v[46:47], v230 offset:512
  ds_read_b64_tr_b16 v[48:49], v230 offset:1024
  ds_read_b64_tr_b16 v[50:51], v230 offset:1536
  s_waitcnt lgkmcnt(0)
  buffer_store_dwordx4 v[44:47], v229, s[4:7], s79 offen offset:0 sc0 sc1
  buffer_store_dwordx4 v[48:51], v229, s[4:7], s79 offen offset:256 sc0 sc1
  s_mul_i32 s26, s19, 320
  s_add_u32 s26, s26, 75776
  buffer_load_dwordx4 v[12:15], v28, s[4:7], s26 offen offset:0 sc1
  buffer_load_dwordx4 v[16:19], v28, s[4:7], s26 offen offset:16 sc1
  buffer_load_dwordx4 v[20:23], v28, s[4:7], s26 offen offset:128 sc1
  buffer_load_dwordx4 v[92:95], v28, s[4:7], s26 offen offset:144 sc1
  buffer_load_dwordx4 v[96:99], v29, s[4:7], s26 offen offset:256 sc1
  s_add_u32 m0, s44, 143360
  s_nop 0
  buffer_load_dwordx4 v5, s[4:7], s59 offen offset:0 sc1 lds
  buffer_load_dwordx4 v5, s[4:7], s59 offen offset:1024 sc1 lds
  buffer_load_dwordx4 v5, s[4:7], s59 offen offset:2048 sc1 lds
  buffer_load_dwordx4 v5, s[4:7], s59 offen offset:3072 sc1 lds
  s_add_u32 m0, s45, 143360
  s_nop 0
  buffer_load_dwordx4 v6, s[4:7], s59 offen sc1 lds
  s_add_u32 s59, s59, 20480
  v_lshlrev_b32 v72, 16, v240
  v_and_b32 v73, 0xffff0000, v240
  v_lshlrev_b32 v74, 16, v241
  v_and_b32 v75, 0xffff0000, v241
  v_lshlrev_b32 v76, 16, v242
  v_and_b32 v77, 0xffff0000, v242
  v_lshlrev_b32 v78, 16, v243
  v_and_b32 v79, 0xffff0000, v243
  v_lshlrev_b32 v80, 16, v244
  v_and_b32 v81, 0xffff0000, v244
  v_lshlrev_b32 v82, 16, v245
  v_and_b32 v83, 0xffff0000, v245
  v_lshlrev_b32 v84, 16, v246
  v_and_b32 v85, 0xffff0000, v246
  v_lshlrev_b32 v86, 16, v247
  v_and_b32 v87, 0xffff0000, v247
  v_lshlrev_b32 v88, 16, v248
  v_and_b32 v89, 0xffff0000, v248
  v_lshlrev_b32 v90, 16, v249
  v_and_b32 v91, 0xffff0000, v249
  s_mov_b32 s27, 400000
  buffer_load_dword v250, v30, s[4:7], s28 offen sc1
POLL_11:
  s_waitcnt vmcnt(0)
  v_cmp_eq_u32 vcc, s36, v250
  s_nop 0
  s_cmp_eq_u64 vcc, -1
  s_cbranch_scc1 POK_12
  buffer_load_dword v250, v30, s[4:7], s28 offen sc1
  s_sub_u32 s27, s27, 1
  s_cmp_lg_u32 s27, 0
  s_cbranch_scc1 POLL_11
POK_12:
  s_add_u32 s56, s46, 0
  buffer_load_dwordx4 v[100:103], v2, s[4:7], s56 offen sc1
  s_add_u32 s56, s46, 1024
  buffer_load_dwordx4 v[104:107], v2, s[4:7], s56 offen sc1
  s_add_u32 s56, s46, 8192
  buffer_load_dwordx4 v[108:111], v2, s[4:7], s56 offen sc1
  s_add_u32 s56, s46, 9216
  buffer_load_dwordx4 v[112:115], v2, s[4:7], s56 offen sc1
  s_add_u32 s56, s46, 2048
  buffer_load_dwordx4 v[116:119], v2, s[4:7], s56 offen sc1
  s_add_u32 s56, s46, 10240
  buffer_load_dwordx4 v[120:123], v2, s[4:7], s56 offen sc1
  s_add_u32 s56, s46, 11264
  buffer_load_dwordx4 v[124:127], v2, s[4:7], s56 offen sc1
  s_add_u32 s56, s46, 3072
  buffer_load_dwordx4 v[128:131], v2, s[4:7], s56 offen sc1
  s_add_u32 s56, s46, 12288
  buffer_load_dwordx4 v[132:135], v2, s[4:7], s56 offen sc1
  s_add_u32 s56, s46, 13312
  buffer_load_dwordx4 v[136:139], v2, s[4:7], s56 offen sc1
  s_add_u32 s56, s46, 4096
  buffer_load_dwordx4 v[140:143], v2, s[4:7], s56 offen sc1
  s_add_u32 s56, s46, 14336
  buffer_load_dwordx4 v[144:147], v2, s[4:7], s56 offen sc1
  s_waitcnt vmcnt(11)
  v_mfma_f32_16x16x32_bf16 v[32:35], a[0:3], v[100:103], 0
  s_add_u32 s56, s46, 15360
  buffer_load_dwordx4 v[148:151], v2, s[4:7], s56 offen sc1
  v_mfma_f32_16x16x32_bf16 v[36:39], a[4:7], v[100:103], 0
  ds_read_b128 v[176:179], v2 offset:40960
  v_mfma_f32_16x16x32_bf16 v[40:43], a[8:11], v[100:103], 0
  ds_read_b128 v[180:183], v2 offset:41984
  v_mfma_f32_16x16x32_bf16 v[44:47], a[12:15], v[100:103], 0
  ds_read_b128 v[184:187], v2 offset:43008
  v_mfma_f32_16x16x32_bf16 v[48:51], a[16:19], v[100:103], 0
  ds_read_b128 v[188:191], v2 offset:44032
  ds_read_b128 v[192:195], v2 offset:45056
  s_waitcnt vmcnt(11)
  v_mfma_f32_16x16x32_bf16 v[32:35], a[20:23], v[104:107], v[32:35]
  s_add_u32 s56, s46, 5120
  buffer_load_dwordx4 v[152:155], v2, s[4:7], s56 offen sc1
  v_mfma_f32_16x16x32_bf16 v[36:39], a[24:27], v[104:107], v[36:39]
  ds_read_b128 v[196:199], v2 offset:46080
  v_mfma_f32_16x16x32_bf16 v[40:43], a[28:31], v[104:107], v[40:43]
  ds_read_b128 v[200:203], v2 offset:47104
  v_mfma_f32_16x16x32_bf16 v[44:47], a[32:35], v[104:107], v[44:47]
  ds_read_b128 v[204:207], v2 offset:48128
  v_mfma_f32_16x16x32_bf16 v[48:51], a[36:39], v[104:107], v[48:51]
  ds_read_b128 v[208:211], v2 offset:49152
  ds_read_b128 v[212:215], v2 offset:50176
  s_waitcnt lgkmcnt(5)
  s_waitcnt vmcnt(11)
  v_mfma_f32_16x16x32_bf16 v[32:35], v[176:179], v[108:111], v[32:35]
  v_mfma_f32_16x16x32_bf16 v[36:39], v[180:183], v[108:111], v[36:39]
  v_mfma_f32_16x16x32_bf16 v[40:43], v[184:187], v[108:111], v[40:43]
  v_mfma_f32_16x16x32_bf16 v[44:47], v[188:191], v[108:111], v[44:47]
  v_mfma_f32_16x16x32_bf16 v[48:51], v[192:195], v[108:111], v[48:51]
  s_add_u32 s56, s46, 16384
  buffer_load_dwordx4 v[156:159], v2, s[4:7], s56 offen sc1
  s_waitcnt lgkmcnt(0)
  s_waitcnt vmcnt(11)
  v_mfma_f32_16x16x32_bf16 v[32:35], v[196:199], v[112:115], v[32:35]
  s_add_u32 s56, s46, 17408
  buffer_load_dwordx4 v[160:163], v2, s[4:7], s56 offen sc1
  v_mfma_f32_16x16x32_bf16 v[36:39], v[200:203], v[112:115], v[36:39]
  ds_read_b128 v[216:219], v2 offset:51200
  v_mfma_f32_16x16x32_bf16 v[40:43], v[204:207], v[112:115], v[40:43]
  ds_read_b128 v[220:223], v2 offset:52224
  v_mfma_f32_16x16x32_bf16 v[44:47], v[208:211], v[112:115], v[44:47]
  ds_read_b128 v[224:227], v2 offset:53248
  v_mfma_f32_16x16x32_bf16 v[48:51], v[212:215], v[112:115], v[48:51]
  ds_read_b128 v[228:231], v2 offset:54272
  ds_read_b128 v[232:235], v2 offset:55296
  s_waitcnt vmcnt(11)
  v_mfma_f32_16x16x32_bf16 v[32:35], a[40:43], v[116:119], v[32:35]
  s_add_u32 s56, s46, 6144
  buffer_load_dwordx4 v[164:167], v2, s[4:7], s56 offen sc1
  v_mfma_f32_16x16x32_bf16 v[36:39], a[44:47], v[116:119], v[36:39]
  ds_read_b128 v[176:179], v2 offset:56320
  v_mfma_f32_16x16x32_bf16 v[40:43], a[48:51], v[116:119], v[40:43]
  ds_read_b128 v[180:183], v2 offset:57344
  v_mfma_f32_16x16x32_bf16 v[44:47], a[52:55], v[116:119], v[44:47]
  ds_read_b128 v[184:187], v2 offset:58368
  v_mfma_f32_16x16x32_bf16 v[48:51], a[56:59], v[116:119], v[48:51]
  ds_read_b128 v[188:191], v2 offset:59392
  ds_read_b128 v[192:195], v2 offset:60416
  s_waitcnt lgkmcnt(5)
  s_waitcnt vmcnt(11)
  v_mfma_f32_16x16x32_bf16 v[32:35], v[216:219], v[120:123], v[32:35]
  v_mfma_f32_16x16x32_bf16 v[36:39], v[220:223], v[120:123], v[36:39]
  v_mfma_f32_16x16x32_bf16 v[40:43], v[224:227], v[120:123], v[40:43]
  v_mfma_f32_16x16x32_bf16 v[44:47], v[228:231], v[120:123], v[44:47]
  v_mfma_f32_16x16x32_bf16 v[48:51], v[232:235], v[120:123], v[48:51]
  s_add_u32 s56, s46, 18432
  buffer_load_dwordx4 v[168:171], v2, s[4:7], s56 offen sc1
  s_waitcnt lgkmcnt(0)
  s_waitcnt vmcnt(11)
  v_mfma_f32_16x16x32_bf16 v[32:35], v[176:179], v[124:127], v[32:35]
  s_add_u32 s56, s46, 19456
  buffer_load_dwordx4 v[172:175], v2, s[4:7], s56 offen sc1
  v_mfma_f32_16x16x32_bf16 v[36:39], v[180:183], v[124:127], v[36:39]
  s_barrier
  v_mfma_f32_16x16x32_bf16 v[40:43], v[184:187], v[124:127], v[40:43]
  ds_read_b128 v[196:199], v2 offset:61440
  v_mfma_f32_16x16x32_bf16 v[44:47], v[188:191], v[124:127], v[44:47]
  ds_read_b128 v[200:203], v2 offset:62464
  ds_read_b128 v[204:207], v2 offset:63488
  v_mfma_f32_16x16x32_bf16 v[48:51], v[192:195], v[124:127], v[48:51]
  ds_read_b128 v[208:211], v2 offset:64512
  ds_read_b128 v[212:215], v3 offset:0
  s_waitcnt vmcnt(11)
  v_mfma_f32_16x16x32_bf16 v[32:35], a[60:63], v[128:131], v[32:35]
  s_add_u32 s56, s46, 7168
  buffer_load_dwordx4 v[100:103], v2, s[4:7], s56 offen sc1
  v_mfma_f32_16x16x32_bf16 v[36:39], a[64:67], v[128:131], v[36:39]
  ds_read_b128 v[216:219], v3 offset:1024
  v_mfma_f32_16x16x32_bf16 v[40:43], a[68:71], v[128:131], v[40:43]
  ds_read_b128 v[220:223], v3 offset:2048
  ds_read_b128 v[224:227], v3 offset:3072
  v_mfma_f32_16x16x32_bf16 v[44:47], a[72:75], v[128:131], v[44:47]
  ds_read_b128 v[228:231], v3 offset:4096
  v_mfma_f32_16x16x32_bf16 v[48:51], a[76:79], v[128:131], v[48:51]
  ds_read_b128 v[232:235], v3 offset:5120
  s_add_u32 m0, s44, 122880
  s_nop 0
  buffer_load_dwordx4 v5, s[4:7], s59 offen offset:0 sc1 lds
  s_waitcnt lgkmcnt(5)
  s_waitcnt vmcnt(12)
  v_mfma_f32_16x16x32_bf16 v[32:35], v[196:199], v[132:135], v[32:35]
  v_mfma_f32_16x16x32_bf16 v[36:39], v[200:203], v[132:135], v[36:39]
  v_mfma_f32_16x16x32_bf16 v[40:43], v[204:207], v[132:135], v[40:43]
  buffer_load_dwordx4 v5, s[4:7], s59 offen offset:1024 sc1 lds
  v_mfma_f32_16x16x32_bf16 v[44:47], v[208:211], v[132:135], v[44:47]
  v_mfma_f32_16x16x32_bf16 v[48:51], v[212:215], v[132:135], v[48:51]
  buffer_load_dwordx4 v5, s[4:7], s59 offen offset:2048 sc1 lds
  s_waitcnt lgkmcnt(0)
  s_waitcnt vmcnt(13)
  v_mfma_f32_16x16x32_bf16 v[32:35], v[216:219], v[136:139], v[32:35]
  buffer_load_dwordx4 v5, s[4:7], s59 offen offset:3072 sc1 lds
  v_mfma_f32_16x16x32_bf16 v[36:39], v[220:223], v[136:139], v[36:39]
  ds_read_b128 v[176:179], v3 offset:6144
  v_mfma_f32_16x16x32_bf16 v[40:43], v[224:227], v[136:139], v[40:43]
  ds_read_b128 v[180:183], v3 offset:7168
  ds_read_b128 v[184:187], v3 offset:8192
  v_mfma_f32_16x16x32_bf16 v[44:47], v[228:231], v[136:139], v[44:47]
  ds_read_b128 v[188:191], v3 offset:9216
  v_mfma_f32_16x16x32_bf16 v[48:51], v[232:235], v[136:139], v[48:51]
  ds_read_b128 v[192:195], v3 offset:10240
  s_add_u32 m0, s45, 122880
  s_nop 0
  buffer_load_dwordx4 v6, s[4:7], s59 offen sc1 lds
  s_add_u32 s59, s59, 20480
  s_waitcnt vmcnt(14)
  v_mfma_f32_16x16x32_bf16 v[32:35], a[80:83], v[140:143], v[32:35]
  s_add_u32 m0, s44, 102400
  s_nop 0
  buffer_load_dwordx4 v5, s[4:7], s59 offen offset:0 sc1 lds
  v_mfma_f32_16x16x32_bf16 v[36:39], a[84:87], v[140:143], v[36:39]
  ds_read_b128 v[196:199], v3 offset:11264
  v_mfma_f32_16x16x32_bf16 v[40:43], a[88:91], v[140:143], v[40:43]
  ds_read_b128 v[200:203], v3 offset:12288
  ds_read_b128 v[204:207], v3 offset:13312
  v_mfma_f32_16x16x32_bf16 v[44:47], a[92:95], v[140:143], v[44:47]
  ds_read_b128 v[208:211], v3 offset:14336
  v_mfma_f32_16x16x32_bf16 v[48:51], a[96:99], v[140:143], v[48:51]
  ds_read_b128 v[212:215], v3 offset:15360
  buffer_load_dwordx4 v5, s[4:7], s59 offen offset:1024 sc1 lds
  s_waitcnt lgkmcnt(5)
  s_waitcnt vmcnt(15)
  v_mfma_f32_16x16x32_bf16 v[32:35], v[176:179], v[144:147], v[32:35]
  v_mfma_f32_16x16x32_bf16 v[36:39], v[180:183], v[144:147], v[36:39]
  v_mfma_f32_16x16x32_bf16 v[40:43], v[184:187], v[144:147], v[40:43]
  buffer_load_dwordx4 v5, s[4:7], s59 offen offset:2048 sc1 lds
  v_mfma_f32_16x16x32_bf16 v[44:47], v[188:191], v[144:147], v[44:47]
  v_mfma_f32_16x16x32_bf16 v[48:51], v[192:195], v[144:147], v[48:51]
  buffer_load_dwordx4 v5, s[4:7], s59 offen offset:3072 sc1 lds
  s_waitcnt lgkmcnt(0)
  s_waitcnt vmcnt(16)
  v_mfma_f32_16x16x32_bf16 v[32:35], v[196:199], v[148:151], v[32:35]
  s_add_u32 m0, s45, 102400
  s_nop 0
  buffer_load_dwordx4 v6, s[4:7], s59 offen sc1 lds
  s_add_u32 s59, s59, 20480
  v_mfma_f32_16x16x32_bf16 v[36:39], v[200:203], v[148:151], v[36:39]
  s_branch WOVER_6
  .p2align 12
WARM_6:
  s_setpc_b64 s[94:95]
  s_nop 0
WOVER_6:
  ds_read_b128 v[216:219], v3 offset:16384
  v_mfma_f32_16x16x32_bf16 v[40:43], v[204:207], v[148:151], v[40:43]
  ds_read_b128 v[220:223], v3 offset:17408
  ds_read_b128 v[224:227], v3 offset:18432
  v_mfma_f32_16x16x32_bf16 v[44:47], v[208:211], v[148:151], v[44:47]
  ds_read_b128 v[228:231], v3 offset:19456
  v_mfma_f32_16x16x32_bf16 v[48:51], v[212:215], v[148:151], v[48:51]
  ds_read_b128 v[232:235], v3 offset:20480
  s_add_u32 m0, s44, 0
  s_nop 0
  buffer_load_dwordx4 v5, s[4:7], s59 offen offset:0 sc1 lds
  s_waitcnt vmcnt(17)
  v_mfma_f32_16x16x32_bf16 v[32:35], a[100:103], v[152:155], v[32:35]
  buffer_load_dwordx4 v5, s[4:7], s59 offen offset:1024 sc1 lds
  v_mfma_f32_16x16x32_bf16 v[36:39], a[104:107], v[152:155], v[36:39]
  ds_read_b128 v[176:179], v3 offset:21504
  v_mfma_f32_16x16x32_bf16 v[40:43], a[108:111], v[152:155], v[40:43]
  ds_read_b128 v[180:183], v3 offset:22528
  ds_read_b128 v[184:187], v3 offset:23552
  v_mfma_f32_16x16x32_bf16 v[44:47], a[112:115], v[152:155], v[44:47]
  ds_read_b128 v[188:191], v3 offset:24576
  v_mfma_f32_16x16x32_bf16 v[48:51], a[116:119], v[152:155], v[48:51]
  ds_read_b128 v[192:195], v3 offset:25600
  buffer_load_dwordx4 v5, s[4:7], s59 offen offset:2048 sc1 lds
  s_waitcnt lgkmcnt(5)
  s_waitcnt vmcnt(18)
  v_mfma_f32_16x16x32_bf16 v[32:35], v[216:219], v[156:159], v[32:35]
  v_mfma_f32_16x16x32_bf16 v[36:39], v[220:223], v[156:159], v[36:39]
  v_mfma_f32_16x16x32_bf16 v[40:43], v[224:227], v[156:159], v[40:43]
  buffer_load_dwordx4 v5, s[4:7], s59 offen offset:3072 sc1 lds
  v_mfma_f32_16x16x32_bf16 v[44:47], v[228:231], v[156:159], v[44:47]
  v_mfma_f32_16x16x32_bf16 v[48:51], v[232:235], v[156:159], v[48:51]
  s_add_u32 m0, s45, 0
  s_nop 0
  buffer_load_dwordx4 v6, s[4:7], s59 offen sc1 lds
  s_add_u32 s59, s59, 20480
  s_waitcnt lgkmcnt(0)
  s_waitcnt vmcnt(19)
  v_mfma_f32_16x16x32_bf16 v[32:35], v[176:179], v[160:163], v[32:35]
  ds_read_b128 v[196:199], v3 offset:26624
  v_mfma_f32_16x16x32_bf16 v[36:39], v[180:183], v[160:163], v[36:39]
  ds_read_b128 v[200:203], v3 offset:27648
  v_mfma_f32_16x16x32_bf16 v[40:43], v[184:187], v[160:163], v[40:43]
  ds_read_b128 v[204:207], v3 offset:28672
  v_mfma_f32_16x16x32_bf16 v[44:47], v[188:191], v[160:163], v[44:47]
  ds_read_b128 v[208:211], v3 offset:29696
  v_mfma_f32_16x16x32_bf16 v[48:51], v[192:195], v[160:163], v[48:51]
  ds_read_b128 v[212:215], v3 offset:30720
  s_waitcnt vmcnt(18)
  v_mfma_f32_16x16x32_bf16 v[32:35], a[120:123], v[164:167], v[32:35]
  ds_read_b128 v[216:219], v3 offset:31744
  v_mfma_f32_16x16x32_bf16 v[36:39], a[124:127], v[164:167], v[36:39]
  ds_read_b128 v[220:223], v3 offset:32768
  v_mfma_f32_16x16x32_bf16 v[40:43], a[128:131], v[164:167], v[40:43]
  ds_read_b128 v[224:227], v3 offset:33792
  v_mfma_f32_16x16x32_bf16 v[44:47], a[132:135], v[164:167], v[44:47]
  ds_read_b128 v[228:231], v3 offset:34816
  v_mfma_f32_16x16x32_bf16 v[48:51], a[136:139], v[164:167], v[48:51]
  ds_read_b128 v[232:235], v3 offset:35840
  s_waitcnt lgkmcnt(5)
  s_waitcnt vmcnt(17)
  v_mfma_f32_16x16x32_bf16 v[32:35], v[196:199], v[168:171], v[32:35]
  v_mfma_f32_16x16x32_bf16 v[36:39], v[200:203], v[168:171], v[36:39]
  v_mfma_f32_16x16x32_bf16 v[40:43], v[204:207], v[168:171], v[40:43]
  v_mfma_f32_16x16x32_bf16 v[44:47], v[208:211], v[168:171], v[44:47]
  v_mfma_f32_16x16x32_bf16 v[48:51], v[212:215], v[168:171], v[48:51]
  s_waitcnt lgkmcnt(0)
  s_waitcnt vmcnt(16)
  v_mfma_f32_16x16x32_bf16 v[32:35], v[216:219], v[172:175], v[32:35]
  v_mfma_f32_16x16x32_bf16 v[36:39], v[220:223], v[172:175], v[36:39]
  v_mfma_f32_16x16x32_bf16 v[40:43], v[224:227], v[172:175], v[40:43]
  v_mfma_f32_16x16x32_bf16 v[44:47], v[228:231], v[172:175], v[44:47]
  v_mfma_f32_16x16x32_bf16 v[48:51], v[232:235], v[172:175], v[48:51]
  s_waitcnt vmcnt(15)
  v_mfma_f32_16x16x32_bf16 v[32:35], a[140:143], v[100:103], v[32:35]
  v_mfma_f32_16x16x32_bf16 v[36:39], a[144:147], v[100:103], v[36:39]
  v_mfma_f32_16x16x32_bf16 v[40:43], a[148:151], v[100:103], v[40:43]
  v_mfma_f32_16x16x32_bf16 v[44:47], a[152:155], v[100:103], v[44:47]
  v_mfma_f32_16x16x32_bf16 v[48:51], a[156:159], v[100:103], v[48:51]
  s_nop 3
  v_pk_fma_f32 v[72:73], v[32:33], v[52:53], v[72:73]
  v_pk_fma_f32 v[74:75], v[34:35], v[54:55], v[74:75]
  v_pk_fma_f32 v[76:77], v[36:37], v[56:57], v[76:77]
  v_pk_fma_f32 v[78:79], v[38:39], v[58:59], v[78:79]
  v_pk_fma_f32 v[80:81], v[40:41], v[60:61], v[80:81]
  v_pk_fma_f32 v[82:83], v[42:43], v[62:63], v[82:83]
  v_pk_fma_f32 v[84:85], v[44:45], v[64:65], v[84:85]
  v_pk_fma_f32 v[86:87], v[46:47], v[66:67], v[86:87]
  v_pk_fma_f32 v[88:89], v[48:49], v[68:69], v[88:89]
  v_pk_fma_f32 v[90:91], v[50:51], v[70:71], v[90:91]
  v_cvt_pk_bf16_f32 v240, v72, v73
  v_cvt_pk_bf16_f32 v241, v74, v75
  v_cvt_pk_bf16_f32 v242, v76, v77
  v_cvt_pk_bf16_f32 v243, v78, v79
  v_cvt_pk_bf16_f32 v244, v80, v81
  v_cvt_pk_bf16_f32 v245, v82, v83
  v_cvt_pk_bf16_f32 v246, v84, v85
  v_cvt_pk_bf16_f32 v247, v86, v87
  v_cvt_pk_bf16_f32 v248, v88, v89
  v_cvt_pk_bf16_f32 v249, v90, v91
  v_lshlrev_b32 v72, 16, v240
  v_and_b32 v73, 0xffff0000, v240
  v_lshlrev_b32 v74, 16, v241
  v_and_b32 v75, 0xffff0000, v241
  v_lshlrev_b32 v76, 16, v242
  v_and_b32 v77, 0xffff0000, v242
  v_lshlrev_b32 v78, 16, v243
  v_and_b32 v79, 0xffff0000, v243
  v_lshlrev_b32 v80, 16, v244
  v_and_b32 v81, 0xffff0000, v244
  v_lshlrev_b32 v82, 16, v245
  v_and_b32 v83, 0xffff0000, v245
  v_lshlrev_b32 v84, 16, v246
  v_and_b32 v85, 0xffff0000, v246
  v_lshlrev_b32 v86, 16, v247
  v_and_b32 v87, 0xffff0000, v247
  v_lshlrev_b32 v88, 16, v248
  v_and_b32 v89, 0xffff0000, v248
  v_lshlrev_b32 v90, 16, v249
  v_and_b32 v91, 0xffff0000, v249
  v_pk_mul_f32 v[72:73], v[72:73], v[12:13]
  v_pk_mul_f32 v[74:75], v[74:75], v[14:15]
  v_pk_mul_f32 v[76:77], v[76:77], v[16:17]
  v_pk_mul_f32 v[78:79], v[78:79], v[18:19]
  v_pk_mul_f32 v[80:81], v[80:81], v[20:21]
  v_pk_mul_f32 v[82:83], v[82:83], v[22:23]
  v_pk_mul_f32 v[84:85], v[84:85], v[92:93]
  v_pk_mul_f32 v[86:87], v[86:87], v[94:95]
  v_pk_mul_f32 v[88:89], v[88:89], v[96:97]
  v_pk_mul_f32 v[90:91], v[90:91], v[98:99]
  v_cvt_pk_bf16_f32 v100, v72, v73
  v_cvt_pk_bf16_f32 v101, v74, v75
  v_cvt_pk_bf16_f32 v102, v76, v77
  v_cvt_pk_bf16_f32 v103, v78, v79
  v_cvt_pk_bf16_f32 v104, v80, v81
  v_cvt_pk_bf16_f32 v105, v82, v83
  v_cvt_pk_bf16_f32 v106, v84, v85
  v_cvt_pk_bf16_f32 v107, v86, v87
  v_cvt_pk_bf16_f32 v108, v88, v89
  v_cvt_pk_bf16_f32 v109, v90, v91
  buffer_store_dwordx4 v[100:103], v2, s[4:7], s55 offen sc0 sc1
  buffer_store_dwordx4 v[104:107], v2, s[4:7], s55 offen offset:1024 sc0 sc1
  v_mov_b32 v110, v108
  v_mov_b32 v111, v109
  v_mov_b32 v22, 0x3f803f80
  v_permlane16_swap_b32 v108, v110
  v_permlane16_swap_b32 v109, v111
  buffer_store_dwordx4 v[108:111], v8, s[4:7], s55 offen offset:2048 sc0 sc1
  v_dot2_f32_bf16 v80, v240, v22, 0
  v_dot2_f32_bf16 v81, v240, v240, 0
  v_dot2_f32_bf16 v80, v241, v22, v80
  v_dot2_f32_bf16 v81, v241, v241, v81
  v_dot2_f32_bf16 v80, v242, v22, v80
  v_dot2_f32_bf16 v81, v242, v242, v81
  v_dot2_f32_bf16 v80, v243, v22, v80
  v_dot2_f32_bf16 v81, v243, v243, v81
  v_dot2_f32_bf16 v80, v244, v22, v80
  v_dot2_f32_bf16 v81, v244, v244, v81
  v_dot2_f32_bf16 v80, v245, v22, v80
  v_dot2_f32_bf16 v81, v245, v245, v81
  v_dot2_f32_bf16 v80, v246, v22, v80
  v_dot2_f32_bf16 v81, v246, v246, v81
  v_dot2_f32_bf16 v80, v247, v22, v80
  v_dot2_f32_bf16 v81, v247, v247, v81
  v_dot2_f32_bf16 v80, v248, v22, v80
  v_dot2_f32_bf16 v81, v248, v248, v81
  v_dot2_f32_bf16 v80, v249, v22, v80
  v_dot2_f32_bf16 v81, v249, v249, v81
  s_nop 1
  v_mov_b32 v82, v80
  v_mov_b32 v83, v81
  s_nop 0
  v_permlane16_swap_b32 v80, v82
  v_permlane16_swap_b32 v81, v83
  v_add_f32 v80, v80, v82
  v_add_f32 v81, v81, v83
  v_mov_b32 v82, v80
  v_mov_b32 v83, v81
  s_nop 0
  v_permlane32_swap_b32 v80, v82
  v_permlane32_swap_b32 v81, v83
  v_add_f32 v80, v80, v82
  v_add_f32 v81, v81, v83
  buffer_store_dwordx2 v[80:81], v9, s[4:7], s47 offen sc0 sc1
  s_and_b32 s62, s54, 1
  s_lshl_b32 s62, s62, 3
  s_add_u32 s62, s62, s19
  s_barrier
  s_mul_i32 s26, s19, 80
  s_lshr_b32 s26, s26, 6
  s_mul_i32 s26, s26, 24
  v_min_u32 v236, 47, v1
  v_add_u32 v236, s26, v236
  v_lshlrev_b32 v236, 7, v236
  s_mov_b32 s51, 919552
  s_mul_i32 s46, s49, 20480
  s_add_u32 s46, s46, 17825792
  s_mul_i32 s48, s49, 49152
  s_mul_i32 s26, s17, 3072
  s_add_u32 s48, s48, s26
  s_add_u32 s48, s48, 20971520
  s_lshl_b32 s47, s49, 10
  s_add_u32 s47, s47, 98304
  v_add_u32 v8, 20480, v2
  v_add_u32 v10, 49152, v2
  v_lshlrev_b32 v9, 8, v27
  v_lshl_add_u32 v9, v26, 3, v9
  s_lshl_b32 s64, s61, 11
  s_lshl_b32 s26, s17, 7
  s_add_u32 s64, s64, s26
  s_add_u32 s64, s64, 360448
  s_lshl_b32 s65, s57, 11
  s_add_u32 s65, s65, 360448
  s_mul_i32 s66, s54, 49152
  s_add_u32 s66, s66, 20971520
  v_mov_b32 v232, s36
  v_mov_b32 v233, s36
  v_mov_b32 v234, s36
  v_mov_b32 v235, s36
  ds_read_b128 a[160:163], v4 offset:12288
  ds_read_b128 a[164:167], v4 offset:13312
  ds_read_b128 a[168:171], v4 offset:14336
  ds_read_b128 a[172:175], v4 offset:15360
  ds_read_b128 a[176:179], v4 offset:16384
  ds_read_b128 a[180:183], v4 offset:17408
  ds_read_b128 a[184:187], v4 offset:18432
  ds_read_b128 a[188:191], v4 offset:19456
  s_lshl_b32 s26, s57, 11
  s_lshl_b32 s27, s62, 7
  s_add_u32 s26, s26, s27
  s_add_u32 s26, s26, 753664
  s_waitcnt vmcnt(0)
  v_mov_b32 v20, s36
  v_mov_b32 v21, s36
  v_mov_b32 v22, s36
  v_mov_b32 v23, s36
  s_mov_b64 exec, 0xff
  buffer_store_dwordx4 v[20:23], v2, s[4:7], s26 offen sc0 sc1
  s_mov_b64 exec, -1
  s_lshl_b32 s28, s61, 11
  s_add_u32 s28, s28, 753664
  v_lshlrev_b32 v30, 7, v26
  v_lshl_add_u32 v30, v27, 2, v30
  s_cmp_lg_u32 s3, 0
  s_cbranch_scc1 WDF_13
  s_lshl_b32 s26, s2, 7
  s_add_u32 s26, s26, 919552
  s_cmp_lt_u32 s2, 240
  s_cselect_b32 s26, s26, 1073741824
  v_mov_b32 v20, s36
  v_mov_b32 v21, s36
  v_mov_b32 v22, s36
  v_mov_b32 v23, s36
  s_mov_b64 exec, 0xff
  buffer_store_dwordx4 v[20:23], v2, s[4:7], s26 offen sc0 sc1
  s_mov_b64 exec, -1
WDF_13:
  s_add_u32 m0, s44, 20480
  s_nop 0
  buffer_load_dwordx4 v5, s[4:7], s59 offen offset:0 sc1 lds
  buffer_load_dwordx4 v5, s[4:7], s59 offen offset:1024 sc1 lds
  buffer_load_dwordx4 v5, s[4:7], s59 offen offset:2048 sc1 lds
  buffer_load_dwordx4 v5, s[4:7], s59 offen offset:3072 sc1 lds
  s_add_u32 m0, s45, 20480
  s_nop 0
  buffer_load_dwordx4 v6, s[4:7], s59 offen sc1 lds
  s_add_u32 s59, s59, 20480
  s_add_u32 m0, s44, 40960
  s_nop 0
  buffer_load_dwordx4 v5, s[4:7], s59 offen offset:0 sc1 lds
  buffer_load_dwordx4 v5, s[4:7], s59 offen offset:1024 sc1 lds
  buffer_load_dwordx4 v5, s[4:7], s59 offen offset:2048 sc1 lds
  buffer_load_dwordx4 v5, s[4:7], s59 offen offset:3072 sc1 lds
  s_add_u32 m0, s45, 40960
  s_nop 0
  buffer_load_dwordx4 v6, s[4:7], s59 offen sc1 lds
  s_add_u32 s59, s59, 20480
  s_mov_b32 s27, 400000
  buffer_load_dword v250, v30, s[4:7], s28 offen sc1
POLL_14:
  s_waitcnt vmcnt(0)
  v_cmp_eq_u32 vcc, s36, v250
  s_nop 0
  s_cmp_eq_u64 vcc, -1
  s_cbranch_scc1 POK_15
  buffer_load_dword v250, v30, s[4:7], s28 offen sc1
  s_sub_u32 s27, s27, 1
  s_cmp_lg_u32 s27, 0
  s_cbranch_scc1 POLL_14
POK_15:
  buffer_load_dwordx4 a[0:3], v2, s[4:7], s46 offen offset:0 sc1
  buffer_load_dwordx4 a[4:7], v8, s[4:7], s46 offen offset:0 sc1
  buffer_load_dwordx4 a[8:11], v2, s[4:7], s46 offen offset:1024 sc1
  buffer_load_dwordx4 a[12:15], v8, s[4:7], s46 offen offset:1024 sc1
  buffer_load_dwordx4 a[16:19], v2, s[4:7], s46 offen offset:2048 sc1
  buffer_load_dwordx4 a[20:23], v8, s[4:7], s46 offen offset:2048 sc1
  buffer_load_dwordx4 a[24:27], v2, s[4:7], s46 offen offset:3072 sc1
  buffer_load_dwordx4 a[28:31], v8, s[4:7], s46 offen offset:3072 sc1
  s_add_u32 s46, s46, 4096
  buffer_load_dwordx4 a[32:35], v2, s[4:7], s46 offen offset:0 sc1
  buffer_load_dwordx4 a[36:39], v8, s[4:7], s46 offen offset:0 sc1
  buffer_load_dwordx4 a[40:43], v2, s[4:7], s46 offen offset:1024 sc1
  buffer_load_dwordx4 a[44:47], v8, s[4:7], s46 offen offset:1024 sc1
  buffer_load_dwordx4 a[48:51], v2, s[4:7], s46 offen offset:2048 sc1
  buffer_load_dwordx4 a[52:55], v8, s[4:7], s46 offen offset:2048 sc1
  buffer_load_dwordx2 v[96:97], v9, s[4:7], s47 offen offset:0 sc1
  buffer_load_dwordx2 v[98:99], v9, s[4:7], s47 offen offset:128 sc1
  buffer_load_dwordx2 v[100:101], v9, s[4:7], s47 offen offset:1024 sc1
  buffer_load_dwordx2 v[102:103], v9, s[4:7], s47 offen offset:1152 sc1
  s_barrier
  s_waitcnt lgkmcnt(4)
  s_waitcnt vmcnt(16)
  v_mfma_f32_16x16x32_bf16 v[32:35], a[160:163], a[0:3], 0
  v_mfma_f32_16x16x32_bf16 v[48:51], a[160:163], a[4:7], 0
  buffer_load_dwordx4 a[56:59], v2, s[4:7], s46 offen offset:3072 sc1
  v_mfma_f32_16x16x32_bf16 v[36:39], a[164:167], a[0:3], 0
  ds_read_b128 a[192:195], v4 offset:20480
  v_mfma_f32_16x16x32_bf16 v[52:55], a[164:167], a[4:7], 0
  ds_read_b128 a[196:199], v4 offset:21504
  v_mfma_f32_16x16x32_bf16 v[40:43], a[168:171], a[0:3], 0
  v_mfma_f32_16x16x32_bf16 v[56:59], a[168:171], a[4:7], 0
  buffer_load_dwordx4 a[60:63], v8, s[4:7], s46 offen offset:3072 sc1
  s_add_u32 s46, s46, 4096
  v_mfma_f32_16x16x32_bf16 v[44:47], a[172:175], a[0:3], 0
  ds_read_b128 a[200:203], v4 offset:22528
  v_mfma_f32_16x16x32_bf16 v[60:63], a[172:175], a[4:7], 0
  ds_read_b128 a[204:207], v4 offset:23552
  s_waitcnt lgkmcnt(4)
  s_waitcnt vmcnt(16)
  v_mfma_f32_16x16x32_bf16 v[32:35], a[176:179], a[8:11], v[32:35]
  v_mfma_f32_16x16x32_bf16 v[48:51], a[176:179], a[12:15], v[48:51]
  buffer_load_dwordx4 a[64:67], v2, s[4:7], s46 offen offset:0 sc1
  v_mfma_f32_16x16x32_bf16 v[36:39], a[180:183], a[8:11], v[36:39]
  ds_read_b128 a[160:163], v4 offset:24576
  v_mfma_f32_16x16x32_bf16 v[52:55], a[180:183], a[12:15], v[52:55]
  ds_read_b128 a[164:167], v4 offset:25600
  v_mfma_f32_16x16x32_bf16 v[40:43], a[184:187], a[8:11], v[40:43]
  v_mfma_f32_16x16x32_bf16 v[56:59], a[184:187], a[12:15], v[56:59]
  buffer_load_dwordx4 a[68:71], v8, s[4:7], s46 offen offset:0 sc1
  v_mfma_f32_16x16x32_bf16 v[44:47], a[188:191], a[8:11], v[44:47]
  ds_read_b128 a[168:171], v4 offset:26624
  v_mfma_f32_16x16x32_bf16 v[60:63], a[188:191], a[12:15], v[60:63]
  ds_read_b128 a[172:175], v4 offset:27648
  s_waitcnt lgkmcnt(4)
  s_waitcnt vmcnt(16)
  v_mfma_f32_16x16x32_bf16 v[32:35], a[192:195], a[16:19], v[32:35]
  v_mfma_f32_16x16x32_bf16 v[48:51], a[192:195], a[20:23], v[48:51]
  buffer_load_dwordx4 a[72:75], v2, s[4:7], s46 offen offset:1024 sc1
  v_mfma_f32_16x16x32_bf16 v[36:39], a[196:199], a[16:19], v[36:39]
  ds_read_b128 a[176:179], v4 offset:28672
  v_mfma_f32_16x16x32_bf16 v[52:55], a[196:199], a[20:23], v[52:55]
  ds_read_b128 a[180:183], v4 offset:29696
  v_mfma_f32_16x16x32_bf16 v[40:43], a[200:203], a[16:19], v[40:43]
  v_mfma_f32_16x16x32_bf16 v[56:59], a[200:203], a[20:23], v[56:59]
  buffer_load_dwordx4 a[76:79], v8, s[4:7], s46 offen offset:1024 sc1
  v_mfma_f32_16x16x32_bf16 v[44:47], a[204:207], a[16:19], v[44:47]
  ds_read_b128 a[184:187], v4 offset:30720
  v_mfma_f32_16x16x32_bf16 v[60:63], a[204:207], a[20:23], v[60:63]
  ds_read_b128 a[188:191], v4 offset:31744
  s_waitcnt lgkmcnt(4)
  s_waitcnt vmcnt(16)
  v_mfma_f32_16x16x32_bf16 v[32:35], a[160:163], a[24:27], v[32:35]
  v_mfma_f32_16x16x32_bf16 v[48:51], a[160:163], a[28:31], v[48:51]
  buffer_load_dwordx4 a[80:83], v2, s[4:7], s46 offen offset:2048 sc1
  v_mfma_f32_16x16x32_bf16 v[36:39], a[164:167], a[24:27], v[36:39]
  ds_read_b128 a[192:195], v3 offset:57344
  v_mfma_f32_16x16x32_bf16 v[52:55], a[164:167], a[28:31], v[52:55]
  ds_read_b128 a[196:199], v3 offset:58368
  v_mfma_f32_16x16x32_bf16 v[40:43], a[168:171], a[24:27], v[40:43]
  v_mfma_f32_16x16x32_bf16 v[56:59], a[168:171], a[28:31], v[56:59]
  buffer_load_dwordx4 a[84:87], v8, s[4:7], s46 offen offset:2048 sc1
  v_mfma_f32_16x16x32_bf16 v[44:47], a[172:175], a[24:27], v[44:47]
  ds_read_b128 a[200:203], v3 offset:59392
  v_mfma_f32_16x16x32_bf16 v[60:63], a[172:175], a[28:31], v[60:63]
  ds_read_b128 a[204:207], v3 offset:60416
  s_waitcnt lgkmcnt(4)
  s_waitcnt vmcnt(16)
  v_mfma_f32_16x16x32_bf16 v[32:35], a[176:179], a[32:35], v[32:35]
  v_mfma_f32_16x16x32_bf16 v[48:51], a[176:179], a[36:39], v[48:51]
  buffer_load_dwordx4 a[88:91], v2, s[4:7], s46 offen offset:3072 sc1
  v_mfma_f32_16x16x32_bf16 v[36:39], a[180:183], a[32:35], v[36:39]
  ds_read_b128 a[160:163], v3 offset:61440
  v_mfma_f32_16x16x32_bf16 v[52:55], a[180:183], a[36:39], v[52:55]
  ds_read_b128 a[164:167], v3 offset:62464
  v_mfma_f32_16x16x32_bf16 v[40:43], a[184:187], a[32:35], v[40:43]
  v_mfma_f32_16x16x32_bf16 v[56:59], a[184:187], a[36:39], v[56:59]
  buffer_load_dwordx4 a[92:95], v8, s[4:7], s46 offen offset:3072 sc1
  s_add_u32 s46, s46, 4096
  v_mfma_f32_16x16x32_bf16 v[44:47], a[188:191], a[32:35], v[44:47]
  ds_read_b128 a[168:171], v3 offset:63488
  v_mfma_f32_16x16x32_bf16 v[60:63], a[188:191], a[36:39], v[60:63]
  ds_read_b128 a[172:175], v3 offset:64512
  s_waitcnt lgkmcnt(4)
  s_waitcnt vmcnt(16)
  v_mfma_f32_16x16x32_bf16 v[32:35], a[192:195], a[40:43], v[32:35]
  v_mfma_f32_16x16x32_bf16 v[48:51], a[192:195], a[44:47], v[48:51]
  buffer_load_dwordx4 a[96:99], v2, s[4:7], s46 offen offset:0 sc1
  v_mfma_f32_16x16x32_bf16 v[36:39], a[196:199], a[40:43], v[36:39]
  ds_read_b128 a[176:179], v4 offset:0
  v_mfma_f32_16x16x32_bf16 v[52:55], a[196:199], a[44:47], v[52:55]
  ds_read_b128 a[180:183], v4 offset:1024
  v_mfma_f32_16x16x32_bf16 v[40:43], a[200:203], a[40:43], v[40:43]
  v_mfma_f32_16x16x32_bf16 v[56:59], a[200:203], a[44:47], v[56:59]
  buffer_load_dwordx4 a[100:103], v8, s[4:7], s46 offen offset:0 sc1
  v_mfma_f32_16x16x32_bf16 v[44:47], a[204:207], a[40:43], v[44:47]
  ds_read_b128 a[184:187], v4 offset:2048
  v_mfma_f32_16x16x32_bf16 v[60:63], a[204:207], a[44:47], v[60:63]
  ds_read_b128 a[188:191], v4 offset:3072
  s_waitcnt lgkmcnt(4)
  s_waitcnt vmcnt(16)
  v_mfma_f32_16x16x32_bf16 v[32:35], a[160:163], a[48:51], v[32:35]
  v_mfma_f32_16x16x32_bf16 v[48:51], a[160:163], a[52:55], v[48:51]
  buffer_load_dwordx4 a[104:107], v2, s[4:7], s46 offen offset:1024 sc1
  v_mfma_f32_16x16x32_bf16 v[36:39], a[164:167], a[48:51], v[36:39]
  ds_read_b128 a[192:195], v4 offset:4096
  v_mfma_f32_16x16x32_bf16 v[52:55], a[164:167], a[52:55], v[52:55]
  ds_read_b128 a[196:199], v4 offset:5120
  v_mfma_f32_16x16x32_bf16 v[40:43], a[168:171], a[48:51], v[40:43]
  v_mfma_f32_16x16x32_bf16 v[56:59], a[168:171], a[52:55], v[56:59]
  buffer_load_dwordx4 a[108:111], v8, s[4:7], s46 offen offset:1024 sc1
  v_mfma_f32_16x16x32_bf16 v[44:47], a[172:175], a[48:51], v[44:47]
  ds_read_b128 a[200:203], v4 offset:6144
  v_mfma_f32_16x16x32_bf16 v[60:63], a[172:175], a[52:55], v[60:63]
  ds_read_b128 a[204:207], v4 offset:7168
  s_waitcnt lgkmcnt(4)
  s_waitcnt vmcnt(12)
  v_mfma_f32_16x16x32_bf16 v[32:35], a[176:179], a[56:59], v[32:35]
  v_mfma_f32_16x16x32_bf16 v[48:51], a[176:179], a[60:63], v[48:51]
  buffer_load_dwordx4 a[112:115], v2, s[4:7], s46 offen offset:2048 sc1
  v_mfma_f32_16x16x32_bf16 v[36:39], a[180:183], a[56:59], v[36:39]
  ds_read_b128 a[160:163], v4 offset:8192
  v_mfma_f32_16x16x32_bf16 v[52:55], a[180:183], a[60:63], v[52:55]
  ds_read_b128 a[164:167], v4 offset:9216
  v_mfma_f32_16x16x32_bf16 v[40:43], a[184:187], a[56:59], v[40:43]
  v_mfma_f32_16x16x32_bf16 v[56:59], a[184:187], a[60:63], v[56:59]
  buffer_load_dwordx4 a[116:119], v8, s[4:7], s46 offen offset:2048 sc1
  v_mfma_f32_16x16x32_bf16 v[44:47], a[188:191], a[56:59], v[44:47]
  ds_read_b128 a[168:171], v4 offset:10240
  v_mfma_f32_16x16x32_bf16 v[60:63], a[188:191], a[60:63], v[60:63]
  ds_read_b128 a[172:175], v4 offset:11264
  s_waitcnt lgkmcnt(4)
  s_waitcnt vmcnt(12)
  v_mfma_f32_16x16x32_bf16 v[32:35], a[192:195], a[64:67], v[32:35]
  buffer_load_dwordx4 a[120:123], v2, s[4:7], s46 offen offset:3072 sc1
  v_mfma_f32_16x16x32_bf16 v[48:51], a[192:195], a[68:71], v[48:51]
  ds_read_b128 a[176:179], v3 offset:36864
  ds_read_b128 a[180:183], v3 offset:37888
  v_mfma_f32_16x16x32_bf16 v[36:39], a[196:199], a[64:67], v[36:39]
  v_mfma_f32_16x16x32_bf16 v[52:55], a[196:199], a[68:71], v[52:55]
  v_add_f32 v96, v96, v98
  v_add_f32 v100, v100, v102
  v_mfma_f32_16x16x32_bf16 v[40:43], a[200:203], a[64:67], v[40:43]
  buffer_load_dwordx4 a[124:127], v8, s[4:7], s46 offen offset:3072 sc1
  s_add_u32 s46, s46, 4096
  v_mfma_f32_16x16x32_bf16 v[56:59], a[200:203], a[68:71], v[56:59]
  ds_read_b128 a[184:187], v3 offset:38912
  ds_read_b128 a[188:191], v3 offset:39936
  v_mfma_f32_16x16x32_bf16 v[44:47], a[204:207], a[64:67], v[44:47]
  v_add_f32 v97, v97, v99
  v_mfma_f32_16x16x32_bf16 v[60:63], a[204:207], a[68:71], v[60:63]
  v_add_f32 v101, v101, v103
  v_mov_b32 v98, v96
  s_waitcnt lgkmcnt(4)
  s_waitcnt vmcnt(12)
  v_mfma_f32_16x16x32_bf16 v[32:35], a[160:163], a[72:75], v[32:35]
  buffer_load_dwordx4 a[128:131], v2, s[4:7], s46 offen offset:0 sc1
  v_mfma_f32_16x16x32_bf16 v[48:51], a[160:163], a[76:79], v[48:51]
  ds_read_b128 a[192:195], v3 offset:40960
  ds_read_b128 a[196:199], v3 offset:41984
  v_mfma_f32_16x16x32_bf16 v[36:39], a[164:167], a[72:75], v[36:39]
  v_mov_b32 v102, v100
  v_mfma_f32_16x16x32_bf16 v[52:55], a[164:167], a[76:79], v[52:55]
  v_mov_b32 v99, v97
  v_mov_b32 v103, v101
  v_mfma_f32_16x16x32_bf16 v[40:43], a[168:171], a[72:75], v[40:43]
  buffer_load_dwordx4 a[132:135], v8, s[4:7], s46 offen offset:0 sc1
  v_mfma_f32_16x16x32_bf16 v[56:59], a[168:171], a[76:79], v[56:59]
  ds_read_b128 a[200:203], v3 offset:43008
  ds_read_b128 a[204:207], v3 offset:44032
  v_mfma_f32_16x16x32_bf16 v[44:47], a[172:175], a[72:75], v[44:47]
  v_permlane16_swap_b32 v96, v98
  v_mfma_f32_16x16x32_bf16 v[60:63], a[172:175], a[76:79], v[60:63]
  v_permlane16_swap_b32 v100, v102
  v_permlane16_swap_b32 v97, v99
  s_waitcnt lgkmcnt(4)
  s_waitcnt vmcnt(12)
  v_mfma_f32_16x16x32_bf16 v[32:35], a[176:179], a[80:83], v[32:35]
  v_mfma_f32_16x16x32_bf16 v[48:51], a[176:179], a[84:87], v[48:51]
  s_barrier
  buffer_load_dwordx4 a[136:139], v2, s[4:7], s46 offen offset:1024 sc1
  v_mfma_f32_16x16x32_bf16 v[36:39], a[180:183], a[80:83], v[36:39]
  ds_read_b128 a[160:163], v3 offset:45056
  ds_read_b128 a[164:167], v3 offset:46080
  v_mfma_f32_16x16x32_bf16 v[52:55], a[180:183], a[84:87], v[52:55]
  v_permlane16_swap_b32 v101, v103
  v_add_f32 v96, v96, v98
  v_mfma_f32_16x16x32_bf16 v[40:43], a[184:187], a[80:83], v[40:43]
  v_add_f32 v100, v100, v102
  v_mfma_f32_16x16x32_bf16 v[56:59], a[184:187], a[84:87], v[56:59]
  buffer_load_dwordx4 a[140:143], v8, s[4:7], s46 offen offset:1024 sc1
  ds_read_b128 a[168:171], v3 offset:47104
  v_mfma_f32_16x16x32_bf16 v[44:47], a[188:191], a[80:83], v[44:47]
  ds_read_b128 a[172:175], v3 offset:48128
  v_add_f32 v97, v97, v99
  v_mfma_f32_16x16x32_bf16 v[60:63], a[188:191], a[84:87], v[60:63]
  v_add_f32 v101, v101, v103
  v_mov_b32 v98, v96
  s_waitcnt lgkmcnt(4)
  s_waitcnt vmcnt(12)
  v_mfma_f32_16x16x32_bf16 v[32:35], a[192:195], a[88:91], v[32:35]
  buffer_load_dwordx4 a[144:147], v2, s[4:7], s46 offen offset:2048 sc1
  v_mfma_f32_16x16x32_bf16 v[48:51], a[192:195], a[92:95], v[48:51]
  ds_read_b128 a[176:179], v3 offset:49152
  ds_read_b128 a[180:183], v3 offset:50176
  v_mfma_f32_16x16x32_bf16 v[36:39], a[196:199], a[88:91], v[36:39]
  v_mov_b32 v102, v100
  v_mfma_f32_16x16x32_bf16 v[52:55], a[196:199], a[92:95], v[52:55]
  v_mov_b32 v99, v97
  v_mov_b32 v103, v101
  v_mfma_f32_16x16x32_bf16 v[40:43], a[200:203], a[88:91], v[40:43]
  buffer_load_dwordx4 a[148:151], v8, s[4:7], s46 offen offset:2048 sc1
  v_mfma_f32_16x16x32_bf16 v[56:59], a[200:203], a[92:95], v[56:59]
  ds_read_b128 a[184:187], v3 offset:51200
  ds_read_b128 a[188:191], v3 offset:52224
  v_mfma_f32_16x16x32_bf16 v[44:47], a[204:207], a[88:91], v[44:47]
  v_permlane32_swap_b32 v96, v98
  v_mfma_f32_16x16x32_bf16 v[60:63], a[204:207], a[92:95], v[60:63]
  v_permlane32_swap_b32 v100, v102
  v_permlane32_swap_b32 v97, v99
  s_waitcnt lgkmcnt(4)
  s_waitcnt vmcnt(12)
  v_mfma_f32_16x16x32_bf16 v[32:35], a[160:163], a[96:99], v[32:35]
  buffer_load_dwordx4 a[152:155], v2, s[4:7], s46 offen offset:3072 sc1
  v_mfma_f32_16x16x32_bf16 v[48:51], a[160:163], a[100:103], v[48:51]
  ds_read_b128 a[192:195], v3 offset:53248
  ds_read_b128 a[196:199], v3 offset:54272
  v_mfma_f32_16x16x32_bf16 v[36:39], a[164:167], a[96:99], v[36:39]
  v_permlane32_swap_b32 v101, v103
  v_mfma_f32_16x16x32_bf16 v[52:55], a[164:167], a[100:103], v[52:55]
  v_add_f32 v96, v96, v98
  v_add_f32 v100, v100, v102
  v_mfma_f32_16x16x32_bf16 v[40:43], a[168:171], a[96:99], v[40:43]
  buffer_load_dwordx4 a[156:159], v8, s[4:7], s46 offen offset:3072 sc1
  s_add_u32 s46, s46, 4096
  v_mfma_f32_16x16x32_bf16 v[56:59], a[168:171], a[100:103], v[56:59]
  ds_read_b128 a[200:203], v3 offset:55296
  ds_read_b128 a[204:207], v3 offset:56320
  v_mfma_f32_16x16x32_bf16 v[44:47], a[172:175], a[96:99], v[44:47]
  v_add_f32 v97, v97, v99
  v_mfma_f32_16x16x32_bf16 v[60:63], a[172:175], a[100:103], v[60:63]
  v_add_f32 v101, v101, v103
  v_mul_f32 v96, 986500301, v96
  s_waitcnt lgkmcnt(4)
  s_waitcnt vmcnt(12)
  v_mfma_f32_16x16x32_bf16 v[32:35], a[176:179], a[104:107], v[32:35]
  s_add_u32 m0, s44, 61440
  s_nop 0
  buffer_load_dwordx4 v5, s[4:7], s59 offen offset:0 sc1 lds
  v_mfma_f32_16x16x32_bf16 v[48:51], a[176:179], a[108:111], v[48:51]
  ds_read_b128 a[160:163], v2 offset:0
  ds_read_b128 a[164:167], v2 offset:1024
  v_mfma_f32_16x16x32_bf16 v[36:39], a[180:183], a[104:107], v[36:39]
  v_mul_f32 v100, 986500301, v100
  v_mfma_f32_16x16x32_bf16 v[52:55], a[180:183], a[108:111], v[52:55]
  v_mul_f32 v97, 986500301, v97
  v_mul_f32 v101, 986500301, v101
  v_mfma_f32_16x16x32_bf16 v[40:43], a[184:187], a[104:107], v[40:43]
  buffer_load_dwordx4 v5, s[4:7], s59 offen offset:1024 sc1 lds
  v_mfma_f32_16x16x32_bf16 v[56:59], a[184:187], a[108:111], v[56:59]
  ds_read_b128 a[168:171], v2 offset:2048
  ds_read_b128 a[172:175], v2 offset:3072
  v_mfma_f32_16x16x32_bf16 v[44:47], a[188:191], a[104:107], v[44:47]
  v_fma_f32 v97, -v96, v96, v97
  v_mfma_f32_16x16x32_bf16 v[60:63], a[188:191], a[108:111], v[60:63]
  v_fma_f32 v101, -v100, v100, v101
  v_max_f32 v97, 0, v97
  s_waitcnt lgkmcnt(4)
  s_waitcnt vmcnt(12)
  v_mfma_f32_16x16x32_bf16 v[32:35], a[192:195], a[112:115], v[32:35]
  buffer_load_dwordx4 v5, s[4:7], s59 offen offset:2048 sc1 lds
  v_mfma_f32_16x16x32_bf16 v[48:51], a[192:195], a[116:119], v[48:51]
  ds_read_b128 a[176:179], v2 offset:4096
  ds_read_b128 a[180:183], v2 offset:5120
  v_mfma_f32_16x16x32_bf16 v[36:39], a[196:199], a[112:115], v[36:39]
  v_max_f32 v101, 0, v101
  v_mfma_f32_16x16x32_bf16 v[52:55], a[196:199], a[116:119], v[52:55]
  v_cvt_pk_bf16_f32 v97, v97, v97
  v_cvt_pk_bf16_f32 v101, v101, v101
  v_mfma_f32_16x16x32_bf16 v[40:43], a[200:203], a[112:115], v[40:43]
  buffer_load_dwordx4 v5, s[4:7], s59 offen offset:3072 sc1 lds
  v_mfma_f32_16x16x32_bf16 v[56:59], a[200:203], a[116:119], v[56:59]
  ds_read_b128 a[184:187], v2 offset:6144
  ds_read_b128 a[188:191], v2 offset:7168
  s_branch WOVER_7
  .p2align 12
WARM_7:
  s_setpc_b64 s[94:95]
  s_nop 0
WOVER_7:
  v_mfma_f32_16x16x32_bf16 v[44:47], a[204:207], a[112:115], v[44:47]
  v_and_b32 v97, 0xffff0000, v97
  v_mfma_f32_16x16x32_bf16 v[60:63], a[204:207], a[116:119], v[60:63]
  v_and_b32 v101, 0xffff0000, v101
  v_add_f32 v97, 925353388, v97
  s_waitcnt lgkmcnt(4)
  s_waitcnt vmcnt(12)
  v_mfma_f32_16x16x32_bf16 v[32:35], a[160:163], a[120:123], v[32:35]
  s_add_u32 m0, s45, 61440
  s_nop 0
  buffer_load_dwordx4 v6, s[4:7], s59 offen sc1 lds
  s_add_u32 s59, s59, 20480
  v_mfma_f32_16x16x32_bf16 v[48:51], a[160:163], a[124:127], v[48:51]
  ds_read_b128 a[192:195], v2 offset:8192
  ds_read_b128 a[196:199], v2 offset:9216
  v_mfma_f32_16x16x32_bf16 v[36:39], a[164:167], a[120:123], v[36:39]
  v_add_f32 v101, 925353388, v101
  v_mfma_f32_16x16x32_bf16 v[52:55], a[164:167], a[124:127], v[52:55]
  v_cvt_pk_bf16_f32 v97, v97, v97
  v_cvt_pk_bf16_f32 v101, v101, v101
  v_mfma_f32_16x16x32_bf16 v[40:43], a[168:171], a[120:123], v[40:43]
  s_add_u32 m0, s44, 81920
  s_nop 0
  buffer_load_dwordx4 v5, s[4:7], s59 offen offset:0 sc1 lds
  v_mfma_f32_16x16x32_bf16 v[56:59], a[168:171], a[124:127], v[56:59]
  ds_read_b128 a[200:203], v2 offset:10240
  ds_read_b128 a[204:207], v2 offset:11264
  v_mfma_f32_16x16x32_bf16 v[44:47], a[172:175], a[120:123], v[44:47]
  v_and_b32 v97, 0xffff0000, v97
  v_mfma_f32_16x16x32_bf16 v[60:63], a[172:175], a[124:127], v[60:63]
  v_and_b32 v101, 0xffff0000, v101
  v_sqrt_f32 v97, v97
  s_waitcnt lgkmcnt(4)
  s_waitcnt vmcnt(12)
  v_mfma_f32_16x16x32_bf16 v[32:35], a[176:179], a[128:131], v[32:35]
  buffer_load_dwordx4 v5, s[4:7], s59 offen offset:1024 sc1 lds
  v_mfma_f32_16x16x32_bf16 v[48:51], a[176:179], a[132:135], v[48:51]
  ds_read_b128 a[160:163], v2 offset:12288
  ds_read_b128 a[164:167], v2 offset:13312
  v_mfma_f32_16x16x32_bf16 v[36:39], a[180:183], a[128:131], v[36:39]
  v_sqrt_f32 v101, v101
  v_mfma_f32_16x16x32_bf16 v[52:55], a[180:183], a[132:135], v[52:55]
  v_cvt_pk_bf16_f32 v12, -v96, -v96
  v_cvt_pk_bf16_f32 v16, -v100, -v100
  v_mfma_f32_16x16x32_bf16 v[40:43], a[184:187], a[128:131], v[40:43]
  buffer_load_dwordx4 v5, s[4:7], s59 offen offset:2048 sc1 lds
  v_mfma_f32_16x16x32_bf16 v[56:59], a[184:187], a[132:135], v[56:59]
  ds_read_b128 a[168:171], v2 offset:14336
  ds_read_b128 a[172:175], v2 offset:15360
  v_mfma_f32_16x16x32_bf16 v[44:47], a[188:191], a[128:131], v[44:47]
  v_cvt_pk_bf16_f32 v13, v97, v97
  v_mfma_f32_16x16x32_bf16 v[60:63], a[188:191], a[132:135], v[60:63]
  v_cvt_pk_bf16_f32 v17, v101, v101
  v_and_b32 v97, 0xffff0000, v13
  s_waitcnt lgkmcnt(4)
  s_waitcnt vmcnt(12)
  v_mfma_f32_16x16x32_bf16 v[32:35], a[192:195], a[136:139], v[32:35]
  buffer_load_dwordx4 v5, s[4:7], s59 offen offset:3072 sc1 lds
  v_mfma_f32_16x16x32_bf16 v[48:51], a[192:195], a[140:143], v[48:51]
  ds_read_b128 a[176:179], v2 offset:16384
  ds_read_b128 a[180:183], v2 offset:17408
  v_mfma_f32_16x16x32_bf16 v[36:39], a[196:199], a[136:139], v[36:39]
  v_and_b32 v101, 0xffff0000, v17
  v_mfma_f32_16x16x32_bf16 v[52:55], a[196:199], a[140:143], v[52:55]
  v_mov_b32 v14, v12
  v_mov_b32 v18, v16
  v_mfma_f32_16x16x32_bf16 v[40:43], a[200:203], a[136:139], v[40:43]
  s_add_u32 m0, s45, 81920
  s_nop 0
  buffer_load_dwordx4 v6, s[4:7], s59 offen sc1 lds
  s_add_u32 s59, s59, 20480
  v_mfma_f32_16x16x32_bf16 v[56:59], a[200:203], a[140:143], v[56:59]
  ds_read_b128 a[184:187], v2 offset:18432
  ds_read_b128 a[188:191], v2 offset:19456
  v_mfma_f32_16x16x32_bf16 v[44:47], a[204:207], a[136:139], v[44:47]
  v_mov_b32 v15, v13
  v_mfma_f32_16x16x32_bf16 v[60:63], a[204:207], a[140:143], v[60:63]
  v_mov_b32 v19, v17
  v_rcp_f32 v128, v97
  s_waitcnt lgkmcnt(4)
  s_waitcnt vmcnt(12)
  v_mfma_f32_16x16x32_bf16 v[32:35], a[160:163], a[144:147], v[32:35]
  s_add_u32 m0, s44, 143360
  s_nop 0
  buffer_load_dwordx4 v5, s[4:7], s59 offen offset:0 sc1 lds
  v_mfma_f32_16x16x32_bf16 v[48:51], a[160:163], a[148:151], v[48:51]
  ds_read_b128 a[192:195], v2 offset:20480
  v_mfma_f32_16x16x32_bf16 v[36:39], a[164:167], a[144:147], v[36:39]
  ds_read_b128 a[196:199], v2 offset:21504
  v_rcp_f32 v129, v101
  v_mfma_f32_16x16x32_bf16 v[52:55], a[164:167], a[148:151], v[52:55]
  v_mul_f32 v130, v97, v97
  v_mfma_f32_16x16x32_bf16 v[40:43], a[168:171], a[144:147], v[40:43]
  buffer_load_dwordx4 v5, s[4:7], s59 offen offset:1024 sc1 lds
  v_mfma_f32_16x16x32_bf16 v[56:59], a[168:171], a[148:151], v[56:59]
  ds_read_b128 a[200:203], v2 offset:22528
  ds_read_b128 a[204:207], v2 offset:23552
  v_mfma_f32_16x16x32_bf16 v[44:47], a[172:175], a[144:147], v[44:47]
  v_mul_f32 v131, v101, v101
  v_mfma_f32_16x16x32_bf16 v[60:63], a[172:175], a[148:151], v[60:63]
  v_mul_f32 v128, 3216550459, v128
  v_mul_f32 v129, 3216550459, v129
  s_waitcnt lgkmcnt(4)
  s_waitcnt vmcnt(12)
  v_mfma_f32_16x16x32_bf16 v[32:35], a[176:179], a[152:155], v[32:35]
  v_mfma_f32_16x16x32_bf16 v[48:51], a[176:179], a[156:159], v[48:51]
  buffer_load_dwordx4 v5, s[4:7], s59 offen offset:2048 sc1 lds
  v_mfma_f32_16x16x32_bf16 v[36:39], a[180:183], a[152:155], v[36:39]
  ds_read_b128 a[160:163], v2 offset:24576
  v_mfma_f32_16x16x32_bf16 v[52:55], a[180:183], a[156:159], v[52:55]
  ds_read_b128 a[164:167], v2 offset:25600
  v_mfma_f32_16x16x32_bf16 v[40:43], a[184:187], a[152:155], v[40:43]
  v_mfma_f32_16x16x32_bf16 v[56:59], a[184:187], a[156:159], v[56:59]
  buffer_load_dwordx4 v5, s[4:7], s59 offen offset:3072 sc1 lds
  v_mfma_f32_16x16x32_bf16 v[44:47], a[188:191], a[152:155], v[44:47]
  ds_read_b128 a[168:171], v2 offset:26624
  v_mfma_f32_16x16x32_bf16 v[60:63], a[188:191], a[156:159], v[60:63]
  ds_read_b128 a[172:175], v2 offset:27648
  s_waitcnt lgkmcnt(4)
  v_mfma_f32_16x16x32_bf16 v[32:35], a[192:195], v[12:15], v[32:35]
  s_waitcnt vmcnt(9)
  v_mfma_f32_16x16x32_bf16 v[48:51], a[192:195], v[16:19], v[48:51]
  s_barrier
  v_mfma_f32_16x16x32_bf16 v[36:39], a[196:199], v[12:15], v[36:39]
  s_add_u32 m0, s45, 143360
  s_nop 0
  buffer_load_dwordx4 v6, s[4:7], s59 offen sc1 lds
  s_add_u32 s59, s59, 20480
  v_mfma_f32_16x16x32_bf16 v[52:55], a[196:199], v[16:19], v[52:55]
  ds_read_b128 a[176:179], v2 offset:28672
  v_mfma_f32_16x16x32_bf16 v[40:43], a[200:203], v[12:15], v[40:43]
  ds_read_b128 a[180:183], v2 offset:29696
  v_mfma_f32_16x16x32_bf16 v[56:59], a[200:203], v[16:19], v[56:59]
  s_add_u32 m0, s44, 122880
  s_nop 0
  buffer_load_dwordx4 v5, s[4:7], s59 offen offset:0 sc1 lds
  v_mfma_f32_16x16x32_bf16 v[44:47], a[204:207], v[12:15], v[44:47]
  ds_read_b128 a[184:187], v2 offset:30720
  v_mfma_f32_16x16x32_bf16 v[60:63], a[204:207], v[16:19], v[60:63]
  ds_read_b128 a[188:191], v2 offset:31744
  s_waitcnt lgkmcnt(4)
  v_mfma_f32_16x16x32_bf16 v[64:67], a[160:163], a[0:3], 0
  v_mfma_f32_16x16x32_bf16 v[80:83], a[160:163], a[4:7], 0
  buffer_load_dwordx4 v5, s[4:7], s59 offen offset:1024 sc1 lds
  v_mfma_f32_16x16x32_bf16 v[68:71], a[164:167], a[0:3], 0
  ds_read_b128 a[192:195], v2 offset:32768
  v_mfma_f32_16x16x32_bf16 v[84:87], a[164:167], a[4:7], 0
  ds_read_b128 a[196:199], v2 offset:33792
  v_mfma_f32_16x16x32_bf16 v[72:75], a[168:171], a[0:3], 0
  v_mfma_f32_16x16x32_bf16 v[88:91], a[168:171], a[4:7], 0
  buffer_load_dwordx4 v5, s[4:7], s59 offen offset:2048 sc1 lds
  v_mfma_f32_16x16x32_bf16 v[76:79], a[172:175], a[0:3], 0
  ds_read_b128 a[200:203], v2 offset:34816
  v_mfma_f32_16x16x32_bf16 v[92:95], a[172:175], a[4:7], 0
  ds_read_b128 a[204:207], v2 offset:35840
  s_waitcnt lgkmcnt(4)
  v_mfma_f32_16x16x32_bf16 v[64:67], a[176:179], a[8:11], v[64:67]
  buffer_load_dword v237, v236, s[4:7], s51 offen sc1
  buffer_load_dwordx4 v5, s[4:7], s59 offen offset:3072 sc1 lds
  v_mfma_f32_16x16x32_bf16 v[80:83], a[176:179], a[12:15], v[80:83]
  ds_read_b128 a[160:163], v2 offset:36864
  ds_read_b128 a[164:167], v2 offset:37888
  v_mfma_f32_16x16x32_bf16 v[68:71], a[180:183], a[8:11], v[68:71]
  v_mul_f32 v104, v32, v128
  v_mul_f32 v105, v33, v128
  v_mfma_f32_16x16x32_bf16 v[84:87], a[180:183], a[12:15], v[84:87]
  v_mul_f32 v106, v34, v128
  v_mul_f32 v107, v35, v128
  v_mfma_f32_16x16x32_bf16 v[72:75], a[184:187], a[8:11], v[72:75]
  s_add_u32 m0, s45, 122880
  s_nop 0
  buffer_load_dwordx4 v6, s[4:7], s59 offen sc1 lds
  s_add_u32 s59, s59, 20480
  ds_read_b128 a[168:171], v2 offset:38912
  v_mfma_f32_16x16x32_bf16 v[88:91], a[184:187], a[12:15], v[88:91]
  ds_read_b128 a[172:175], v2 offset:39936
  v_mul_f32 v108, v36, v128
  v_mfma_f32_16x16x32_bf16 v[76:79], a[188:191], a[8:11], v[76:79]
  v_mul_f32 v109, v37, v128
  v_mul_f32 v110, v38, v128
  v_mfma_f32_16x16x32_bf16 v[92:95], a[188:191], a[12:15], v[92:95]
  v_mul_f32 v111, v39, v128
  v_exp_f32 v104, v104
  s_waitcnt lgkmcnt(4)
  v_mfma_f32_16x16x32_bf16 v[64:67], a[192:195], a[16:19], v[64:67]
  s_add_u32 m0, s44, 102400
  s_nop 0
  buffer_load_dwordx4 v5, s[4:7], s59 offen offset:0 sc1 lds
  v_mfma_f32_16x16x32_bf16 v[80:83], a[192:195], a[20:23], v[80:83]
  ds_read_b128 a[176:179], v2 offset:40960
  ds_read_b128 a[180:183], v2 offset:41984
  v_mfma_f32_16x16x32_bf16 v[68:71], a[196:199], a[16:19], v[68:71]
  v_mul_f32 v40, v32, v40
  v_exp_f32 v105, v105
  v_mfma_f32_16x16x32_bf16 v[84:87], a[196:199], a[20:23], v[84:87]
  v_mul_f32 v41, v33, v41
  v_exp_f32 v106, v106
  v_mfma_f32_16x16x32_bf16 v[72:75], a[200:203], a[16:19], v[72:75]
  buffer_load_dwordx4 v5, s[4:7], s59 offen offset:1024 sc1 lds
  ds_read_b128 a[184:187], v2 offset:43008
  v_mfma_f32_16x16x32_bf16 v[88:91], a[200:203], a[20:23], v[88:91]
  ds_read_b128 a[188:191], v2 offset:44032
  v_mul_f32 v42, v34, v42
  v_mfma_f32_16x16x32_bf16 v[76:79], a[204:207], a[16:19], v[76:79]
  v_exp_f32 v107, v107
  v_mul_f32 v43, v35, v43
  v_mfma_f32_16x16x32_bf16 v[92:95], a[204:207], a[20:23], v[92:95]
  v_exp_f32 v108, v108
  v_mul_f32 v44, v36, v44
  s_waitcnt lgkmcnt(4)
  v_mfma_f32_16x16x32_bf16 v[64:67], a[160:163], a[24:27], v[64:67]
  buffer_load_dwordx4 v5, s[4:7], s59 offen offset:2048 sc1 lds
  v_mfma_f32_16x16x32_bf16 v[80:83], a[160:163], a[28:31], v[80:83]
  ds_read_b128 a[192:195], v2 offset:45056
  ds_read_b128 a[196:199], v2 offset:46080
  v_mfma_f32_16x16x32_bf16 v[68:71], a[164:167], a[24:27], v[68:71]
  v_exp_f32 v109, v109
  v_mul_f32 v45, v37, v45
  v_mfma_f32_16x16x32_bf16 v[84:87], a[164:167], a[28:31], v[84:87]
  v_exp_f32 v110, v110
  v_mul_f32 v46, v38, v46
  v_mfma_f32_16x16x32_bf16 v[72:75], a[168:171], a[24:27], v[72:75]
  buffer_load_dwordx4 v5, s[4:7], s59 offen offset:3072 sc1 lds
  ds_read_b128 a[200:203], v2 offset:47104
  v_mfma_f32_16x16x32_bf16 v[88:91], a[168:171], a[28:31], v[88:91]
  ds_read_b128 a[204:207], v2 offset:48128
  v_exp_f32 v111, v111
  v_mfma_f32_16x16x32_bf16 v[76:79], a[172:175], a[24:27], v[76:79]
  v_mul_f32 v47, v39, v47
  v_fma_f32 v104, v104, v130, v130
  v_mfma_f32_16x16x32_bf16 v[92:95], a[172:175], a[28:31], v[92:95]
  v_fma_f32 v105, v105, v130, v130
  v_fma_f32 v106, v106, v130, v130
  s_waitcnt lgkmcnt(4)
  v_mfma_f32_16x16x32_bf16 v[64:67], a[176:179], a[32:35], v[64:67]
  s_add_u32 m0, s45, 102400
  s_nop 0
  buffer_load_dwordx4 v6, s[4:7], s59 offen sc1 lds
  s_add_u32 s59, s59, 20480
  v_mfma_f32_16x16x32_bf16 v[80:83], a[176:179], a[36:39], v[80:83]
  ds_read_b128 a[160:163], v2 offset:49152
  ds_read_b128 a[164:167], v2 offset:50176
  v_mfma_f32_16x16x32_bf16 v[68:71], a[180:183], a[32:35], v[68:71]
  v_fma_f32 v107, v107, v130, v130
  v_fma_f32 v108, v108, v130, v130
  v_mfma_f32_16x16x32_bf16 v[84:87], a[180:183], a[36:39], v[84:87]
  v_fma_f32 v109, v109, v130, v130
  v_fma_f32 v110, v110, v130, v130
  v_mfma_f32_16x16x32_bf16 v[72:75], a[184:187], a[32:35], v[72:75]
  s_add_u32 m0, s44, 0
  s_nop 0
  buffer_load_dwordx4 v5, s[4:7], s59 offen offset:0 sc1 lds
  ds_read_b128 a[168:171], v2 offset:51200
  v_mfma_f32_16x16x32_bf16 v[88:91], a[184:187], a[36:39], v[88:91]
  ds_read_b128 a[172:175], v2 offset:52224
  v_fma_f32 v111, v111, v130, v130
  v_mfma_f32_16x16x32_bf16 v[76:79], a[188:191], a[32:35], v[76:79]
  v_rcp_f32 v104, v104
  v_rcp_f32 v105, v105
  v_mfma_f32_16x16x32_bf16 v[92:95], a[188:191], a[36:39], v[92:95]
  v_rcp_f32 v106, v106
  v_rcp_f32 v107, v107
  s_waitcnt lgkmcnt(4)
  v_mfma_f32_16x16x32_bf16 v[64:67], a[192:195], a[40:43], v[64:67]
  buffer_load_dwordx4 v5, s[4:7], s59 offen offset:1024 sc1 lds
  v_mfma_f32_16x16x32_bf16 v[80:83], a[192:195], a[44:47], v[80:83]
  ds_read_b128 a[176:179], v2 offset:53248
  ds_read_b128 a[180:183], v2 offset:54272
  v_mfma_f32_16x16x32_bf16 v[68:71], a[196:199], a[40:43], v[68:71]
  v_rcp_f32 v108, v108
  v_rcp_f32 v109, v109
  v_mfma_f32_16x16x32_bf16 v[84:87], a[196:199], a[44:47], v[84:87]
  v_rcp_f32 v110, v110
  v_rcp_f32 v111, v111
  v_mfma_f32_16x16x32_bf16 v[72:75], a[200:203], a[40:43], v[72:75]
  ds_read_b128 a[184:187], v2 offset:55296
  v_mfma_f32_16x16x32_bf16 v[88:91], a[200:203], a[44:47], v[88:91]
  ds_read_b128 a[188:191], v2 offset:56320
  v_mul_f32 v40, v40, v104
  v_mfma_f32_16x16x32_bf16 v[76:79], a[204:207], a[40:43], v[76:79]
  v_mul_f32 v41, v41, v105
  v_mul_f32 v42, v42, v106
  v_mfma_f32_16x16x32_bf16 v[92:95], a[204:207], a[44:47], v[92:95]
  v_mul_f32 v43, v43, v107
  v_mul_f32 v44, v44, v108
  s_waitcnt lgkmcnt(4)
  v_mfma_f32_16x16x32_bf16 v[64:67], a[160:163], a[48:51], v[64:67]
  buffer_load_dwordx4 v5, s[4:7], s59 offen offset:2048 sc1 lds
  v_mfma_f32_16x16x32_bf16 v[80:83], a[160:163], a[52:55], v[80:83]
  ds_read_b128 a[192:195], v2 offset:57344
  ds_read_b128 a[196:199], v2 offset:58368
  v_mfma_f32_16x16x32_bf16 v[68:71], a[164:167], a[48:51], v[68:71]
  v_mul_f32 v45, v45, v109
  v_mul_f32 v46, v46, v110
  v_mfma_f32_16x16x32_bf16 v[84:87], a[164:167], a[52:55], v[84:87]
  v_mul_f32 v47, v47, v111
  v_cvt_pk_bf16_f32 v120, v40, v41
  v_mfma_f32_16x16x32_bf16 v[72:75], a[168:171], a[48:51], v[72:75]
  ds_read_b128 a[200:203], v2 offset:59392
  v_mfma_f32_16x16x32_bf16 v[88:91], a[168:171], a[52:55], v[88:91]
  ds_read_b128 a[204:207], v2 offset:60416
  v_cvt_pk_bf16_f32 v121, v42, v43
  v_mfma_f32_16x16x32_bf16 v[76:79], a[172:175], a[48:51], v[76:79]
  v_cvt_pk_bf16_f32 v122, v44, v45
  v_cvt_pk_bf16_f32 v123, v46, v47
  v_mfma_f32_16x16x32_bf16 v[92:95], a[172:175], a[52:55], v[92:95]
  buffer_store_dwordx4 v[120:123], v2, s[4:7], s48 offen offset:0 sc0 sc1
  v_mul_f32 v112, v48, v129
  s_waitcnt lgkmcnt(4)
  v_mfma_f32_16x16x32_bf16 v[64:67], a[176:179], a[56:59], v[64:67]
  buffer_load_dwordx4 v5, s[4:7], s59 offen offset:3072 sc1 lds
  v_mfma_f32_16x16x32_bf16 v[80:83], a[176:179], a[60:63], v[80:83]
  ds_read_b128 a[160:163], v2 offset:61440
  ds_read_b128 a[164:167], v2 offset:62464
  v_mfma_f32_16x16x32_bf16 v[68:71], a[180:183], a[56:59], v[68:71]
  v_mul_f32 v113, v49, v129
  v_mul_f32 v114, v50, v129
  v_mfma_f32_16x16x32_bf16 v[84:87], a[180:183], a[60:63], v[84:87]
  v_mul_f32 v115, v51, v129
  v_mul_f32 v116, v52, v129
  v_mfma_f32_16x16x32_bf16 v[72:75], a[184:187], a[56:59], v[72:75]
  ds_read_b128 a[168:171], v2 offset:63488
  v_mfma_f32_16x16x32_bf16 v[88:91], a[184:187], a[60:63], v[88:91]
  ds_read_b128 a[172:175], v2 offset:64512
  v_mul_f32 v117, v53, v129
  v_mfma_f32_16x16x32_bf16 v[76:79], a[188:191], a[56:59], v[76:79]
  v_mul_f32 v118, v54, v129
  v_mul_f32 v119, v55, v129
  v_mfma_f32_16x16x32_bf16 v[92:95], a[188:191], a[60:63], v[92:95]
  v_exp_f32 v112, v112
  v_mul_f32 v56, v48, v56
  s_waitcnt lgkmcnt(4)
  v_mfma_f32_16x16x32_bf16 v[64:67], a[192:195], a[64:67], v[64:67]
  s_waitcnt vmcnt(12)
  v_cmp_eq_u32 vcc, s36, v237
  s_nop 0
  s_cmp_eq_u64 vcc, -1
  s_cbranch_scc1 WDOK_16
  s_mov_b32 s27, 400000
  buffer_load_dword v250, v236, s[4:7], s51 offen sc1
POLL_17:
  s_waitcnt vmcnt(0)
  v_cmp_eq_u32 vcc, s36, v250
  s_nop 0
  s_cmp_eq_u64 vcc, -1
  s_cbranch_scc1 WDOK_16
  buffer_load_dword v250, v236, s[4:7], s51 offen sc1
  s_sub_u32 s27, s27, 1
  s_cmp_lg_u32 s27, 0
  s_cbranch_scc1 POLL_17
WDOK_16:
  v_mfma_f32_16x16x32_bf16 v[80:83], a[192:195], a[68:71], v[80:83]
  s_add_u32 m0, s45, 0
  s_nop 0
  buffer_load_dwordx4 v6, s[4:7], s59 offen sc1 lds
  s_add_u32 s59, s59, 20480
  ds_read_b128 a[176:179], v3 offset:0
  v_mfma_f32_16x16x32_bf16 v[68:71], a[196:199], a[64:67], v[68:71]
  ds_read_b128 a[180:183], v3 offset:1024
  v_exp_f32 v113, v113
  v_mfma_f32_16x16x32_bf16 v[84:87], a[196:199], a[68:71], v[84:87]
  v_mul_f32 v57, v49, v57
  v_exp_f32 v114, v114
  v_mfma_f32_16x16x32_bf16 v[72:75], a[200:203], a[64:67], v[72:75]
  v_mul_f32 v58, v50, v58
  ds_read_b128 a[184:187], v3 offset:2048
  v_mfma_f32_16x16x32_bf16 v[88:91], a[200:203], a[68:71], v[88:91]
  ds_read_b128 a[188:191], v3 offset:3072
  v_exp_f32 v115, v115
  v_mfma_f32_16x16x32_bf16 v[76:79], a[204:207], a[64:67], v[76:79]
  v_mul_f32 v59, v51, v59
  v_exp_f32 v116, v116
  v_mfma_f32_16x16x32_bf16 v[92:95], a[204:207], a[68:71], v[92:95]
  v_mul_f32 v60, v52, v60
  v_exp_f32 v117, v117
  s_waitcnt lgkmcnt(4)
  v_mfma_f32_16x16x32_bf16 v[64:67], a[160:163], a[72:75], v[64:67]
  s_barrier
  v_mfma_f32_16x16x32_bf16 v[80:83], a[160:163], a[76:79], v[80:83]
  s_add_u32 m0, s44, 20480
  s_nop 0
  buffer_load_dwordx4 v5, s[4:7], s59 offen offset:0 sc1 lds
  ds_read_b128 a[192:195], v3 offset:4096
  v_mfma_f32_16x16x32_bf16 v[68:71], a[164:167], a[72:75], v[68:71]
  ds_read_b128 a[196:199], v3 offset:5120
  v_mul_f32 v61, v53, v61
  v_mfma_f32_16x16x32_bf16 v[84:87], a[164:167], a[76:79], v[84:87]
  v_exp_f32 v118, v118
  v_mul_f32 v62, v54, v62
  v_mfma_f32_16x16x32_bf16 v[72:75], a[168:171], a[72:75], v[72:75]
  v_exp_f32 v119, v119
  ds_read_b128 a[200:203], v3 offset:6144
  v_mfma_f32_16x16x32_bf16 v[88:91], a[168:171], a[76:79], v[88:91]
  ds_read_b128 a[204:207], v3 offset:7168
  v_mul_f32 v63, v55, v63
  v_mfma_f32_16x16x32_bf16 v[76:79], a[172:175], a[72:75], v[76:79]
  v_fma_f32 v112, v112, v131, v131
  v_fma_f32 v113, v113, v131, v131
  v_mfma_f32_16x16x32_bf16 v[92:95], a[172:175], a[76:79], v[92:95]
  v_fma_f32 v114, v114, v131, v131
  v_fma_f32 v115, v115, v131, v131
  s_waitcnt lgkmcnt(4)
  v_mfma_f32_16x16x32_bf16 v[64:67], a[176:179], a[80:83], v[64:67]
  buffer_load_dwordx4 v5, s[4:7], s59 offen offset:1024 sc1 lds
  v_mfma_f32_16x16x32_bf16 v[80:83], a[176:179], a[84:87], v[80:83]
  ds_read_b128 a[160:163], v3 offset:8192
  ds_read_b128 a[164:167], v3 offset:9216
  v_mfma_f32_16x16x32_bf16 v[68:71], a[180:183], a[80:83], v[68:71]
  v_fma_f32 v116, v116, v131, v131
  v_fma_f32 v117, v117, v131, v131
  v_mfma_f32_16x16x32_bf16 v[84:87], a[180:183], a[84:87], v[84:87]
  v_fma_f32 v118, v118, v131, v131
  v_fma_f32 v119, v119, v131, v131
  v_mfma_f32_16x16x32_bf16 v[72:75], a[184:187], a[80:83], v[72:75]
  ds_read_b128 a[168:171], v3 offset:10240
  v_mfma_f32_16x16x32_bf16 v[88:91], a[184:187], a[84:87], v[88:91]
  ds_read_b128 a[172:175], v3 offset:11264
  v_rcp_f32 v112, v112
  v_mfma_f32_16x16x32_bf16 v[76:79], a[188:191], a[80:83], v[76:79]
  v_rcp_f32 v113, v113
  v_rcp_f32 v114, v114
  v_mfma_f32_16x16x32_bf16 v[92:95], a[188:191], a[84:87], v[92:95]
  v_rcp_f32 v115, v115
  v_rcp_f32 v116, v116
  s_waitcnt lgkmcnt(4)
  v_mfma_f32_16x16x32_bf16 v[64:67], a[192:195], a[88:91], v[64:67]
  buffer_load_dwordx4 v5, s[4:7], s59 offen offset:2048 sc1 lds
  v_mfma_f32_16x16x32_bf16 v[80:83], a[192:195], a[92:95], v[80:83]
  ds_read_b128 a[176:179], v3 offset:12288
  ds_read_b128 a[180:183], v3 offset:13312
  v_mfma_f32_16x16x32_bf16 v[68:71], a[196:199], a[88:91], v[68:71]
  v_rcp_f32 v117, v117
  v_rcp_f32 v118, v118
  v_mfma_f32_16x16x32_bf16 v[84:87], a[196:199], a[92:95], v[84:87]
  v_rcp_f32 v119, v119
  v_mul_f32 v56, v56, v112
  v_mfma_f32_16x16x32_bf16 v[72:75], a[200:203], a[88:91], v[72:75]
  ds_read_b128 a[184:187], v3 offset:14336
  v_mfma_f32_16x16x32_bf16 v[88:91], a[200:203], a[92:95], v[88:91]
  ds_read_b128 a[188:191], v3 offset:15360
  v_mul_f32 v57, v57, v113
  v_mfma_f32_16x16x32_bf16 v[76:79], a[204:207], a[88:91], v[76:79]
  v_mul_f32 v58, v58, v114
  v_mul_f32 v59, v59, v115
  v_mfma_f32_16x16x32_bf16 v[92:95], a[204:207], a[92:95], v[92:95]
  v_mul_f32 v60, v60, v116
  v_mul_f32 v61, v61, v117
  s_waitcnt lgkmcnt(4)
  v_mfma_f32_16x16x32_bf16 v[64:67], a[160:163], a[96:99], v[64:67]
  buffer_load_dwordx4 v5, s[4:7], s59 offen offset:3072 sc1 lds
  v_mfma_f32_16x16x32_bf16 v[80:83], a[160:163], a[100:103], v[80:83]
  ds_read_b128 a[192:195], v3 offset:16384
  ds_read_b128 a[196:199], v3 offset:17408
  v_mfma_f32_16x16x32_bf16 v[68:71], a[164:167], a[96:99], v[68:71]
  v_mul_f32 v62, v62, v118
  v_mfma_f32_16x16x32_bf16 v[84:87], a[164:167], a[100:103], v[84:87]
  v_mul_f32 v63, v63, v119
  v_cvt_pk_bf16_f32 v124, v56, v57
  v_mfma_f32_16x16x32_bf16 v[72:75], a[168:171], a[96:99], v[72:75]
  ds_read_b128 a[200:203], v3 offset:18432
  v_mfma_f32_16x16x32_bf16 v[88:91], a[168:171], a[100:103], v[88:91]
  ds_read_b128 a[204:207], v3 offset:19456
  v_cvt_pk_bf16_f32 v125, v58, v59
  v_mfma_f32_16x16x32_bf16 v[76:79], a[172:175], a[96:99], v[76:79]
  v_cvt_pk_bf16_f32 v126, v60, v61
  v_mfma_f32_16x16x32_bf16 v[92:95], a[172:175], a[100:103], v[92:95]
  v_cvt_pk_bf16_f32 v127, v62, v63
  buffer_store_dwordx4 v[124:127], v10, s[4:7], s48 offen offset:0 sc0 sc1
  s_waitcnt lgkmcnt(4)
  v_mfma_f32_16x16x32_bf16 v[64:67], a[176:179], a[104:107], v[64:67]
  v_mfma_f32_16x16x32_bf16 v[80:83], a[176:179], a[108:111], v[80:83]
  s_add_u32 m0, s45, 20480
  s_nop 0
  buffer_load_dwordx4 v6, s[4:7], s59 offen sc1 lds
  s_add_u32 s59, s59, 20480
  v_mfma_f32_16x16x32_bf16 v[68:71], a[180:183], a[104:107], v[68:71]
  v_mfma_f32_16x16x32_bf16 v[84:87], a[180:183], a[108:111], v[84:87]
  ds_read_b128 a[160:163], v3 offset:20480
  v_mfma_f32_16x16x32_bf16 v[72:75], a[184:187], a[104:107], v[72:75]
  ds_read_b128 a[164:167], v3 offset:21504
  v_mfma_f32_16x16x32_bf16 v[88:91], a[184:187], a[108:111], v[88:91]
  v_mfma_f32_16x16x32_bf16 v[76:79], a[188:191], a[104:107], v[76:79]
  ds_read_b128 a[168:171], v3 offset:22528
  v_mfma_f32_16x16x32_bf16 v[92:95], a[188:191], a[108:111], v[92:95]
  ds_read_b128 a[172:175], v3 offset:23552
  s_waitcnt lgkmcnt(4)
  v_mfma_f32_16x16x32_bf16 v[64:67], a[192:195], a[112:115], v[64:67]
  v_mfma_f32_16x16x32_bf16 v[80:83], a[192:195], a[116:119], v[80:83]
  s_add_u32 m0, s44, 40960
  s_nop 0
  buffer_load_dwordx4 v5, s[4:7], s60 offen offset:0 sc1 lds
  v_mfma_f32_16x16x32_bf16 v[68:71], a[196:199], a[112:115], v[68:71]
  v_mfma_f32_16x16x32_bf16 v[84:87], a[196:199], a[116:119], v[84:87]
  ds_read_b128 a[176:179], v3 offset:24576
  v_mfma_f32_16x16x32_bf16 v[72:75], a[200:203], a[112:115], v[72:75]
  ds_read_b128 a[180:183], v3 offset:25600
  v_mfma_f32_16x16x32_bf16 v[88:91], a[200:203], a[116:119], v[88:91]
  v_mfma_f32_16x16x32_bf16 v[76:79], a[204:207], a[112:115], v[76:79]
  ds_read_b128 a[184:187], v3 offset:26624
  v_mfma_f32_16x16x32_bf16 v[92:95], a[204:207], a[116:119], v[92:95]
  ds_read_b128 a[188:191], v3 offset:27648
  s_waitcnt lgkmcnt(4)
  v_mfma_f32_16x16x32_bf16 v[64:67], a[160:163], a[120:123], v[64:67]
  v_mfma_f32_16x16x32_bf16 v[80:83], a[160:163], a[124:127], v[80:83]
  buffer_load_dwordx4 v5, s[4:7], s60 offen offset:1024 sc1 lds
  v_mfma_f32_16x16x32_bf16 v[68:71], a[164:167], a[120:123], v[68:71]
  v_mfma_f32_16x16x32_bf16 v[84:87], a[164:167], a[124:127], v[84:87]
  ds_read_b128 a[192:195], v3 offset:28672
  v_mfma_f32_16x16x32_bf16 v[72:75], a[168:171], a[120:123], v[72:75]
  ds_read_b128 a[196:199], v3 offset:29696
  v_mfma_f32_16x16x32_bf16 v[88:91], a[168:171], a[124:127], v[88:91]
  v_mfma_f32_16x16x32_bf16 v[76:79], a[172:175], a[120:123], v[76:79]
  ds_read_b128 a[200:203], v3 offset:30720
  v_mfma_f32_16x16x32_bf16 v[92:95], a[172:175], a[124:127], v[92:95]
  ds_read_b128 a[204:207], v3 offset:31744
  s_waitcnt lgkmcnt(4)
  v_mfma_f32_16x16x32_bf16 v[64:67], a[176:179], a[128:131], v[64:67]
  v_mfma_f32_16x16x32_bf16 v[80:83], a[176:179], a[132:135], v[80:83]
  buffer_load_dwordx4 v5, s[4:7], s60 offen offset:2048 sc1 lds
  v_mfma_f32_16x16x32_bf16 v[68:71], a[180:183], a[128:131], v[68:71]
  v_mfma_f32_16x16x32_bf16 v[84:87], a[180:183], a[132:135], v[84:87]
  ds_read_b128 a[160:163], v3 offset:32768
  v_mfma_f32_16x16x32_bf16 v[72:75], a[184:187], a[128:131], v[72:75]
  ds_read_b128 a[164:167], v3 offset:33792
  v_mfma_f32_16x16x32_bf16 v[88:91], a[184:187], a[132:135], v[88:91]
  v_mfma_f32_16x16x32_bf16 v[76:79], a[188:191], a[128:131], v[76:79]
  ds_read_b128 a[168:171], v3 offset:34816
  v_mfma_f32_16x16x32_bf16 v[92:95], a[188:191], a[132:135], v[92:95]
  ds_read_b128 a[172:175], v3 offset:35840
  s_waitcnt lgkmcnt(4)
  v_mfma_f32_16x16x32_bf16 v[64:67], a[192:195], a[136:139], v[64:67]
  v_mfma_f32_16x16x32_bf16 v[80:83], a[192:195], a[140:143], v[80:83]
  buffer_load_dwordx4 v5, s[4:7], s60 offen offset:3072 sc1 lds
  v_mfma_f32_16x16x32_bf16 v[68:71], a[196:199], a[136:139], v[68:71]
  v_mfma_f32_16x16x32_bf16 v[84:87], a[196:199], a[140:143], v[84:87]
  ds_read_b128 a[176:179], v4 offset:12288
  v_mfma_f32_16x16x32_bf16 v[72:75], a[200:203], a[136:139], v[72:75]
  ds_read_b128 a[180:183], v4 offset:13312
  v_mfma_f32_16x16x32_bf16 v[88:91], a[200:203], a[140:143], v[88:91]
  v_mfma_f32_16x16x32_bf16 v[76:79], a[204:207], a[136:139], v[76:79]
  ds_read_b128 a[184:187], v4 offset:14336
  v_mfma_f32_16x16x32_bf16 v[92:95], a[204:207], a[140:143], v[92:95]
  ds_read_b128 a[188:191], v4 offset:15360
  s_waitcnt lgkmcnt(4)
  v_mfma_f32_16x16x32_bf16 v[64:67], a[160:163], a[144:147], v[64:67]
  v_mfma_f32_16x16x32_bf16 v[80:83], a[160:163], a[148:151], v[80:83]
  s_add_u32 m0, s45, 40960
  s_nop 0
  buffer_load_dwordx4 v6, s[4:7], s60 offen sc1 lds
  s_add_u32 s60, s60, 20480
  v_mfma_f32_16x16x32_bf16 v[68:71], a[164:167], a[144:147], v[68:71]
  v_mfma_f32_16x16x32_bf16 v[84:87], a[164:167], a[148:151], v[84:87]
  ds_read_b128 a[192:195], v4 offset:16384
  v_mfma_f32_16x16x32_bf16 v[72:75], a[168:171], a[144:147], v[72:75]
  ds_read_b128 a[196:199], v4 offset:17408
  v_mfma_f32_16x16x32_bf16 v[88:91], a[168:171], a[148:151], v[88:91]
  v_mfma_f32_16x16x32_bf16 v[76:79], a[172:175], a[144:147], v[76:79]
  ds_read_b128 a[200:203], v4 offset:18432
  v_mfma_f32_16x16x32_bf16 v[92:95], a[172:175], a[148:151], v[92:95]
  ds_read_b128 a[204:207], v4 offset:19456
  s_waitcnt lgkmcnt(4)
  v_mfma_f32_16x16x32_bf16 v[64:67], a[176:179], a[152:155], v[64:67]
  s_waitcnt vmcnt(17)
  v_mfma_f32_16x16x32_bf16 v[80:83], a[176:179], a[156:159], v[80:83]
  s_barrier
  v_mfma_f32_16x16x32_bf16 v[68:71], a[180:183], a[152:155], v[68:71]
  s_waitcnt vmcnt(6)
  s_mov_b64 exec, 0xff
  buffer_store_dwordx4 v[232:235], v2, s[4:7], s64 offen sc0 sc1
  s_mov_b64 exec, -1
  s_add_u32 s64, s64, 131072
  v_mfma_f32_16x16x32_bf16 v[84:87], a[180:183], a[156:159], v[84:87]
  s_add_u32 m0, s44, 61440
  s_nop 0
  buffer_load_dwordx4 v5, s[4:7], s60 offen offset:0 sc1 lds
  v_mfma_f32_16x16x32_bf16 v[72:75], a[184:187], a[152:155], v[72:75]
  ds_read_b128 a[160:163], v4 offset:20480
  v_mfma_f32_16x16x32_bf16 v[88:91], a[184:187], a[156:159], v[88:91]
  ds_read_b128 a[164:167], v4 offset:21504
  v_mfma_f32_16x16x32_bf16 v[76:79], a[188:191], a[152:155], v[76:79]
  ds_read_b128 a[168:171], v4 offset:22528
  v_mfma_f32_16x16x32_bf16 v[92:95], a[188:191], a[156:159], v[92:95]
  ds_read_b128 a[172:175], v4 offset:23552
  s_waitcnt lgkmcnt(4)
  v_mfma_f32_16x16x32_bf16 v[64:67], a[192:195], v[12:15], v[64:67]
  v_mfma_f32_16x16x32_bf16 v[80:83], a[192:195], v[16:19], v[80:83]
  buffer_load_dwordx4 v5, s[4:7], s60 offen offset:1024 sc1 lds
  v_mfma_f32_16x16x32_bf16 v[68:71], a[196:199], v[12:15], v[68:71]
  v_mfma_f32_16x16x32_bf16 v[84:87], a[196:199], v[16:19], v[84:87]
  ds_read_b128 a[176:179], v4 offset:24576
  v_mfma_f32_16x16x32_bf16 v[72:75], a[200:203], v[12:15], v[72:75]
  ds_read_b128 a[180:183], v4 offset:25600
  s_branch WOVER_8
  .p2align 12
WARM_8:
  s_setpc_b64 s[94:95]
  s_nop 0
WOVER_8:
  v_mfma_f32_16x16x32_bf16 v[88:91], a[200:203], v[16:19], v[88:91]
  v_mfma_f32_16x16x32_bf16 v[76:79], a[204:207], v[12:15], v[76:79]
  ds_read_b128 a[184:187], v4 offset:26624
  v_mfma_f32_16x16x32_bf16 v[92:95], a[204:207], v[16:19], v[92:95]
  ds_read_b128 a[188:191], v4 offset:27648
  s_waitcnt lgkmcnt(4)
  v_mfma_f32_16x16x32_bf16 v[32:35], a[160:163], a[0:3], 0
  v_mfma_f32_16x16x32_bf16 v[48:51], a[160:163], a[4:7], 0
  buffer_load_dwordx4 v5, s[4:7], s60 offen offset:2048 sc1 lds
  v_mfma_f32_16x16x32_bf16 v[36:39], a[164:167], a[0:3], 0
  v_mfma_f32_16x16x32_bf16 v[52:55], a[164:167], a[4:7], 0
  ds_read_b128 a[192:195], v4 offset:28672
  v_mfma_f32_16x16x32_bf16 v[40:43], a[168:171], a[0:3], 0
  ds_read_b128 a[196:199], v4 offset:29696
  v_mfma_f32_16x16x32_bf16 v[56:59], a[168:171], a[4:7], 0
  v_mfma_f32_16x16x32_bf16 v[44:47], a[172:175], a[0:3], 0
  ds_read_b128 a[200:203], v4 offset:30720
  v_mfma_f32_16x16x32_bf16 v[60:63], a[172:175], a[4:7], 0
  ds_read_b128 a[204:207], v4 offset:31744
  s_waitcnt lgkmcnt(4)
  v_mfma_f32_16x16x32_bf16 v[32:35], a[176:179], a[8:11], v[32:35]
  buffer_load_dwordx4 v5, s[4:7], s60 offen offset:3072 sc1 lds
  v_mfma_f32_16x16x32_bf16 v[48:51], a[176:179], a[12:15], v[48:51]
  ds_read_b128 a[160:163], v3 offset:57344
  ds_read_b128 a[164:167], v3 offset:58368
  v_mfma_f32_16x16x32_bf16 v[36:39], a[180:183], a[8:11], v[36:39]
  v_mul_f32 v104, v64, v128
  v_mul_f32 v105, v65, v128
  v_mfma_f32_16x16x32_bf16 v[52:55], a[180:183], a[12:15], v[52:55]
  v_mul_f32 v106, v66, v128
  v_mul_f32 v107, v67, v128
  v_mfma_f32_16x16x32_bf16 v[40:43], a[184:187], a[8:11], v[40:43]
  ds_read_b128 a[168:171], v3 offset:59392
  v_mfma_f32_16x16x32_bf16 v[56:59], a[184:187], a[12:15], v[56:59]
  ds_read_b128 a[172:175], v3 offset:60416
  v_mul_f32 v108, v68, v128
  v_mfma_f32_16x16x32_bf16 v[44:47], a[188:191], a[8:11], v[44:47]
  v_mul_f32 v109, v69, v128
  v_mul_f32 v110, v70, v128
  v_mfma_f32_16x16x32_bf16 v[60:63], a[188:191], a[12:15], v[60:63]
  v_mul_f32 v111, v71, v128
  v_exp_f32 v104, v104
  s_waitcnt lgkmcnt(4)
  v_mfma_f32_16x16x32_bf16 v[32:35], a[192:195], a[16:19], v[32:35]
  s_add_u32 m0, s45, 61440
  s_nop 0
  buffer_load_dwordx4 v6, s[4:7], s60 offen sc1 lds
  s_add_u32 s60, s60, 20480
  v_mfma_f32_16x16x32_bf16 v[48:51], a[192:195], a[20:23], v[48:51]
  ds_read_b128 a[176:179], v3 offset:61440
  ds_read_b128 a[180:183], v3 offset:62464
  v_mfma_f32_16x16x32_bf16 v[36:39], a[196:199], a[16:19], v[36:39]
  v_mul_f32 v72, v64, v72
  v_exp_f32 v105, v105
  v_mfma_f32_16x16x32_bf16 v[52:55], a[196:199], a[20:23], v[52:55]
  v_mul_f32 v73, v65, v73
  v_exp_f32 v106, v106
  v_mfma_f32_16x16x32_bf16 v[40:43], a[200:203], a[16:19], v[40:43]
  ds_read_b128 a[184:187], v3 offset:63488
  v_mfma_f32_16x16x32_bf16 v[56:59], a[200:203], a[20:23], v[56:59]
  ds_read_b128 a[188:191], v3 offset:64512
  v_mul_f32 v74, v66, v74
  v_mfma_f32_16x16x32_bf16 v[44:47], a[204:207], a[16:19], v[44:47]
  v_exp_f32 v107, v107
  v_mul_f32 v75, v67, v75
  v_mfma_f32_16x16x32_bf16 v[60:63], a[204:207], a[20:23], v[60:63]
  v_exp_f32 v108, v108
  v_mul_f32 v76, v68, v76
  s_waitcnt lgkmcnt(4)
  v_mfma_f32_16x16x32_bf16 v[32:35], a[160:163], a[24:27], v[32:35]
  s_add_u32 m0, s44, 81920
  s_nop 0
  buffer_load_dwordx4 v5, s[4:7], s60 offen offset:0 sc1 lds
  v_mfma_f32_16x16x32_bf16 v[48:51], a[160:163], a[28:31], v[48:51]
  ds_read_b128 a[192:195], v4 offset:0
  ds_read_b128 a[196:199], v4 offset:1024
  v_mfma_f32_16x16x32_bf16 v[36:39], a[164:167], a[24:27], v[36:39]
  v_exp_f32 v109, v109
  v_mul_f32 v77, v69, v77
  v_mfma_f32_16x16x32_bf16 v[52:55], a[164:167], a[28:31], v[52:55]
  v_exp_f32 v110, v110
  v_mul_f32 v78, v70, v78
  v_mfma_f32_16x16x32_bf16 v[40:43], a[168:171], a[24:27], v[40:43]
  ds_read_b128 a[200:203], v4 offset:2048
  v_mfma_f32_16x16x32_bf16 v[56:59], a[168:171], a[28:31], v[56:59]
  ds_read_b128 a[204:207], v4 offset:3072
  v_exp_f32 v111, v111
  v_mfma_f32_16x16x32_bf16 v[44:47], a[172:175], a[24:27], v[44:47]
  v_mul_f32 v79, v71, v79
  v_fma_f32 v104, v104, v130, v130
  v_mfma_f32_16x16x32_bf16 v[60:63], a[172:175], a[28:31], v[60:63]
  v_fma_f32 v105, v105, v130, v130
  v_fma_f32 v106, v106, v130, v130
  s_waitcnt lgkmcnt(4)
  v_mfma_f32_16x16x32_bf16 v[32:35], a[176:179], a[32:35], v[32:35]
  buffer_load_dwordx4 v5, s[4:7], s60 offen offset:1024 sc1 lds
  v_mfma_f32_16x16x32_bf16 v[48:51], a[176:179], a[36:39], v[48:51]
  ds_read_b128 a[160:163], v4 offset:4096
  ds_read_b128 a[164:167], v4 offset:5120
  v_mfma_f32_16x16x32_bf16 v[36:39], a[180:183], a[32:35], v[36:39]
  v_fma_f32 v107, v107, v130, v130
  v_fma_f32 v108, v108, v130, v130
  v_mfma_f32_16x16x32_bf16 v[52:55], a[180:183], a[36:39], v[52:55]
  v_fma_f32 v109, v109, v130, v130
  v_fma_f32 v110, v110, v130, v130
  v_mfma_f32_16x16x32_bf16 v[40:43], a[184:187], a[32:35], v[40:43]
  ds_read_b128 a[168:171], v4 offset:6144
  v_mfma_f32_16x16x32_bf16 v[56:59], a[184:187], a[36:39], v[56:59]
  ds_read_b128 a[172:175], v4 offset:7168
  v_fma_f32 v111, v111, v130, v130
  v_mfma_f32_16x16x32_bf16 v[44:47], a[188:191], a[32:35], v[44:47]
  v_rcp_f32 v104, v104
  v_rcp_f32 v105, v105
  v_mfma_f32_16x16x32_bf16 v[60:63], a[188:191], a[36:39], v[60:63]
  v_rcp_f32 v106, v106
  v_rcp_f32 v107, v107
  s_waitcnt lgkmcnt(4)
  v_mfma_f32_16x16x32_bf16 v[32:35], a[192:195], a[40:43], v[32:35]
  buffer_load_dwordx4 v5, s[4:7], s60 offen offset:2048 sc1 lds
  v_mfma_f32_16x16x32_bf16 v[48:51], a[192:195], a[44:47], v[48:51]
  ds_read_b128 a[176:179], v4 offset:8192
  ds_read_b128 a[180:183], v4 offset:9216
  v_mfma_f32_16x16x32_bf16 v[36:39], a[196:199], a[40:43], v[36:39]
  v_rcp_f32 v108, v108
  v_rcp_f32 v109, v109
  v_mfma_f32_16x16x32_bf16 v[52:55], a[196:199], a[44:47], v[52:55]
  v_rcp_f32 v110, v110
  v_rcp_f32 v111, v111
  v_mfma_f32_16x16x32_bf16 v[40:43], a[200:203], a[40:43], v[40:43]
  ds_read_b128 a[184:187], v4 offset:10240
  v_mfma_f32_16x16x32_bf16 v[56:59], a[200:203], a[44:47], v[56:59]
  ds_read_b128 a[188:191], v4 offset:11264
  v_mul_f32 v72, v72, v104
  v_mfma_f32_16x16x32_bf16 v[44:47], a[204:207], a[40:43], v[44:47]
  v_mul_f32 v73, v73, v105
  v_mul_f32 v74, v74, v106
  v_mfma_f32_16x16x32_bf16 v[60:63], a[204:207], a[44:47], v[60:63]
  v_mul_f32 v75, v75, v107
  v_mul_f32 v76, v76, v108
  s_waitcnt lgkmcnt(4)
  v_mfma_f32_16x16x32_bf16 v[32:35], a[160:163], a[48:51], v[32:35]
  buffer_load_dword v253, v30, s[4:7], s65 offen sc1
  v_mfma_f32_16x16x32_bf16 v[48:51], a[160:163], a[52:55], v[48:51]
  buffer_load_dwordx4 v5, s[4:7], s60 offen offset:3072 sc1 lds
  ds_read_b128 a[192:195], v3 offset:36864
  v_mfma_f32_16x16x32_bf16 v[36:39], a[164:167], a[48:51], v[36:39]
  ds_read_b128 a[196:199], v3 offset:37888
  v_mul_f32 v77, v77, v109
  v_mfma_f32_16x16x32_bf16 v[52:55], a[164:167], a[52:55], v[52:55]
  v_mul_f32 v78, v78, v110
  v_mul_f32 v79, v79, v111
  v_mfma_f32_16x16x32_bf16 v[40:43], a[168:171], a[48:51], v[40:43]
  v_cvt_pk_bf16_f32 v120, v72, v73
  ds_read_b128 a[200:203], v3 offset:38912
  v_mfma_f32_16x16x32_bf16 v[56:59], a[168:171], a[52:55], v[56:59]
  ds_read_b128 a[204:207], v3 offset:39936
  v_cvt_pk_bf16_f32 v121, v74, v75
  v_mfma_f32_16x16x32_bf16 v[44:47], a[172:175], a[48:51], v[44:47]
  v_cvt_pk_bf16_f32 v122, v76, v77
  v_cvt_pk_bf16_f32 v123, v78, v79
  v_mfma_f32_16x16x32_bf16 v[60:63], a[172:175], a[52:55], v[60:63]
  buffer_store_dwordx4 v[120:123], v2, s[4:7], s48 offen offset:1024 sc0 sc1
  v_mul_f32 v112, v80, v129
  s_waitcnt lgkmcnt(4)
  v_mfma_f32_16x16x32_bf16 v[32:35], a[176:179], a[56:59], v[32:35]
  s_add_u32 m0, s45, 81920
  s_nop 0
  buffer_load_dwordx4 v6, s[4:7], s60 offen sc1 lds
  s_add_u32 s60, s60, 20480
  v_mfma_f32_16x16x32_bf16 v[48:51], a[176:179], a[60:63], v[48:51]
  ds_read_b128 a[160:163], v3 offset:40960
  ds_read_b128 a[164:167], v3 offset:41984
  v_mfma_f32_16x16x32_bf16 v[36:39], a[180:183], a[56:59], v[36:39]
  v_mul_f32 v113, v81, v129
  v_mul_f32 v114, v82, v129
  v_mfma_f32_16x16x32_bf16 v[52:55], a[180:183], a[60:63], v[52:55]
  v_mul_f32 v115, v83, v129
  v_mul_f32 v116, v84, v129
  v_mfma_f32_16x16x32_bf16 v[40:43], a[184:187], a[56:59], v[40:43]
  ds_read_b128 a[168:171], v3 offset:43008
  v_mfma_f32_16x16x32_bf16 v[56:59], a[184:187], a[60:63], v[56:59]
  ds_read_b128 a[172:175], v3 offset:44032
  v_mul_f32 v117, v85, v129
  v_mfma_f32_16x16x32_bf16 v[44:47], a[188:191], a[56:59], v[44:47]
  v_mul_f32 v118, v86, v129
  v_mul_f32 v119, v87, v129
  v_mfma_f32_16x16x32_bf16 v[60:63], a[188:191], a[60:63], v[60:63]
  v_exp_f32 v112, v112
  v_mul_f32 v88, v80, v88
  s_waitcnt lgkmcnt(4)
  v_mfma_f32_16x16x32_bf16 v[32:35], a[192:195], a[64:67], v[32:35]
  s_waitcnt vmcnt(18)
  s_barrier
  v_mfma_f32_16x16x32_bf16 v[48:51], a[192:195], a[68:71], v[48:51]
  s_add_u32 m0, s44, 143360
  s_nop 0
  buffer_load_dwordx4 v5, s[4:7], s60 offen offset:0 sc1 lds
  ds_read_b128 a[176:179], v3 offset:45056
  v_mfma_f32_16x16x32_bf16 v[36:39], a[196:199], a[64:67], v[36:39]
  ds_read_b128 a[180:183], v3 offset:46080
  v_exp_f32 v113, v113
  v_mfma_f32_16x16x32_bf16 v[52:55], a[196:199], a[68:71], v[52:55]
  v_mul_f32 v89, v81, v89
  v_exp_f32 v114, v114
  v_mfma_f32_16x16x32_bf16 v[40:43], a[200:203], a[64:67], v[40:43]
  v_mul_f32 v90, v82, v90
  ds_read_b128 a[184:187], v3 offset:47104
  v_mfma_f32_16x16x32_bf16 v[56:59], a[200:203], a[68:71], v[56:59]
  ds_read_b128 a[188:191], v3 offset:48128
  v_exp_f32 v115, v115
  v_mfma_f32_16x16x32_bf16 v[44:47], a[204:207], a[64:67], v[44:47]
  v_mul_f32 v91, v83, v91
  v_exp_f32 v116, v116
  v_mfma_f32_16x16x32_bf16 v[60:63], a[204:207], a[68:71], v[60:63]
  v_mul_f32 v92, v84, v92
  v_exp_f32 v117, v117
  s_waitcnt lgkmcnt(4)
  v_mfma_f32_16x16x32_bf16 v[32:35], a[160:163], a[72:75], v[32:35]
  buffer_load_dwordx4 v5, s[4:7], s60 offen offset:1024 sc1 lds
  v_mfma_f32_16x16x32_bf16 v[48:51], a[160:163], a[76:79], v[48:51]
  ds_read_b128 a[192:195], v3 offset:49152
  ds_read_b128 a[196:199], v3 offset:50176
  v_mfma_f32_16x16x32_bf16 v[36:39], a[164:167], a[72:75], v[36:39]
  v_mul_f32 v93, v85, v93
  v_exp_f32 v118, v118
  v_mfma_f32_16x16x32_bf16 v[52:55], a[164:167], a[76:79], v[52:55]
  v_mul_f32 v94, v86, v94
  v_exp_f32 v119, v119
  v_mfma_f32_16x16x32_bf16 v[40:43], a[168:171], a[72:75], v[40:43]
  ds_read_b128 a[200:203], v3 offset:51200
  v_mfma_f32_16x16x32_bf16 v[56:59], a[168:171], a[76:79], v[56:59]
  ds_read_b128 a[204:207], v3 offset:52224
  v_mul_f32 v95, v87, v95
  v_mfma_f32_16x16x32_bf16 v[44:47], a[172:175], a[72:75], v[44:47]
  v_fma_f32 v112, v112, v131, v131
  v_fma_f32 v113, v113, v131, v131
  v_mfma_f32_16x16x32_bf16 v[60:63], a[172:175], a[76:79], v[60:63]
  v_fma_f32 v114, v114, v131, v131
  v_fma_f32 v115, v115, v131, v131
  s_waitcnt lgkmcnt(4)
  v_mfma_f32_16x16x32_bf16 v[32:35], a[176:179], a[80:83], v[32:35]
  buffer_load_dwordx4 v5, s[4:7], s60 offen offset:2048 sc1 lds
  v_mfma_f32_16x16x32_bf16 v[48:51], a[176:179], a[84:87], v[48:51]
  ds_read_b128 a[160:163], v3 offset:53248
  ds_read_b128 a[164:167], v3 offset:54272
  v_mfma_f32_16x16x32_bf16 v[36:39], a[180:183], a[80:83], v[36:39]
  v_fma_f32 v116, v116, v131, v131
  v_fma_f32 v117, v117, v131, v131
  v_mfma_f32_16x16x32_bf16 v[52:55], a[180:183], a[84:87], v[52:55]
  v_fma_f32 v118, v118, v131, v131
  v_fma_f32 v119, v119, v131, v131
  v_mfma_f32_16x16x32_bf16 v[40:43], a[184:187], a[80:83], v[40:43]
  ds_read_b128 a[168:171], v3 offset:55296
  v_mfma_f32_16x16x32_bf16 v[56:59], a[184:187], a[84:87], v[56:59]
  ds_read_b128 a[172:175], v3 offset:56320
  v_rcp_f32 v112, v112
  v_mfma_f32_16x16x32_bf16 v[44:47], a[188:191], a[80:83], v[44:47]
  v_rcp_f32 v113, v113
  v_rcp_f32 v114, v114
  v_mfma_f32_16x16x32_bf16 v[60:63], a[188:191], a[84:87], v[60:63]
  v_rcp_f32 v115, v115
  v_rcp_f32 v116, v116
  s_waitcnt lgkmcnt(4)
  v_mfma_f32_16x16x32_bf16 v[32:35], a[192:195], a[88:91], v[32:35]
  buffer_load_dwordx4 v5, s[4:7], s60 offen offset:3072 sc1 lds
  v_mfma_f32_16x16x32_bf16 v[48:51], a[192:195], a[92:95], v[48:51]
  ds_read_b128 a[176:179], v2 offset:0
  ds_read_b128 a[180:183], v2 offset:1024
  v_mfma_f32_16x16x32_bf16 v[36:39], a[196:199], a[88:91], v[36:39]
  v_rcp_f32 v117, v117
  v_rcp_f32 v118, v118
  v_mfma_f32_16x16x32_bf16 v[52:55], a[196:199], a[92:95], v[52:55]
  v_rcp_f32 v119, v119
  v_mul_f32 v88, v88, v112
  v_mfma_f32_16x16x32_bf16 v[40:43], a[200:203], a[88:91], v[40:43]
  ds_read_b128 a[184:187], v2 offset:2048
  v_mfma_f32_16x16x32_bf16 v[56:59], a[200:203], a[92:95], v[56:59]
  ds_read_b128 a[188:191], v2 offset:3072
  v_mul_f32 v89, v89, v113
  v_mfma_f32_16x16x32_bf16 v[44:47], a[204:207], a[88:91], v[44:47]
  v_mul_f32 v90, v90, v114
  v_mul_f32 v91, v91, v115
  v_mfma_f32_16x16x32_bf16 v[60:63], a[204:207], a[92:95], v[60:63]
  v_mul_f32 v92, v92, v116
  v_mul_f32 v93, v93, v117
  s_waitcnt lgkmcnt(4)
  v_mfma_f32_16x16x32_bf16 v[32:35], a[160:163], a[96:99], v[32:35]
  s_waitcnt vmcnt(7)
  v_cmp_eq_u32 vcc, s36, v253
  s_nop 0
  s_cmp_eq_u64 vcc, -1
  s_cbranch_scc1 PDOK_18
  s_mov_b32 s27, 400000
  buffer_load_dword v250, v30, s[4:7], s65 offen sc1
POLL_19:
  s_waitcnt vmcnt(0)
  v_cmp_eq_u32 vcc, s36, v250
  s_nop 0
  s_cmp_eq_u64 vcc, -1
  s_cbranch_scc1 PDOK_18
  buffer_load_dword v250, v30, s[4:7], s65 offen sc1
  s_sub_u32 s27, s27, 1
  s_cmp_lg_u32 s27, 0
  s_cbranch_scc1 POLL_19
PDOK_18:
  s_add_u32 s65, s65, 131072
  v_mfma_f32_16x16x32_bf16 v[48:51], a[160:163], a[100:103], v[48:51]
  s_add_u32 s56, s66, 0
  buffer_load_dwordx4 v[136:139], v2, s[4:7], s56 offen sc1
  ds_read_b128 a[192:195], v2 offset:4096
  v_mfma_f32_16x16x32_bf16 v[36:39], a[164:167], a[96:99], v[36:39]
  ds_read_b128 a[196:199], v2 offset:5120
  v_mul_f32 v94, v94, v118
  v_mfma_f32_16x16x32_bf16 v[52:55], a[164:167], a[100:103], v[52:55]
  v_mul_f32 v95, v95, v119
  v_cvt_pk_bf16_f32 v124, v88, v89
  v_mfma_f32_16x16x32_bf16 v[40:43], a[168:171], a[96:99], v[40:43]
  s_add_u32 s56, s66, 3072
  buffer_load_dwordx4 v[140:143], v2, s[4:7], s56 offen sc1
  ds_read_b128 a[200:203], v2 offset:6144
  v_mfma_f32_16x16x32_bf16 v[56:59], a[168:171], a[100:103], v[56:59]
  ds_read_b128 a[204:207], v2 offset:7168
  v_cvt_pk_bf16_f32 v125, v90, v91
  v_mfma_f32_16x16x32_bf16 v[44:47], a[172:175], a[96:99], v[44:47]
  v_cvt_pk_bf16_f32 v126, v92, v93
  v_cvt_pk_bf16_f32 v127, v94, v95
  v_mfma_f32_16x16x32_bf16 v[60:63], a[172:175], a[100:103], v[60:63]
  buffer_store_dwordx4 v[124:127], v10, s[4:7], s48 offen offset:1024 sc0 sc1
  s_add_u32 m0, s45, 143360
  s_nop 0
  buffer_load_dwordx4 v6, s[4:7], s60 offen sc1 lds
  s_add_u32 s60, s60, 20480
  s_waitcnt lgkmcnt(4)
  v_mfma_f32_16x16x32_bf16 v[32:35], a[176:179], a[104:107], v[32:35]
  v_mfma_f32_16x16x32_bf16 v[48:51], a[176:179], a[108:111], v[48:51]
  s_add_u32 s56, s66, 6144
  buffer_load_dwordx4 v[144:147], v2, s[4:7], s56 offen sc1
  v_mfma_f32_16x16x32_bf16 v[36:39], a[180:183], a[104:107], v[36:39]
  ds_read_b128 a[160:163], v2 offset:8192
  v_mfma_f32_16x16x32_bf16 v[52:55], a[180:183], a[108:111], v[52:55]
  ds_read_b128 a[164:167], v2 offset:9216
  v_mfma_f32_16x16x32_bf16 v[40:43], a[184:187], a[104:107], v[40:43]
  s_add_u32 s56, s66, 9216
  buffer_load_dwordx4 v[148:151], v2, s[4:7], s56 offen sc1
  v_mfma_f32_16x16x32_bf16 v[56:59], a[184:187], a[108:111], v[56:59]
  ds_read_b128 a[168:171], v2 offset:10240
  v_mfma_f32_16x16x32_bf16 v[44:47], a[188:191], a[104:107], v[44:47]
  ds_read_b128 a[172:175], v2 offset:11264
  v_mfma_f32_16x16x32_bf16 v[60:63], a[188:191], a[108:111], v[60:63]
  s_add_u32 m0, s44, 122880
  s_nop 0
  buffer_load_dwordx4 v5, s[4:7], s60 offen offset:0 sc1 lds
  s_waitcnt lgkmcnt(4)
  v_mfma_f32_16x16x32_bf16 v[32:35], a[192:195], a[112:115], v[32:35]
  v_mfma_f32_16x16x32_bf16 v[48:51], a[192:195], a[116:119], v[48:51]
  s_add_u32 s56, s66, 12288
  buffer_load_dwordx4 v[152:155], v2, s[4:7], s56 offen sc1
  v_mfma_f32_16x16x32_bf16 v[36:39], a[196:199], a[112:115], v[36:39]
  ds_read_b128 a[176:179], v2 offset:12288
  v_mfma_f32_16x16x32_bf16 v[52:55], a[196:199], a[116:119], v[52:55]
  ds_read_b128 a[180:183], v2 offset:13312
  v_mfma_f32_16x16x32_bf16 v[40:43], a[200:203], a[112:115], v[40:43]
  s_add_u32 s56, s66, 15360
  buffer_load_dwordx4 v[156:159], v2, s[4:7], s56 offen sc1
  v_mfma_f32_16x16x32_bf16 v[56:59], a[200:203], a[116:119], v[56:59]
  ds_read_b128 a[184:187], v2 offset:14336
  v_mfma_f32_16x16x32_bf16 v[44:47], a[204:207], a[112:115], v[44:47]
  ds_read_b128 a[188:191], v2 offset:15360
  v_mfma_f32_16x16x32_bf16 v[60:63], a[204:207], a[116:119], v[60:63]
  buffer_load_dwordx4 v5, s[4:7], s60 offen offset:1024 sc1 lds
  s_waitcnt lgkmcnt(4)
  v_mfma_f32_16x16x32_bf16 v[32:35], a[160:163], a[120:123], v[32:35]
  v_mfma_f32_16x16x32_bf16 v[48:51], a[160:163], a[124:127], v[48:51]
  s_add_u32 s56, s66, 18432
  buffer_load_dwordx4 v[160:163], v2, s[4:7], s56 offen sc1
  v_mfma_f32_16x16x32_bf16 v[36:39], a[164:167], a[120:123], v[36:39]
  ds_read_b128 a[192:195], v2 offset:16384
  v_mfma_f32_16x16x32_bf16 v[52:55], a[164:167], a[124:127], v[52:55]
  ds_read_b128 a[196:199], v2 offset:17408
  v_mfma_f32_16x16x32_bf16 v[40:43], a[168:171], a[120:123], v[40:43]
  s_add_u32 s56, s66, 21504
  buffer_load_dwordx4 v[164:167], v2, s[4:7], s56 offen sc1
  v_mfma_f32_16x16x32_bf16 v[56:59], a[168:171], a[124:127], v[56:59]
  ds_read_b128 a[200:203], v2 offset:18432
  v_mfma_f32_16x16x32_bf16 v[44:47], a[172:175], a[120:123], v[44:47]
  ds_read_b128 a[204:207], v2 offset:19456
  v_mfma_f32_16x16x32_bf16 v[60:63], a[172:175], a[124:127], v[60:63]
  buffer_load_dwordx4 v5, s[4:7], s60 offen offset:2048 sc1 lds
  s_waitcnt lgkmcnt(4)
  v_mfma_f32_16x16x32_bf16 v[32:35], a[176:179], a[128:131], v[32:35]
  v_mfma_f32_16x16x32_bf16 v[48:51], a[176:179], a[132:135], v[48:51]
  s_add_u32 s56, s66, 24576
  buffer_load_dwordx4 v[168:171], v2, s[4:7], s56 offen sc1
  v_mfma_f32_16x16x32_bf16 v[36:39], a[180:183], a[128:131], v[36:39]
  ds_read_b128 a[160:163], v2 offset:20480
  v_mfma_f32_16x16x32_bf16 v[52:55], a[180:183], a[132:135], v[52:55]
  ds_read_b128 a[164:167], v2 offset:21504
  v_mfma_f32_16x16x32_bf16 v[40:43], a[184:187], a[128:131], v[40:43]
  s_add_u32 s56, s66, 27648
  buffer_load_dwordx4 v[172:175], v2, s[4:7], s56 offen sc1
  v_mfma_f32_16x16x32_bf16 v[56:59], a[184:187], a[132:135], v[56:59]
  ds_read_b128 a[168:171], v2 offset:22528
  v_mfma_f32_16x16x32_bf16 v[44:47], a[188:191], a[128:131], v[44:47]
  ds_read_b128 a[172:175], v2 offset:23552
  v_mfma_f32_16x16x32_bf16 v[60:63], a[188:191], a[132:135], v[60:63]
  buffer_load_dwordx4 v5, s[4:7], s60 offen offset:3072 sc1 lds
  s_waitcnt lgkmcnt(4)
  v_mfma_f32_16x16x32_bf16 v[32:35], a[192:195], a[136:139], v[32:35]
  v_mfma_f32_16x16x32_bf16 v[48:51], a[192:195], a[140:143], v[48:51]
  s_add_u32 s56, s66, 30720
  buffer_load_dwordx4 v[176:179], v2, s[4:7], s56 offen sc1
  v_mfma_f32_16x16x32_bf16 v[36:39], a[196:199], a[136:139], v[36:39]
  ds_read_b128 a[176:179], v2 offset:24576
  v_mfma_f32_16x16x32_bf16 v[52:55], a[196:199], a[140:143], v[52:55]
  ds_read_b128 a[180:183], v2 offset:25600
  v_mfma_f32_16x16x32_bf16 v[40:43], a[200:203], a[136:139], v[40:43]
  s_add_u32 s56, s66, 33792
  buffer_load_dwordx4 v[180:183], v2, s[4:7], s56 offen sc1
  v_mfma_f32_16x16x32_bf16 v[56:59], a[200:203], a[140:143], v[56:59]
  ds_read_b128 a[184:187], v2 offset:26624
  v_mfma_f32_16x16x32_bf16 v[44:47], a[204:207], a[136:139], v[44:47]
  ds_read_b128 a[188:191], v2 offset:27648
  v_mfma_f32_16x16x32_bf16 v[60:63], a[204:207], a[140:143], v[60:63]
  s_add_u32 m0, s45, 122880
  s_nop 0
  buffer_load_dwordx4 v6, s[4:7], s60 offen sc1 lds
  s_add_u32 s60, s60, 20480
  s_waitcnt lgkmcnt(4)
  v_mfma_f32_16x16x32_bf16 v[32:35], a[160:163], a[144:147], v[32:35]
  s_barrier
  v_mfma_f32_16x16x32_bf16 v[48:51], a[160:163], a[148:151], v[48:51]
  s_add_u32 s56, s66, 36864
  buffer_load_dwordx4 v[184:187], v2, s[4:7], s56 offen sc1
  v_mfma_f32_16x16x32_bf16 v[36:39], a[164:167], a[144:147], v[36:39]
  ds_read_b128 a[192:195], v2 offset:28672
  v_mfma_f32_16x16x32_bf16 v[52:55], a[164:167], a[148:151], v[52:55]
  ds_read_b128 a[196:199], v2 offset:29696
  v_mfma_f32_16x16x32_bf16 v[40:43], a[168:171], a[144:147], v[40:43]
  s_add_u32 s56, s66, 39936
  buffer_load_dwordx4 v[188:191], v2, s[4:7], s56 offen sc1
  v_mfma_f32_16x16x32_bf16 v[56:59], a[168:171], a[148:151], v[56:59]
  ds_read_b128 a[200:203], v2 offset:30720
  v_mfma_f32_16x16x32_bf16 v[44:47], a[172:175], a[144:147], v[44:47]
  ds_read_b128 a[204:207], v2 offset:31744
  v_mfma_f32_16x16x32_bf16 v[60:63], a[172:175], a[148:151], v[60:63]
  s_add_u32 m0, s44, 102400
  s_nop 0
  buffer_load_dwordx4 v5, s[4:7], s60 offen offset:0 sc1 lds
  s_waitcnt lgkmcnt(4)
  v_mfma_f32_16x16x32_bf16 v[32:35], a[176:179], a[152:155], v[32:35]
  v_mfma_f32_16x16x32_bf16 v[48:51], a[176:179], a[156:159], v[48:51]
  s_waitcnt vmcnt(19)
  s_mov_b64 exec, 0xff
  buffer_store_dwordx4 v[232:235], v2, s[4:7], s64 offen sc0 sc1
  s_mov_b64 exec, -1
  s_add_u32 s64, s64, 131072
  v_mfma_f32_16x16x32_bf16 v[36:39], a[180:183], a[152:155], v[36:39]
  v_mfma_f32_16x16x32_bf16 v[52:55], a[180:183], a[156:159], v[52:55]
  s_add_u32 s56, s66, 43008
  buffer_load_dwordx4 v[192:195], v2, s[4:7], s56 offen sc1
  v_mfma_f32_16x16x32_bf16 v[40:43], a[184:187], a[152:155], v[40:43]
  v_mfma_f32_16x16x32_bf16 v[56:59], a[184:187], a[156:159], v[56:59]
  s_add_u32 s56, s66, 46080
  buffer_load_dwordx4 v[196:199], v2, s[4:7], s56 offen sc1
  v_mfma_f32_16x16x32_bf16 v[44:47], a[188:191], a[152:155], v[44:47]
  v_mfma_f32_16x16x32_bf16 v[60:63], a[188:191], a[156:159], v[60:63]
  buffer_load_dwordx4 v5, s[4:7], s60 offen offset:1024 sc1 lds
  s_waitcnt lgkmcnt(0)
  v_mfma_f32_16x16x32_bf16 v[32:35], a[192:195], v[12:15], v[32:35]
  v_mfma_f32_16x16x32_bf16 v[48:51], a[192:195], v[16:19], v[48:51]
  v_mfma_f32_16x16x32_bf16 v[36:39], a[196:199], v[12:15], v[36:39]
  v_mfma_f32_16x16x32_bf16 v[52:55], a[196:199], v[16:19], v[52:55]
  v_mfma_f32_16x16x32_bf16 v[40:43], a[200:203], v[12:15], v[40:43]
  v_mfma_f32_16x16x32_bf16 v[56:59], a[200:203], v[16:19], v[56:59]
  v_mfma_f32_16x16x32_bf16 v[44:47], a[204:207], v[12:15], v[44:47]
  v_mfma_f32_16x16x32_bf16 v[60:63], a[204:207], v[16:19], v[60:63]
  buffer_load_dwordx4 v5, s[4:7], s60 offen offset:2048 sc1 lds
  s_waitcnt vmcnt(8)
  s_barrier
  ds_read_b128 a[0:3], v2 offset:40960
  ds_read_b128 a[4:7], v2 offset:41984
  ds_read_b128 a[8:11], v2 offset:43008
  ds_read_b128 a[12:15], v2 offset:44032
  ds_read_b128 a[16:19], v2 offset:45056
  ds_read_b128 a[20:23], v2 offset:46080
  ds_read_b128 a[24:27], v2 offset:47104
  ds_read_b128 a[28:31], v2 offset:48128
  ds_read_b128 a[32:35], v2 offset:49152
  ds_read_b128 a[36:39], v2 offset:50176
  ds_read_b128 a[40:43], v2 offset:51200
  ds_read_b128 a[44:47], v2 offset:52224
  ds_read_b128 a[48:51], v2 offset:53248
  ds_read_b128 a[52:55], v2 offset:54272
  ds_read_b128 a[56:59], v2 offset:55296
  v_pk_mul_f32 v[104:105], v[32:33], v[128:129] op_sel:[0,0] op_sel_hi:[1,0]
  v_pk_mul_f32 v[106:107], v[34:35], v[128:129] op_sel:[0,0] op_sel_hi:[1,0]
  v_pk_mul_f32 v[108:109], v[36:37], v[128:129] op_sel:[0,0] op_sel_hi:[1,0]
  v_pk_mul_f32 v[110:111], v[38:39], v[128:129] op_sel:[0,0] op_sel_hi:[1,0]
  buffer_load_dwordx4 v5, s[4:7], s60 offen offset:3072 sc1 lds
  v_exp_f32 v104, v104
  v_exp_f32 v105, v105
  v_exp_f32 v106, v106
  v_exp_f32 v107, v107
  s_add_u32 m0, s45, 102400
  s_nop 0
  buffer_load_dwordx4 v6, s[4:7], s60 offen sc1 lds
  s_add_u32 s60, s60, 20480
  v_exp_f32 v108, v108
  v_exp_f32 v109, v109
  v_exp_f32 v110, v110
  v_exp_f32 v111, v111
  s_add_u32 m0, s44, 0
  s_nop 0
  buffer_load_dwordx4 v5, s[4:7], s60 offen offset:0 sc1 lds
  v_pk_mul_f32 v[40:41], v[32:33], v[40:41]
  v_pk_mul_f32 v[42:43], v[34:35], v[42:43]
  v_pk_mul_f32 v[44:45], v[36:37], v[44:45]
  v_pk_mul_f32 v[46:47], v[38:39], v[46:47]
  buffer_load_dwordx4 v5, s[4:7], s60 offen offset:1024 sc1 lds
  v_pk_fma_f32 v[104:105], v[104:105], v[130:131], v[130:131] op_sel:[0,0,0] op_sel_hi:[1,0,0]
  v_pk_fma_f32 v[106:107], v[106:107], v[130:131], v[130:131] op_sel:[0,0,0] op_sel_hi:[1,0,0]
  v_pk_fma_f32 v[108:109], v[108:109], v[130:131], v[130:131] op_sel:[0,0,0] op_sel_hi:[1,0,0]
  v_pk_fma_f32 v[110:111], v[110:111], v[130:131], v[130:131] op_sel:[0,0,0] op_sel_hi:[1,0,0]
  buffer_load_dwordx4 v5, s[4:7], s60 offen offset:2048 sc1 lds
  v_rcp_f32 v104, v104
  v_rcp_f32 v105, v105
  v_rcp_f32 v106, v106
  v_rcp_f32 v107, v107
  buffer_load_dwordx4 v5, s[4:7], s60 offen offset:3072 sc1 lds
  v_rcp_f32 v108, v108
  v_rcp_f32 v109, v109
  v_rcp_f32 v110, v110
  v_rcp_f32 v111, v111
  s_add_u32 m0, s45, 0
  s_nop 0
  buffer_load_dwordx4 v6, s[4:7], s60 offen sc1 lds
  s_add_u32 s60, s60, 20480
  v_pk_mul_f32 v[40:41], v[40:41], v[104:105]
  v_pk_mul_f32 v[42:43], v[42:43], v[106:107]
  buffer_load_dword v253, v30, s[4:7], s65 offen sc1
  v_pk_mul_f32 v[44:45], v[44:45], v[108:109]
  v_pk_mul_f32 v[46:47], v[46:47], v[110:111]
  s_add_u32 m0, s44, 20480
  s_nop 0
  buffer_load_dwordx4 v5, s[4:7], s60 offen offset:0 sc1 lds
  v_cvt_pk_bf16_f32 v120, v40, v41
  v_cvt_pk_bf16_f32 v121, v42, v43
  v_cvt_pk_bf16_f32 v122, v44, v45
  v_cvt_pk_bf16_f32 v123, v46, v47
  buffer_load_dwordx4 v5, s[4:7], s60 offen offset:1024 sc1 lds
  buffer_store_dwordx4 v[120:123], v2, s[4:7], s48 offen offset:2048 sc0 sc1
  v_pk_mul_f32 v[112:113], v[48:49], v[128:129] op_sel:[0,1] op_sel_hi:[1,1]
  v_pk_mul_f32 v[114:115], v[50:51], v[128:129] op_sel:[0,1] op_sel_hi:[1,1]
  v_pk_mul_f32 v[116:117], v[52:53], v[128:129] op_sel:[0,1] op_sel_hi:[1,1]
  buffer_load_dwordx4 v5, s[4:7], s60 offen offset:2048 sc1 lds
  v_pk_mul_f32 v[118:119], v[54:55], v[128:129] op_sel:[0,1] op_sel_hi:[1,1]
  v_exp_f32 v112, v112
  v_exp_f32 v113, v113
  v_exp_f32 v114, v114
  buffer_load_dwordx4 v5, s[4:7], s60 offen offset:3072 sc1 lds
  v_exp_f32 v115, v115
  v_exp_f32 v116, v116
  v_exp_f32 v117, v117
  v_exp_f32 v118, v118
  s_add_u32 m0, s45, 20480
  s_nop 0
  buffer_load_dwordx4 v6, s[4:7], s60 offen sc1 lds
  s_add_u32 s60, s60, 20480
  v_exp_f32 v119, v119
  v_pk_mul_f32 v[56:57], v[48:49], v[56:57]
  v_pk_mul_f32 v[58:59], v[50:51], v[58:59]
  v_pk_mul_f32 v[60:61], v[52:53], v[60:61]
  v_pk_mul_f32 v[62:63], v[54:55], v[62:63]
  v_pk_fma_f32 v[112:113], v[112:113], v[130:131], v[130:131] op_sel:[0,1,1] op_sel_hi:[1,1,1]
  v_pk_fma_f32 v[114:115], v[114:115], v[130:131], v[130:131] op_sel:[0,1,1] op_sel_hi:[1,1,1]
  v_pk_fma_f32 v[116:117], v[116:117], v[130:131], v[130:131] op_sel:[0,1,1] op_sel_hi:[1,1,1]
  v_pk_fma_f32 v[118:119], v[118:119], v[130:131], v[130:131] op_sel:[0,1,1] op_sel_hi:[1,1,1]
  v_rcp_f32 v112, v112
  v_rcp_f32 v113, v113
  v_rcp_f32 v114, v114
  v_rcp_f32 v115, v115
  v_rcp_f32 v116, v116
  v_rcp_f32 v117, v117
  v_rcp_f32 v118, v118
  v_rcp_f32 v119, v119
  v_pk_mul_f32 v[56:57], v[56:57], v[112:113]
  v_pk_mul_f32 v[58:59], v[58:59], v[114:115]
  v_pk_mul_f32 v[60:61], v[60:61], v[116:117]
  v_pk_mul_f32 v[62:63], v[62:63], v[118:119]
  v_cvt_pk_bf16_f32 v124, v56, v57
  v_cvt_pk_bf16_f32 v125, v58, v59
  v_cvt_pk_bf16_f32 v126, v60, v61
  v_cvt_pk_bf16_f32 v127, v62, v63
  buffer_store_dwordx4 v[124:127], v10, s[4:7], s48 offen offset:2048 sc0 sc1
  s_waitcnt lgkmcnt(10)
  v_mfma_f32_16x16x32_bf16 v[64:67], a[0:3], v[136:139], 0
  v_mfma_f32_16x16x32_bf16 v[68:71], a[4:7], v[136:139], 0
  s_branch WOVER_9
  .p2align 12
WARM_9:
  s_setpc_b64 s[94:95]
  s_nop 0
WOVER_9:
  ds_read_b128 a[60:63], v2 offset:56320
  v_mfma_f32_16x16x32_bf16 v[72:75], a[8:11], v[136:139], 0
  ds_read_b128 a[64:67], v2 offset:57344
  ds_read_b128 a[68:71], v2 offset:58368
  v_mfma_f32_16x16x32_bf16 v[76:79], a[12:15], v[136:139], 0
  v_mfma_f32_16x16x32_bf16 v[80:83], a[16:19], v[136:139], 0
  ds_read_b128 a[72:75], v2 offset:59392
  ds_read_b128 a[76:79], v2 offset:60416
  s_waitcnt lgkmcnt(10)
  v_mfma_f32_16x16x32_bf16 v[64:67], a[20:23], v[140:143], v[64:67]
  v_mfma_f32_16x16x32_bf16 v[68:71], a[24:27], v[140:143], v[68:71]
  ds_read_b128 a[0:3], v2 offset:61440
  v_mfma_f32_16x16x32_bf16 v[72:75], a[28:31], v[140:143], v[72:75]
  ds_read_b128 a[4:7], v2 offset:62464
  ds_read_b128 a[8:11], v2 offset:63488
  v_mfma_f32_16x16x32_bf16 v[76:79], a[32:35], v[140:143], v[76:79]
  v_mfma_f32_16x16x32_bf16 v[80:83], a[36:39], v[140:143], v[80:83]
  ds_read_b128 a[12:15], v2 offset:64512
  ds_read_b128 a[16:19], v3 offset:0
  s_waitcnt lgkmcnt(10)
  v_mfma_f32_16x16x32_bf16 v[64:67], a[40:43], v[144:147], v[64:67]
  v_mfma_f32_16x16x32_bf16 v[68:71], a[44:47], v[144:147], v[68:71]
  ds_read_b128 a[20:23], v3 offset:1024
  v_mfma_f32_16x16x32_bf16 v[72:75], a[48:51], v[144:147], v[72:75]
  ds_read_b128 a[24:27], v3 offset:2048
  ds_read_b128 a[28:31], v3 offset:3072
  v_mfma_f32_16x16x32_bf16 v[76:79], a[52:55], v[144:147], v[76:79]
  v_mfma_f32_16x16x32_bf16 v[80:83], a[56:59], v[144:147], v[80:83]
  ds_read_b128 a[32:35], v3 offset:4096
  ds_read_b128 a[36:39], v3 offset:5120
  s_waitcnt lgkmcnt(10)
  v_mfma_f32_16x16x32_bf16 v[64:67], a[60:63], v[148:151], v[64:67]
  s_waitcnt vmcnt(7)
  v_cmp_eq_u32 vcc, s36, v253
  s_nop 0
  s_cmp_eq_u64 vcc, -1
  s_cbranch_scc1 PDOK_20
  s_mov_b32 s27, 400000
  buffer_load_dword v250, v30, s[4:7], s65 offen sc1
POLL_21:
  s_waitcnt vmcnt(0)
  v_cmp_eq_u32 vcc, s36, v250
  s_nop 0
  s_cmp_eq_u64 vcc, -1
  s_cbranch_scc1 PDOK_20
  buffer_load_dword v250, v30, s[4:7], s65 offen sc1
  s_sub_u32 s27, s27, 1
  s_cmp_lg_u32 s27, 0
  s_cbranch_scc1 POLL_21
PDOK_20:
  s_add_u32 s65, s65, 131072
  v_mfma_f32_16x16x32_bf16 v[68:71], a[64:67], v[148:151], v[68:71]
  s_add_u32 s56, s66, 1024
  buffer_load_dwordx4 v[200:203], v2, s[4:7], s56 offen sc1
  ds_read_b128 a[40:43], v3 offset:6144
  v_mfma_f32_16x16x32_bf16 v[72:75], a[68:71], v[148:151], v[72:75]
  ds_read_b128 a[44:47], v3 offset:7168
  v_mfma_f32_16x16x32_bf16 v[76:79], a[72:75], v[148:151], v[76:79]
  ds_read_b128 a[48:51], v3 offset:8192
  s_add_u32 s56, s66, 4096
  buffer_load_dwordx4 v[204:207], v2, s[4:7], s56 offen sc1
  v_mfma_f32_16x16x32_bf16 v[80:83], a[76:79], v[148:151], v[80:83]
  ds_read_b128 a[52:55], v3 offset:9216
  ds_read_b128 a[56:59], v3 offset:10240
  s_waitcnt lgkmcnt(10)
  v_mfma_f32_16x16x32_bf16 v[64:67], a[0:3], v[152:155], v[64:67]
  s_add_u32 s56, s66, 7168
  buffer_load_dwordx4 v[208:211], v2, s[4:7], s56 offen sc1
  v_mfma_f32_16x16x32_bf16 v[68:71], a[4:7], v[152:155], v[68:71]
  ds_read_b128 a[60:63], v3 offset:11264
  v_mfma_f32_16x16x32_bf16 v[72:75], a[8:11], v[152:155], v[72:75]
  ds_read_b128 a[64:67], v3 offset:12288
  ds_read_b128 a[68:71], v3 offset:13312
  v_mfma_f32_16x16x32_bf16 v[76:79], a[12:15], v[152:155], v[76:79]
  s_add_u32 s56, s66, 10240
  buffer_load_dwordx4 v[212:215], v2, s[4:7], s56 offen sc1
  v_mfma_f32_16x16x32_bf16 v[80:83], a[16:19], v[152:155], v[80:83]
  ds_read_b128 a[72:75], v3 offset:14336
  ds_read_b128 a[76:79], v3 offset:15360
  s_waitcnt lgkmcnt(10)
  v_mfma_f32_16x16x32_bf16 v[64:67], a[20:23], v[156:159], v[64:67]
  s_add_u32 s56, s66, 13312
  buffer_load_dwordx4 v[216:219], v2, s[4:7], s56 offen sc1
  v_mfma_f32_16x16x32_bf16 v[68:71], a[24:27], v[156:159], v[68:71]
  ds_read_b128 a[0:3], v3 offset:16384
  v_mfma_f32_16x16x32_bf16 v[72:75], a[28:31], v[156:159], v[72:75]
  ds_read_b128 a[4:7], v3 offset:17408
  ds_read_b128 a[8:11], v3 offset:18432
  v_mfma_f32_16x16x32_bf16 v[76:79], a[32:35], v[156:159], v[76:79]
  s_add_u32 s56, s66, 16384
  buffer_load_dwordx4 v[220:223], v2, s[4:7], s56 offen sc1
  v_mfma_f32_16x16x32_bf16 v[80:83], a[36:39], v[156:159], v[80:83]
  ds_read_b128 a[12:15], v3 offset:19456
  ds_read_b128 a[16:19], v3 offset:20480
  s_waitcnt lgkmcnt(10)
  v_mfma_f32_16x16x32_bf16 v[64:67], a[40:43], v[160:163], v[64:67]
  s_add_u32 s56, s66, 19456
  buffer_load_dwordx4 v[224:227], v2, s[4:7], s56 offen sc1
  v_mfma_f32_16x16x32_bf16 v[68:71], a[44:47], v[160:163], v[68:71]
  ds_read_b128 a[20:23], v3 offset:21504
  v_mfma_f32_16x16x32_bf16 v[72:75], a[48:51], v[160:163], v[72:75]
  ds_read_b128 a[24:27], v3 offset:22528
  ds_read_b128 a[28:31], v3 offset:23552
  v_mfma_f32_16x16x32_bf16 v[76:79], a[52:55], v[160:163], v[76:79]
  s_add_u32 s56, s66, 22528
  buffer_load_dwordx4 v[228:231], v2, s[4:7], s56 offen sc1
  v_mfma_f32_16x16x32_bf16 v[80:83], a[56:59], v[160:163], v[80:83]
  ds_read_b128 a[32:35], v3 offset:24576
  ds_read_b128 a[36:39], v3 offset:25600
  s_waitcnt lgkmcnt(10)
  v_mfma_f32_16x16x32_bf16 v[64:67], a[60:63], v[164:167], v[64:67]
  s_add_u32 s56, s66, 25600
  buffer_load_dwordx4 v[136:139], v2, s[4:7], s56 offen sc1
  v_mfma_f32_16x16x32_bf16 v[68:71], a[64:67], v[164:167], v[68:71]
  ds_read_b128 a[40:43], v3 offset:26624
  v_mfma_f32_16x16x32_bf16 v[72:75], a[68:71], v[164:167], v[72:75]
  ds_read_b128 a[44:47], v3 offset:27648
  ds_read_b128 a[48:51], v3 offset:28672
  v_mfma_f32_16x16x32_bf16 v[76:79], a[72:75], v[164:167], v[76:79]
  s_add_u32 s56, s66, 28672
  buffer_load_dwordx4 v[140:143], v2, s[4:7], s56 offen sc1
  v_mfma_f32_16x16x32_bf16 v[80:83], a[76:79], v[164:167], v[80:83]
  ds_read_b128 a[52:55], v3 offset:29696
  ds_read_b128 a[56:59], v3 offset:30720
  s_waitcnt lgkmcnt(10)
  v_mfma_f32_16x16x32_bf16 v[64:67], a[0:3], v[168:171], v[64:67]
  s_waitcnt vmcnt(10)
  s_mov_b64 exec, 0xff
  buffer_store_dwordx4 v[232:235], v2, s[4:7], s64 offen sc0 sc1
  s_mov_b64 exec, -1
  s_add_u32 s64, s64, 131072
  v_mfma_f32_16x16x32_bf16 v[68:71], a[4:7], v[168:171], v[68:71]
  s_add_u32 s56, s66, 31744
  buffer_load_dwordx4 v[144:147], v2, s[4:7], s56 offen sc1
  ds_read_b128 a[60:63], v3 offset:31744
  v_mfma_f32_16x16x32_bf16 v[72:75], a[8:11], v[168:171], v[72:75]
  ds_read_b128 a[64:67], v3 offset:32768
  v_mfma_f32_16x16x32_bf16 v[76:79], a[12:15], v[168:171], v[76:79]
  ds_read_b128 a[68:71], v3 offset:33792
  s_add_u32 s56, s66, 34816
  buffer_load_dwordx4 v[148:151], v2, s[4:7], s56 offen sc1
  v_mfma_f32_16x16x32_bf16 v[80:83], a[16:19], v[168:171], v[80:83]
  ds_read_b128 a[72:75], v3 offset:34816
  ds_read_b128 a[76:79], v3 offset:35840
  s_waitcnt lgkmcnt(10)
  v_mfma_f32_16x16x32_bf16 v[64:67], a[20:23], v[172:175], v[64:67]
  s_barrier
  v_mfma_f32_16x16x32_bf16 v[68:71], a[24:27], v[172:175], v[68:71]
  s_add_u32 s56, s66, 37888
  buffer_load_dwordx4 v[152:155], v2, s[4:7], s56 offen sc1
  v_mfma_f32_16x16x32_bf16 v[72:75], a[28:31], v[172:175], v[72:75]
  ds_read_b128 a[0:3], v4 offset:12288
  ds_read_b128 a[4:7], v4 offset:13312
  v_mfma_f32_16x16x32_bf16 v[76:79], a[32:35], v[172:175], v[76:79]
  ds_read_b128 a[8:11], v4 offset:14336
  s_add_u32 s56, s66, 40960
  buffer_load_dwordx4 v[156:159], v2, s[4:7], s56 offen sc1
  v_mfma_f32_16x16x32_bf16 v[80:83], a[36:39], v[172:175], v[80:83]
  ds_read_b128 a[12:15], v4 offset:15360
  ds_read_b128 a[16:19], v4 offset:16384
  s_waitcnt lgkmcnt(10)
  v_mfma_f32_16x16x32_bf16 v[64:67], a[40:43], v[176:179], v[64:67]
  s_add_u32 s56, s66, 44032
  buffer_load_dwordx4 v[160:163], v2, s[4:7], s56 offen sc1
  v_mfma_f32_16x16x32_bf16 v[68:71], a[44:47], v[176:179], v[68:71]
  ds_read_b128 a[20:23], v4 offset:17408
  v_mfma_f32_16x16x32_bf16 v[72:75], a[48:51], v[176:179], v[72:75]
  ds_read_b128 a[24:27], v4 offset:18432
  ds_read_b128 a[28:31], v4 offset:19456
  v_mfma_f32_16x16x32_bf16 v[76:79], a[52:55], v[176:179], v[76:79]
  s_add_u32 s56, s66, 47104
  buffer_load_dwordx4 v[164:167], v2, s[4:7], s56 offen sc1
  v_mfma_f32_16x16x32_bf16 v[80:83], a[56:59], v[176:179], v[80:83]
  ds_read_b128 a[32:35], v4 offset:20480
  ds_read_b128 a[36:39], v4 offset:21504
  s_waitcnt lgkmcnt(10)
  v_mfma_f32_16x16x32_bf16 v[64:67], a[60:63], v[180:183], v[64:67]
  s_add_u32 m0, s44, 40960
  s_nop 0
  buffer_load_dwordx4 v5, s[4:7], s60 offen offset:0 sc1 lds
  v_mfma_f32_16x16x32_bf16 v[68:71], a[64:67], v[180:183], v[68:71]
  ds_read_b128 a[40:43], v4 offset:22528
  v_mfma_f32_16x16x32_bf16 v[72:75], a[68:71], v[180:183], v[72:75]
  ds_read_b128 a[44:47], v4 offset:23552
  ds_read_b128 a[48:51], v4 offset:24576
  v_mfma_f32_16x16x32_bf16 v[76:79], a[72:75], v[180:183], v[76:79]
  buffer_load_dwordx4 v5, s[4:7], s60 offen offset:1024 sc1 lds
  v_mfma_f32_16x16x32_bf16 v[80:83], a[76:79], v[180:183], v[80:83]
  ds_read_b128 a[52:55], v4 offset:25600
  ds_read_b128 a[56:59], v4 offset:26624
  s_waitcnt lgkmcnt(10)
  v_mfma_f32_16x16x32_bf16 v[64:67], a[0:3], v[184:187], v[64:67]
  buffer_load_dwordx4 v5, s[4:7], s60 offen offset:2048 sc1 lds
  v_mfma_f32_16x16x32_bf16 v[68:71], a[4:7], v[184:187], v[68:71]
  ds_read_b128 a[60:63], v4 offset:27648
  v_mfma_f32_16x16x32_bf16 v[72:75], a[8:11], v[184:187], v[72:75]
  ds_read_b128 a[64:67], v4 offset:28672
  ds_read_b128 a[68:71], v4 offset:29696
  v_mfma_f32_16x16x32_bf16 v[76:79], a[12:15], v[184:187], v[76:79]
  buffer_load_dwordx4 v5, s[4:7], s60 offen offset:3072 sc1 lds
  v_mfma_f32_16x16x32_bf16 v[80:83], a[16:19], v[184:187], v[80:83]
  ds_read_b128 a[72:75], v4 offset:30720
  ds_read_b128 a[76:79], v4 offset:31744
  s_waitcnt lgkmcnt(10)
  v_mfma_f32_16x16x32_bf16 v[64:67], a[20:23], v[188:191], v[64:67]
  s_add_u32 m0, s45, 40960
  s_nop 0
  buffer_load_dwordx4 v6, s[4:7], s60 offen sc1 lds
  s_add_u32 s60, s60, 20480
  v_mfma_f32_16x16x32_bf16 v[68:71], a[24:27], v[188:191], v[68:71]
  ds_read_b128 a[0:3], v3 offset:57344
  v_mfma_f32_16x16x32_bf16 v[72:75], a[28:31], v[188:191], v[72:75]
  ds_read_b128 a[4:7], v3 offset:58368
  ds_read_b128 a[8:11], v3 offset:59392
  v_mfma_f32_16x16x32_bf16 v[76:79], a[32:35], v[188:191], v[76:79]
  s_add_u32 m0, s44, 61440
  s_nop 0
  buffer_load_dwordx4 v5, s[4:7], s60 offen offset:0 sc1 lds
  v_mfma_f32_16x16x32_bf16 v[80:83], a[36:39], v[188:191], v[80:83]
  ds_read_b128 a[12:15], v3 offset:60416
  ds_read_b128 a[16:19], v3 offset:61440
  s_waitcnt lgkmcnt(10)
  v_mfma_f32_16x16x32_bf16 v[64:67], a[40:43], v[192:195], v[64:67]
  buffer_load_dwordx4 v5, s[4:7], s60 offen offset:1024 sc1 lds
  v_mfma_f32_16x16x32_bf16 v[68:71], a[44:47], v[192:195], v[68:71]
  ds_read_b128 a[20:23], v3 offset:62464
  v_mfma_f32_16x16x32_bf16 v[72:75], a[48:51], v[192:195], v[72:75]
  ds_read_b128 a[24:27], v3 offset:63488
  ds_read_b128 a[28:31], v3 offset:64512
  v_mfma_f32_16x16x32_bf16 v[76:79], a[52:55], v[192:195], v[76:79]
  buffer_load_dwordx4 v5, s[4:7], s60 offen offset:2048 sc1 lds
  v_mfma_f32_16x16x32_bf16 v[80:83], a[56:59], v[192:195], v[80:83]
  ds_read_b128 a[32:35], v4 offset:0
  ds_read_b128 a[36:39], v4 offset:1024
  s_waitcnt lgkmcnt(10)
  v_mfma_f32_16x16x32_bf16 v[64:67], a[60:63], v[196:199], v[64:67]
  buffer_load_dword v253, v30, s[4:7], s65 offen sc1
  v_mfma_f32_16x16x32_bf16 v[68:71], a[64:67], v[196:199], v[68:71]
  buffer_load_dwordx4 v5, s[4:7], s60 offen offset:3072 sc1 lds
  ds_read_b128 a[40:43], v4 offset:2048
  v_mfma_f32_16x16x32_bf16 v[72:75], a[68:71], v[196:199], v[72:75]
  ds_read_b128 a[44:47], v4 offset:3072
  v_mfma_f32_16x16x32_bf16 v[76:79], a[72:75], v[196:199], v[76:79]
  ds_read_b128 a[48:51], v4 offset:4096
  s_add_u32 m0, s45, 61440
  s_nop 0
  buffer_load_dwordx4 v6, s[4:7], s60 offen sc1 lds
  s_add_u32 s60, s60, 20480
  v_mfma_f32_16x16x32_bf16 v[80:83], a[76:79], v[196:199], v[80:83]
  ds_read_b128 a[52:55], v4 offset:5120
  ds_read_b128 a[56:59], v4 offset:6144
  s_waitcnt lgkmcnt(10)
  s_waitcnt vmcnt(27)
  v_mfma_f32_16x16x32_bf16 v[64:67], a[0:3], v[200:203], v[64:67]
  v_mfma_f32_16x16x32_bf16 v[68:71], a[4:7], v[200:203], v[68:71]
  ds_read_b128 a[60:63], v4 offset:7168
  v_mfma_f32_16x16x32_bf16 v[72:75], a[8:11], v[200:203], v[72:75]
  ds_read_b128 a[64:67], v4 offset:8192
  ds_read_b128 a[68:71], v4 offset:9216
  v_mfma_f32_16x16x32_bf16 v[76:79], a[12:15], v[200:203], v[76:79]
  v_mfma_f32_16x16x32_bf16 v[80:83], a[16:19], v[200:203], v[80:83]
  ds_read_b128 a[72:75], v4 offset:10240
  ds_read_b128 a[76:79], v4 offset:11264
  s_waitcnt lgkmcnt(10)
  s_waitcnt vmcnt(26)
  v_mfma_f32_16x16x32_bf16 v[64:67], a[20:23], v[204:207], v[64:67]
  s_barrier
  v_mfma_f32_16x16x32_bf16 v[68:71], a[24:27], v[204:207], v[68:71]
  s_add_u32 m0, s44, 81920
  s_nop 0
  buffer_load_dwordx4 v5, s[4:7], s60 offen offset:0 sc1 lds
  v_mfma_f32_16x16x32_bf16 v[72:75], a[28:31], v[204:207], v[72:75]
  ds_read_b128 a[0:3], v3 offset:36864
  ds_read_b128 a[4:7], v3 offset:37888
  v_mfma_f32_16x16x32_bf16 v[76:79], a[32:35], v[204:207], v[76:79]
  ds_read_b128 a[8:11], v3 offset:38912
  buffer_load_dwordx4 v5, s[4:7], s60 offen offset:1024 sc1 lds
  v_mfma_f32_16x16x32_bf16 v[80:83], a[36:39], v[204:207], v[80:83]
  ds_read_b128 a[12:15], v3 offset:39936
  ds_read_b128 a[16:19], v3 offset:40960
  s_waitcnt lgkmcnt(10)
  s_waitcnt vmcnt(27)
  v_mfma_f32_16x16x32_bf16 v[64:67], a[40:43], v[208:211], v[64:67]
  buffer_load_dwordx4 v5, s[4:7], s60 offen offset:2048 sc1 lds
  v_mfma_f32_16x16x32_bf16 v[68:71], a[44:47], v[208:211], v[68:71]
  ds_read_b128 a[20:23], v3 offset:41984
  v_mfma_f32_16x16x32_bf16 v[72:75], a[48:51], v[208:211], v[72:75]
  ds_read_b128 a[24:27], v3 offset:43008
  ds_read_b128 a[28:31], v3 offset:44032
  v_mfma_f32_16x16x32_bf16 v[76:79], a[52:55], v[208:211], v[76:79]
  buffer_load_dwordx4 v5, s[4:7], s60 offen offset:3072 sc1 lds
  v_mfma_f32_16x16x32_bf16 v[80:83], a[56:59], v[208:211], v[80:83]
  ds_read_b128 a[32:35], v3 offset:45056
  ds_read_b128 a[36:39], v3 offset:46080
  s_waitcnt lgkmcnt(10)
  s_waitcnt vmcnt(28)
  v_mfma_f32_16x16x32_bf16 v[64:67], a[60:63], v[212:215], v[64:67]
  s_add_u32 m0, s45, 81920
  s_nop 0
  buffer_load_dwordx4 v6, s[4:7], s60 offen sc1 lds
  s_add_u32 s60, s60, 20480
  v_mfma_f32_16x16x32_bf16 v[68:71], a[64:67], v[212:215], v[68:71]
  ds_read_b128 a[40:43], v3 offset:47104
  v_mfma_f32_16x16x32_bf16 v[72:75], a[68:71], v[212:215], v[72:75]
  ds_read_b128 a[44:47], v3 offset:48128
  ds_read_b128 a[48:51], v3 offset:49152
  v_mfma_f32_16x16x32_bf16 v[76:79], a[72:75], v[212:215], v[76:79]
  s_add_u32 m0, s44, 143360
  s_nop 0
  buffer_load_dwordx4 v5, s[4:7], s60 offen offset:0 sc1 lds
  v_mfma_f32_16x16x32_bf16 v[80:83], a[76:79], v[212:215], v[80:83]
  ds_read_b128 a[52:55], v3 offset:50176
  ds_read_b128 a[56:59], v3 offset:51200
  s_waitcnt lgkmcnt(10)
  s_waitcnt vmcnt(29)
  v_mfma_f32_16x16x32_bf16 v[64:67], a[0:3], v[216:219], v[64:67]
  buffer_load_dwordx4 v5, s[4:7], s60 offen offset:1024 sc1 lds
  v_mfma_f32_16x16x32_bf16 v[68:71], a[4:7], v[216:219], v[68:71]
  ds_read_b128 a[60:63], v3 offset:52224
  v_mfma_f32_16x16x32_bf16 v[72:75], a[8:11], v[216:219], v[72:75]
  ds_read_b128 a[64:67], v3 offset:53248
  ds_read_b128 a[68:71], v3 offset:54272
  v_mfma_f32_16x16x32_bf16 v[76:79], a[12:15], v[216:219], v[76:79]
  buffer_load_dwordx4 v5, s[4:7], s60 offen offset:2048 sc1 lds
  v_mfma_f32_16x16x32_bf16 v[80:83], a[16:19], v[216:219], v[80:83]
  ds_read_b128 a[72:75], v3 offset:55296
  ds_read_b128 a[76:79], v3 offset:56320
  s_waitcnt lgkmcnt(10)
  s_waitcnt vmcnt(30)
  v_mfma_f32_16x16x32_bf16 v[64:67], a[20:23], v[220:223], v[64:67]
  buffer_load_dwordx4 v5, s[4:7], s60 offen offset:3072 sc1 lds
  v_mfma_f32_16x16x32_bf16 v[68:71], a[24:27], v[220:223], v[68:71]
  ds_read_b128 a[0:3], v2 offset:0
  v_mfma_f32_16x16x32_bf16 v[72:75], a[28:31], v[220:223], v[72:75]
  ds_read_b128 a[4:7], v2 offset:1024
  ds_read_b128 a[8:11], v2 offset:2048
  v_mfma_f32_16x16x32_bf16 v[76:79], a[32:35], v[220:223], v[76:79]
  s_add_u32 m0, s45, 143360
  s_nop 0
  buffer_load_dwordx4 v6, s[4:7], s60 offen sc1 lds
  s_add_u32 s60, s60, 20480
  v_mfma_f32_16x16x32_bf16 v[80:83], a[36:39], v[220:223], v[80:83]
  ds_read_b128 a[12:15], v2 offset:3072
  ds_read_b128 a[16:19], v2 offset:4096
  s_waitcnt lgkmcnt(10)
  s_waitcnt vmcnt(31)
  v_mfma_f32_16x16x32_bf16 v[64:67], a[40:43], v[224:227], v[64:67]
  s_waitcnt vmcnt(12)
  v_cmp_eq_u32 vcc, s36, v253
  s_nop 0
  s_cmp_eq_u64 vcc, -1
  s_cbranch_scc1 PDOK_22
  s_mov_b32 s27, 400000
  buffer_load_dword v250, v30, s[4:7], s65 offen sc1
POLL_23:
  s_waitcnt vmcnt(0)
  v_cmp_eq_u32 vcc, s36, v250
  s_nop 0
  s_cmp_eq_u64 vcc, -1
  s_cbranch_scc1 PDOK_22
  buffer_load_dword v250, v30, s[4:7], s65 offen sc1
  s_sub_u32 s27, s27, 1
  s_cmp_lg_u32 s27, 0
  s_cbranch_scc1 POLL_23
PDOK_22:
  s_add_u32 s65, s65, 131072
  v_mfma_f32_16x16x32_bf16 v[68:71], a[44:47], v[224:227], v[68:71]
  s_add_u32 s56, s66, 2048
  buffer_load_dwordx4 v[168:171], v2, s[4:7], s56 offen sc1
  ds_read_b128 a[20:23], v2 offset:5120
  v_mfma_f32_16x16x32_bf16 v[72:75], a[48:51], v[224:227], v[72:75]
  ds_read_b128 a[24:27], v2 offset:6144
  v_mfma_f32_16x16x32_bf16 v[76:79], a[52:55], v[224:227], v[76:79]
  ds_read_b128 a[28:31], v2 offset:7168
  s_add_u32 s56, s66, 5120
  buffer_load_dwordx4 v[172:175], v2, s[4:7], s56 offen sc1
  v_mfma_f32_16x16x32_bf16 v[80:83], a[56:59], v[224:227], v[80:83]
  ds_read_b128 a[32:35], v2 offset:8192
  ds_read_b128 a[36:39], v2 offset:9216
  s_waitcnt lgkmcnt(10)
  v_mfma_f32_16x16x32_bf16 v[64:67], a[60:63], v[228:231], v[64:67]
  s_add_u32 s56, s66, 8192
  buffer_load_dwordx4 v[176:179], v2, s[4:7], s56 offen sc1
  v_mfma_f32_16x16x32_bf16 v[68:71], a[64:67], v[228:231], v[68:71]
  ds_read_b128 a[40:43], v2 offset:10240
  v_mfma_f32_16x16x32_bf16 v[72:75], a[68:71], v[228:231], v[72:75]
  ds_read_b128 a[44:47], v2 offset:11264
  ds_read_b128 a[48:51], v2 offset:12288
  v_mfma_f32_16x16x32_bf16 v[76:79], a[72:75], v[228:231], v[76:79]
  s_add_u32 s56, s66, 11264
  buffer_load_dwordx4 v[180:183], v2, s[4:7], s56 offen sc1
  v_mfma_f32_16x16x32_bf16 v[80:83], a[76:79], v[228:231], v[80:83]
  ds_read_b128 a[52:55], v2 offset:13312
  ds_read_b128 a[56:59], v2 offset:14336
  s_waitcnt lgkmcnt(10)
  v_mfma_f32_16x16x32_bf16 v[64:67], a[0:3], v[136:139], v[64:67]
  s_add_u32 s56, s66, 14336
  buffer_load_dwordx4 v[184:187], v2, s[4:7], s56 offen sc1
  v_mfma_f32_16x16x32_bf16 v[68:71], a[4:7], v[136:139], v[68:71]
  ds_read_b128 a[60:63], v2 offset:15360
  v_mfma_f32_16x16x32_bf16 v[72:75], a[8:11], v[136:139], v[72:75]
  ds_read_b128 a[64:67], v2 offset:16384
  ds_read_b128 a[68:71], v2 offset:17408
  v_mfma_f32_16x16x32_bf16 v[76:79], a[12:15], v[136:139], v[76:79]
  s_add_u32 s56, s66, 17408
  buffer_load_dwordx4 v[188:191], v2, s[4:7], s56 offen sc1
  v_mfma_f32_16x16x32_bf16 v[80:83], a[16:19], v[136:139], v[80:83]
  ds_read_b128 a[72:75], v2 offset:18432
  ds_read_b128 a[76:79], v2 offset:19456
  s_waitcnt lgkmcnt(10)
  v_mfma_f32_16x16x32_bf16 v[64:67], a[20:23], v[140:143], v[64:67]
  s_add_u32 s56, s66, 20480
  buffer_load_dwordx4 v[192:195], v2, s[4:7], s56 offen sc1
  v_mfma_f32_16x16x32_bf16 v[68:71], a[24:27], v[140:143], v[68:71]
  ds_read_b128 a[0:3], v2 offset:20480
  v_mfma_f32_16x16x32_bf16 v[72:75], a[28:31], v[140:143], v[72:75]
  ds_read_b128 a[4:7], v2 offset:21504
  ds_read_b128 a[8:11], v2 offset:22528
  v_mfma_f32_16x16x32_bf16 v[76:79], a[32:35], v[140:143], v[76:79]
  s_add_u32 s56, s66, 23552
  buffer_load_dwordx4 v[196:199], v2, s[4:7], s56 offen sc1
  v_mfma_f32_16x16x32_bf16 v[80:83], a[36:39], v[140:143], v[80:83]
  ds_read_b128 a[12:15], v2 offset:23552
  ds_read_b128 a[16:19], v2 offset:24576
  s_waitcnt lgkmcnt(10)
  v_mfma_f32_16x16x32_bf16 v[64:67], a[40:43], v[144:147], v[64:67]
  s_add_u32 s56, s66, 26624
  buffer_load_dwordx4 v[200:203], v2, s[4:7], s56 offen sc1
  v_mfma_f32_16x16x32_bf16 v[68:71], a[44:47], v[144:147], v[68:71]
  ds_read_b128 a[20:23], v2 offset:25600
  v_mfma_f32_16x16x32_bf16 v[72:75], a[48:51], v[144:147], v[72:75]
  ds_read_b128 a[24:27], v2 offset:26624
  ds_read_b128 a[28:31], v2 offset:27648
  v_mfma_f32_16x16x32_bf16 v[76:79], a[52:55], v[144:147], v[76:79]
  s_add_u32 s56, s66, 29696
  buffer_load_dwordx4 v[204:207], v2, s[4:7], s56 offen sc1
  v_mfma_f32_16x16x32_bf16 v[80:83], a[56:59], v[144:147], v[80:83]
  ds_read_b128 a[32:35], v2 offset:28672
  ds_read_b128 a[36:39], v2 offset:29696
  s_waitcnt lgkmcnt(10)
  v_mfma_f32_16x16x32_bf16 v[64:67], a[60:63], v[148:151], v[64:67]
  s_add_u32 s56, s66, 32768
  buffer_load_dwordx4 v[208:211], v2, s[4:7], s56 offen sc1
  v_mfma_f32_16x16x32_bf16 v[68:71], a[64:67], v[148:151], v[68:71]
  ds_read_b128 a[40:43], v2 offset:30720
  v_mfma_f32_16x16x32_bf16 v[72:75], a[68:71], v[148:151], v[72:75]
  ds_read_b128 a[44:47], v2 offset:31744
  ds_read_b128 a[48:51], v2 offset:32768
  v_mfma_f32_16x16x32_bf16 v[76:79], a[72:75], v[148:151], v[76:79]
  s_add_u32 s56, s66, 35840
  buffer_load_dwordx4 v[212:215], v2, s[4:7], s56 offen sc1
  v_mfma_f32_16x16x32_bf16 v[80:83], a[76:79], v[148:151], v[80:83]
  ds_read_b128 a[52:55], v2 offset:33792
  ds_read_b128 a[56:59], v2 offset:34816
  s_waitcnt lgkmcnt(10)
  v_mfma_f32_16x16x32_bf16 v[64:67], a[0:3], v[152:155], v[64:67]
  s_add_u32 s56, s66, 38912
  buffer_load_dwordx4 v[216:219], v2, s[4:7], s56 offen sc1
  v_mfma_f32_16x16x32_bf16 v[68:71], a[4:7], v[152:155], v[68:71]
  ds_read_b128 a[60:63], v2 offset:35840
  v_mfma_f32_16x16x32_bf16 v[72:75], a[8:11], v[152:155], v[72:75]
  ds_read_b128 a[64:67], v2 offset:36864
  ds_read_b128 a[68:71], v2 offset:37888
  v_mfma_f32_16x16x32_bf16 v[76:79], a[12:15], v[152:155], v[76:79]
  s_add_u32 s56, s66, 41984
  buffer_load_dwordx4 v[220:223], v2, s[4:7], s56 offen sc1
  v_mfma_f32_16x16x32_bf16 v[80:83], a[16:19], v[152:155], v[80:83]
  ds_read_b128 a[72:75], v2 offset:38912
  ds_read_b128 a[76:79], v2 offset:39936
  s_waitcnt lgkmcnt(10)
  v_mfma_f32_16x16x32_bf16 v[64:67], a[20:23], v[156:159], v[64:67]
  s_waitcnt vmcnt(24)
  v_mfma_f32_16x16x32_bf16 v[68:71], a[24:27], v[156:159], v[68:71]
  s_barrier
  s_add_u32 s56, s66, 45056
  buffer_load_dwordx4 v[224:227], v2, s[4:7], s56 offen sc1
  v_mfma_f32_16x16x32_bf16 v[72:75], a[28:31], v[156:159], v[72:75]
  ds_read_b128 a[0:3], v2 offset:40960
  ds_read_b128 a[4:7], v2 offset:41984
  v_mfma_f32_16x16x32_bf16 v[76:79], a[32:35], v[156:159], v[76:79]
  ds_read_b128 a[8:11], v2 offset:43008
  s_add_u32 s56, s66, 48128
  buffer_load_dwordx4 v[228:231], v2, s[4:7], s56 offen sc1
  v_mfma_f32_16x16x32_bf16 v[80:83], a[36:39], v[156:159], v[80:83]
  ds_read_b128 a[12:15], v2 offset:44032
  ds_read_b128 a[16:19], v2 offset:45056
  s_waitcnt lgkmcnt(10)
  v_mfma_f32_16x16x32_bf16 v[64:67], a[40:43], v[160:163], v[64:67]
  s_mul_i32 s26, s19, 320
  s_add_u32 s26, s26, 78336
  buffer_load_dwordx4 v[84:87], v28, s[4:7], s26 offen offset:0 sc1
  buffer_load_dwordx4 v[88:91], v28, s[4:7], s26 offen offset:16 sc1
  buffer_load_dwordx4 v[92:95], v28, s[4:7], s26 offen offset:128 sc1
  buffer_load_dwordx4 v[96:99], v28, s[4:7], s26 offen offset:144 sc1
  buffer_load_dwordx4 v[100:103], v29, s[4:7], s26 offen offset:256 sc1
  v_mfma_f32_16x16x32_bf16 v[68:71], a[44:47], v[160:163], v[68:71]
  ds_read_b128 a[20:23], v2 offset:46080
  v_mfma_f32_16x16x32_bf16 v[72:75], a[48:51], v[160:163], v[72:75]
  ds_read_b128 a[24:27], v2 offset:47104
  ds_read_b128 a[28:31], v2 offset:48128
  v_mfma_f32_16x16x32_bf16 v[76:79], a[52:55], v[160:163], v[76:79]
  v_mfma_f32_16x16x32_bf16 v[80:83], a[56:59], v[160:163], v[80:83]
  ds_read_b128 a[32:35], v2 offset:49152
  ds_read_b128 a[36:39], v2 offset:50176
  s_waitcnt lgkmcnt(10)
  v_mfma_f32_16x16x32_bf16 v[64:67], a[60:63], v[164:167], v[64:67]
  v_mfma_f32_16x16x32_bf16 v[68:71], a[64:67], v[164:167], v[68:71]
  ds_read_b128 a[40:43], v2 offset:51200
  v_mfma_f32_16x16x32_bf16 v[72:75], a[68:71], v[164:167], v[72:75]
  ds_read_b128 a[44:47], v2 offset:52224
  ds_read_b128 a[48:51], v2 offset:53248
  v_mfma_f32_16x16x32_bf16 v[76:79], a[72:75], v[164:167], v[76:79]
  v_mfma_f32_16x16x32_bf16 v[80:83], a[76:79], v[164:167], v[80:83]
  ds_read_b128 a[52:55], v2 offset:54272
  ds_read_b128 a[56:59], v2 offset:55296
  s_waitcnt lgkmcnt(10)
  s_waitcnt vmcnt(20)
  v_mfma_f32_16x16x32_bf16 v[64:67], a[0:3], v[168:171], v[64:67]
  v_mfma_f32_16x16x32_bf16 v[68:71], a[4:7], v[168:171], v[68:71]
  ds_read_b128 a[60:63], v2 offset:56320
  v_mfma_f32_16x16x32_bf16 v[72:75], a[8:11], v[168:171], v[72:75]
  ds_read_b128 a[64:67], v2 offset:57344
  ds_read_b128 a[68:71], v2 offset:58368
  v_mfma_f32_16x16x32_bf16 v[76:79], a[12:15], v[168:171], v[76:79]
  v_mfma_f32_16x16x32_bf16 v[80:83], a[16:19], v[168:171], v[80:83]
  ds_read_b128 a[72:75], v2 offset:59392
  ds_read_b128 a[76:79], v2 offset:60416
  s_waitcnt lgkmcnt(10)
  s_waitcnt vmcnt(19)
  v_mfma_f32_16x16x32_bf16 v[64:67], a[20:23], v[172:175], v[64:67]
  v_mfma_f32_16x16x32_bf16 v[68:71], a[24:27], v[172:175], v[68:71]
  ds_read_b128 a[0:3], v2 offset:61440
  v_mfma_f32_16x16x32_bf16 v[72:75], a[28:31], v[172:175], v[72:75]
  ds_read_b128 a[4:7], v2 offset:62464
  ds_read_b128 a[8:11], v2 offset:63488
  v_mfma_f32_16x16x32_bf16 v[76:79], a[32:35], v[172:175], v[76:79]
  v_mfma_f32_16x16x32_bf16 v[80:83], a[36:39], v[172:175], v[80:83]
  ds_read_b128 a[12:15], v2 offset:64512
  ds_read_b128 a[16:19], v3 offset:0
  s_waitcnt lgkmcnt(10)
  s_waitcnt vmcnt(18)
  v_mfma_f32_16x16x32_bf16 v[64:67], a[40:43], v[176:179], v[64:67]
  v_mfma_f32_16x16x32_bf16 v[68:71], a[44:47], v[176:179], v[68:71]
  ds_read_b128 a[20:23], v3 offset:1024
  v_mfma_f32_16x16x32_bf16 v[72:75], a[48:51], v[176:179], v[72:75]
  ds_read_b128 a[24:27], v3 offset:2048
  ds_read_b128 a[28:31], v3 offset:3072
  v_mfma_f32_16x16x32_bf16 v[76:79], a[52:55], v[176:179], v[76:79]
  v_mfma_f32_16x16x32_bf16 v[80:83], a[56:59], v[176:179], v[80:83]
  ds_read_b128 a[32:35], v3 offset:4096
  ds_read_b128 a[36:39], v3 offset:5120
  s_waitcnt lgkmcnt(10)
  s_waitcnt vmcnt(17)
  v_mfma_f32_16x16x32_bf16 v[64:67], a[60:63], v[180:183], v[64:67]
  v_mfma_f32_16x16x32_bf16 v[68:71], a[64:67], v[180:183], v[68:71]
  ds_read_b128 a[40:43], v3 offset:6144
  v_mfma_f32_16x16x32_bf16 v[72:75], a[68:71], v[180:183], v[72:75]
  s_branch WOVER_10
  .p2align 12
WARM_10:
  s_setpc_b64 s[94:95]
  s_nop 0
WOVER_10:
  ds_read_b128 a[44:47], v3 offset:7168
  ds_read_b128 a[48:51], v3 offset:8192
  v_mfma_f32_16x16x32_bf16 v[76:79], a[72:75], v[180:183], v[76:79]
  v_mfma_f32_16x16x32_bf16 v[80:83], a[76:79], v[180:183], v[80:83]
  ds_read_b128 a[52:55], v3 offset:9216
  ds_read_b128 a[56:59], v3 offset:10240
  s_waitcnt lgkmcnt(10)
  s_waitcnt vmcnt(16)
  v_mfma_f32_16x16x32_bf16 v[64:67], a[0:3], v[184:187], v[64:67]
  v_mfma_f32_16x16x32_bf16 v[68:71], a[4:7], v[184:187], v[68:71]
  ds_read_b128 a[60:63], v3 offset:11264
  v_mfma_f32_16x16x32_bf16 v[72:75], a[8:11], v[184:187], v[72:75]
  ds_read_b128 a[64:67], v3 offset:12288
  ds_read_b128 a[68:71], v3 offset:13312
  v_mfma_f32_16x16x32_bf16 v[76:79], a[12:15], v[184:187], v[76:79]
  v_mfma_f32_16x16x32_bf16 v[80:83], a[16:19], v[184:187], v[80:83]
  ds_read_b128 a[72:75], v3 offset:14336
  ds_read_b128 a[76:79], v3 offset:15360
  s_waitcnt lgkmcnt(10)
  s_waitcnt vmcnt(15)
  v_mfma_f32_16x16x32_bf16 v[64:67], a[20:23], v[188:191], v[64:67]
  v_mfma_f32_16x16x32_bf16 v[68:71], a[24:27], v[188:191], v[68:71]
  s_barrier
  v_mfma_f32_16x16x32_bf16 v[72:75], a[28:31], v[188:191], v[72:75]
  ds_read_b128 a[0:3], v3 offset:16384
  ds_read_b128 a[4:7], v3 offset:17408
  v_mfma_f32_16x16x32_bf16 v[76:79], a[32:35], v[188:191], v[76:79]
  ds_read_b128 a[8:11], v3 offset:18432
  v_mfma_f32_16x16x32_bf16 v[80:83], a[36:39], v[188:191], v[80:83]
  ds_read_b128 a[12:15], v3 offset:19456
  ds_read_b128 a[16:19], v3 offset:20480
  s_waitcnt lgkmcnt(10)
  s_waitcnt vmcnt(14)
  v_mfma_f32_16x16x32_bf16 v[64:67], a[40:43], v[192:195], v[64:67]
  v_mfma_f32_16x16x32_bf16 v[68:71], a[44:47], v[192:195], v[68:71]
  ds_read_b128 a[20:23], v3 offset:21504
  ds_read_b128 a[24:27], v3 offset:22528
  v_mfma_f32_16x16x32_bf16 v[72:75], a[48:51], v[192:195], v[72:75]
  ds_read_b128 a[28:31], v3 offset:23552
  v_mfma_f32_16x16x32_bf16 v[76:79], a[52:55], v[192:195], v[76:79]
  ds_read_b128 a[32:35], v3 offset:24576
  ds_read_b128 a[36:39], v3 offset:25600
  v_mfma_f32_16x16x32_bf16 v[80:83], a[56:59], v[192:195], v[80:83]
  v_lshlrev_b32 v104, 16, v240
  v_and_b32 v105, 0xffff0000, v240
  s_waitcnt lgkmcnt(10)
  s_waitcnt vmcnt(13)
  v_mfma_f32_16x16x32_bf16 v[64:67], a[60:63], v[196:199], v[64:67]
  v_mfma_f32_16x16x32_bf16 v[68:71], a[64:67], v[196:199], v[68:71]
  ds_read_b128 a[40:43], v3 offset:26624
  ds_read_b128 a[44:47], v3 offset:27648
  v_mfma_f32_16x16x32_bf16 v[72:75], a[68:71], v[196:199], v[72:75]
  ds_read_b128 a[48:51], v3 offset:28672
  v_mfma_f32_16x16x32_bf16 v[76:79], a[72:75], v[196:199], v[76:79]
  ds_read_b128 a[52:55], v3 offset:29696
  ds_read_b128 a[56:59], v3 offset:30720
  v_mfma_f32_16x16x32_bf16 v[80:83], a[76:79], v[196:199], v[80:83]
  v_lshlrev_b32 v106, 16, v241
  v_and_b32 v107, 0xffff0000, v241
  s_waitcnt lgkmcnt(10)
  s_waitcnt vmcnt(12)
  v_mfma_f32_16x16x32_bf16 v[64:67], a[0:3], v[200:203], v[64:67]
  v_mfma_f32_16x16x32_bf16 v[68:71], a[4:7], v[200:203], v[68:71]
  ds_read_b128 a[60:63], v3 offset:31744
  ds_read_b128 a[64:67], v3 offset:32768
  v_mfma_f32_16x16x32_bf16 v[72:75], a[8:11], v[200:203], v[72:75]
  ds_read_b128 a[68:71], v3 offset:33792
  v_mfma_f32_16x16x32_bf16 v[76:79], a[12:15], v[200:203], v[76:79]
  ds_read_b128 a[72:75], v3 offset:34816
  ds_read_b128 a[76:79], v3 offset:35840
  v_mfma_f32_16x16x32_bf16 v[80:83], a[16:19], v[200:203], v[80:83]
  v_lshlrev_b32 v108, 16, v242
  v_and_b32 v109, 0xffff0000, v242
  s_waitcnt lgkmcnt(10)
  s_waitcnt vmcnt(11)
  v_mfma_f32_16x16x32_bf16 v[64:67], a[20:23], v[204:207], v[64:67]
  v_mfma_f32_16x16x32_bf16 v[68:71], a[24:27], v[204:207], v[68:71]
  ds_read_b128 a[0:3], v4 offset:12288
  ds_read_b128 a[4:7], v4 offset:13312
  v_mfma_f32_16x16x32_bf16 v[72:75], a[28:31], v[204:207], v[72:75]
  ds_read_b128 a[8:11], v4 offset:14336
  v_mfma_f32_16x16x32_bf16 v[76:79], a[32:35], v[204:207], v[76:79]
  ds_read_b128 a[12:15], v4 offset:15360
  ds_read_b128 a[16:19], v4 offset:16384
  v_mfma_f32_16x16x32_bf16 v[80:83], a[36:39], v[204:207], v[80:83]
  v_lshlrev_b32 v110, 16, v243
  v_and_b32 v111, 0xffff0000, v243
  s_waitcnt lgkmcnt(10)
  s_waitcnt vmcnt(10)
  v_mfma_f32_16x16x32_bf16 v[64:67], a[40:43], v[208:211], v[64:67]
  v_mfma_f32_16x16x32_bf16 v[68:71], a[44:47], v[208:211], v[68:71]
  ds_read_b128 a[20:23], v4 offset:17408
  ds_read_b128 a[24:27], v4 offset:18432
  v_mfma_f32_16x16x32_bf16 v[72:75], a[48:51], v[208:211], v[72:75]
  ds_read_b128 a[28:31], v4 offset:19456
  v_mfma_f32_16x16x32_bf16 v[76:79], a[52:55], v[208:211], v[76:79]
  ds_read_b128 a[32:35], v4 offset:20480
  ds_read_b128 a[36:39], v4 offset:21504
  v_mfma_f32_16x16x32_bf16 v[80:83], a[56:59], v[208:211], v[80:83]
  v_lshlrev_b32 v112, 16, v244
  v_and_b32 v113, 0xffff0000, v244
  s_waitcnt lgkmcnt(10)
  s_waitcnt vmcnt(9)
  v_mfma_f32_16x16x32_bf16 v[64:67], a[60:63], v[212:215], v[64:67]
  v_mfma_f32_16x16x32_bf16 v[68:71], a[64:67], v[212:215], v[68:71]
  ds_read_b128 a[40:43], v4 offset:22528
  ds_read_b128 a[44:47], v4 offset:23552
  v_mfma_f32_16x16x32_bf16 v[72:75], a[68:71], v[212:215], v[72:75]
  ds_read_b128 a[48:51], v4 offset:24576
  v_mfma_f32_16x16x32_bf16 v[76:79], a[72:75], v[212:215], v[76:79]
  ds_read_b128 a[52:55], v4 offset:25600
  ds_read_b128 a[56:59], v4 offset:26624
  v_mfma_f32_16x16x32_bf16 v[80:83], a[76:79], v[212:215], v[80:83]
  v_lshlrev_b32 v114, 16, v245
  v_and_b32 v115, 0xffff0000, v245
  s_waitcnt lgkmcnt(10)
  s_waitcnt vmcnt(8)
  v_mfma_f32_16x16x32_bf16 v[64:67], a[0:3], v[216:219], v[64:67]
  v_mfma_f32_16x16x32_bf16 v[68:71], a[4:7], v[216:219], v[68:71]
  ds_read_b128 a[60:63], v4 offset:27648
  ds_read_b128 a[64:67], v4 offset:28672
  v_mfma_f32_16x16x32_bf16 v[72:75], a[8:11], v[216:219], v[72:75]
  ds_read_b128 a[68:71], v4 offset:29696
  v_mfma_f32_16x16x32_bf16 v[76:79], a[12:15], v[216:219], v[76:79]
  ds_read_b128 a[72:75], v4 offset:30720
  ds_read_b128 a[76:79], v4 offset:31744
  v_mfma_f32_16x16x32_bf16 v[80:83], a[16:19], v[216:219], v[80:83]
  v_lshlrev_b32 v116, 16, v246
  v_and_b32 v117, 0xffff0000, v246
  s_waitcnt lgkmcnt(10)
  s_waitcnt vmcnt(7)
  v_mfma_f32_16x16x32_bf16 v[64:67], a[20:23], v[220:223], v[64:67]
  v_mfma_f32_16x16x32_bf16 v[68:71], a[24:27], v[220:223], v[68:71]
  v_mfma_f32_16x16x32_bf16 v[72:75], a[28:31], v[220:223], v[72:75]
  v_mfma_f32_16x16x32_bf16 v[76:79], a[32:35], v[220:223], v[76:79]
  v_lshlrev_b32 v118, 16, v247
  v_mfma_f32_16x16x32_bf16 v[80:83], a[36:39], v[220:223], v[80:83]
  v_and_b32 v119, 0xffff0000, v247
  s_waitcnt lgkmcnt(5)
  s_waitcnt vmcnt(6)
  v_mfma_f32_16x16x32_bf16 v[64:67], a[40:43], v[224:227], v[64:67]
  v_mfma_f32_16x16x32_bf16 v[68:71], a[44:47], v[224:227], v[68:71]
  v_mfma_f32_16x16x32_bf16 v[72:75], a[48:51], v[224:227], v[72:75]
  v_mfma_f32_16x16x32_bf16 v[76:79], a[52:55], v[224:227], v[76:79]
  v_lshlrev_b32 v120, 16, v248
  v_mfma_f32_16x16x32_bf16 v[80:83], a[56:59], v[224:227], v[80:83]
  v_and_b32 v121, 0xffff0000, v248
  s_waitcnt lgkmcnt(0)
  s_waitcnt vmcnt(5)
  v_mfma_f32_16x16x32_bf16 v[64:67], a[60:63], v[228:231], v[64:67]
  v_mfma_f32_16x16x32_bf16 v[68:71], a[64:67], v[228:231], v[68:71]
  v_mfma_f32_16x16x32_bf16 v[72:75], a[68:71], v[228:231], v[72:75]
  v_mfma_f32_16x16x32_bf16 v[76:79], a[72:75], v[228:231], v[76:79]
  v_lshlrev_b32 v122, 16, v249
  v_mfma_f32_16x16x32_bf16 v[80:83], a[76:79], v[228:231], v[80:83]
  v_and_b32 v123, 0xffff0000, v249
  s_waitcnt vmcnt(0)
  s_nop 0
  v_pk_fma_f32 v[104:105], v[64:65], v[84:85], v[104:105]
  v_pk_fma_f32 v[106:107], v[66:67], v[86:87], v[106:107]
  v_pk_fma_f32 v[108:109], v[68:69], v[88:89], v[108:109]
  v_pk_fma_f32 v[110:111], v[70:71], v[90:91], v[110:111]
  v_pk_fma_f32 v[112:113], v[72:73], v[92:93], v[112:113]
  v_pk_fma_f32 v[114:115], v[74:75], v[94:95], v[114:115]
  v_pk_fma_f32 v[116:117], v[76:77], v[96:97], v[116:117]
  v_pk_fma_f32 v[118:119], v[78:79], v[98:99], v[118:119]
  v_pk_fma_f32 v[120:121], v[80:81], v[100:101], v[120:121]
  v_pk_fma_f32 v[122:123], v[82:83], v[102:103], v[122:123]
  v_cvt_pk_bf16_f32 v240, v104, v105
  v_cvt_pk_bf16_f32 v241, v106, v107
  v_cvt_pk_bf16_f32 v242, v108, v109
  v_cvt_pk_bf16_f32 v243, v110, v111
  v_cvt_pk_bf16_f32 v244, v112, v113
  v_cvt_pk_bf16_f32 v245, v114, v115
  v_cvt_pk_bf16_f32 v246, v116, v117
  v_cvt_pk_bf16_f32 v247, v118, v119
  v_cvt_pk_bf16_f32 v248, v120, v121
  v_cvt_pk_bf16_f32 v249, v122, v123
  buffer_store_dwordx4 v[240:243], v24, s[12:15], s53 offen
  buffer_store_dwordx4 v[244:247], v24, s[12:15], s53 offen offset:64
  buffer_store_dwordx2 v[248:249], v25, s[12:15], s53 offen offset:128
K_END:
  s_endpgm
.section .rodata,"a"
.p2align 6
.amdhsa_kernel adaLN_cond__sliding_local_dilated__swiglu_ffn__prompt_kernel
  .amdhsa_next_free_vgpr 512
  .amdhsa_next_free_sgpr 102
  .amdhsa_accum_offset 256
  .amdhsa_group_segment_fixed_size 0
  .amdhsa_kernarg_size 96
  .amdhsa_user_sgpr_count 2
  .amdhsa_user_sgpr_kernarg_segment_ptr 1
  .amdhsa_system_sgpr_workgroup_id_x 1
  .amdhsa_float_denorm_mode_32 3
.end_amdhsa_kernel
```
